```python
import torch

def _softmax(x, axis=-1):
    return torch.softmax(x, dim=axis)

def _gelu(x):
    return torch.nn.functional.gelu(x, approximate='tanh')

def _silu(x):
    return torch.nn.functional.silu(x)

def _sigmoid(x):
    return torch.sigmoid(x)

def _layernorm(x, axis=-1, eps=1e-05):
    m = x.mean(dim=axis, keepdim=True)
    v = x.var(dim=axis, keepdim=True, unbiased=False)
    return (x - m) / torch.sqrt(v + eps)

def _scatter_add(tgt, idx, src, axis=0):
    return tgt.clone().index_add_(axis, idx, src)

def _segment_sum(src, seg, n):
    out = torch.zeros((n,) + src.shape[1:], dtype=src.dtype)
    return out.index_add_(0, seg, src)

def _pad(x, pw):
    flat = tuple((v for pair in reversed(pw) for v in pair))
    return torch.nn.functional.pad(x, flat)
kernel_name = 'adaLN_cond__ssm_conv_s4d__mixer_channel_mlp__prompt'

def setup_inputs():

    _w = lambda a: (lambda t: t.to(torch.bfloat16) if t.is_floating_point() else t)(torch.as_tensor(a))

    def _A_setup():
        Bsz, L, D, N = (1, 2048, 512, 128)
        return {'u': _w((lambda *s: torch.randn(*s, dtype=torch.bfloat16) * 0.05)(Bsz, L, D)), 'log_A_real': _w((lambda *s: torch.randn(*s, dtype=torch.bfloat16) * 3.2)(D, N) * 0.5), 'A_imag': _w((lambda *s: torch.randn(*s, dtype=torch.bfloat16) * 0.05)(D, N) * 3.14), 'C_real': _w((lambda *s: torch.randn(*s, dtype=torch.bfloat16) * 0.1)(D, N) / N ** 0.5), 'C_imag': _w((lambda *s: torch.randn(*s, dtype=torch.bfloat16) * 0.2)(D, N) / N ** 0.5), 'log_dt': _w((lambda *s: torch.randn(*s, dtype=torch.bfloat16) * 0.05)(D) * 0.5 - 4.0), 'D_skip': _w((lambda *s: torch.randn(*s, dtype=torch.bfloat16) * 0.1)(D))}
    _A_in = _A_setup()

    def _B_setup():
        B, S, D, F = (1, 2048, 512, 1376)
        return {'x': _w((lambda *s: torch.randn(*s, dtype=torch.bfloat16) * 0.05)(B, S, D)), 'w1': _w((lambda *s: torch.randn(*s, dtype=torch.bfloat16) * 3.2)(D, F) * D ** (-0.5)), 'b1': _w((lambda *s: torch.randn(*s, dtype=torch.bfloat16) * 0.8)(F)), 'w2': _w((lambda *s: torch.randn(*s, dtype=torch.bfloat16) * 3.2)(F, D) * F ** (-0.5)), 'b2': _w((lambda *s: torch.randn(*s, dtype=torch.bfloat16) * 3.2)(D))}
    _B_in = _B_setup()
    return {'A_u': _A_in['u'], 'A_log_A_real': _A_in['log_A_real'], 'A_A_imag': _A_in['A_imag'], 'A_C_real': _A_in['C_real'], 'A_C_imag': _A_in['C_imag'], 'A_log_dt': _A_in['log_dt'], 'A_D_skip': _A_in['D_skip'], 'B_x': _B_in['x'], 'B_w1': _B_in['w1'], 'B_b1': _B_in['b1'], 'B_w2': _B_in['w2'], 'B_b2': _B_in['b2'], 'c': _w((lambda *s: torch.randn(*s, dtype=torch.bfloat16) * 0.4)(1, 512) * 8.0), 'w_mod': _w((lambda *s: torch.randn(*s, dtype=torch.bfloat16) * 0.4)(512, 6 * 512) * 512 ** (-0.5) * 8.0)}

def reference(A_u, A_log_A_real, A_A_imag, A_C_real, A_C_imag, A_log_dt, A_D_skip, B_x, B_w1, B_b1, B_w2, B_b2, c, w_mod):

    def _A_ref(u, log_A_real, A_imag, C_real, C_imag, log_dt, D_skip):
        L = u.shape[1]
        dt = torch.exp(log_dt)
        A = -torch.exp(log_A_real) + 1j * A_imag
        C = (C_real + 1j * C_imag) * dt[:, None]
        pos = (lambda x, dt: x.to(dt))(torch.arange(L), log_dt.dtype)
        P = torch.exp((A * dt[:, None])[:, :, None] * pos[None, None, :])
        K = 2.0 * torch.einsum('dn,dnl->dl', C, P).real
        L2 = 2 * L
        u_t = (lambda x, *d: x.permute(*d))(u, 0, 2, 1)
        Kf = (lambda x, *a, **k: torch.fft.rfft(x.float(), *a, **k))(K, L2)
        Uf = (lambda x, *a, **k: torch.fft.rfft(x.float(), *a, **k))(u_t, L2)
        y = (lambda x, *a, **k: torch.fft.irfft(x, *a, **k).to(torch.bfloat16))(Uf * Kf[None, :, :], L2)[:, :, :L]
        y = (lambda x, *d: x.permute(*d))(y, 0, 2, 1)
        return y + u * D_skip[None, None, :]

    def _B_ref(x, w1, b1, w2, b2):
        y = _layernorm(x, axis=-1)
        h = _gelu(torch.einsum('bsd,df->bsf', y, w1) + b1)
        return torch.einsum('bsf,fd->bsd', h, w2) + b2
    x = A_u
    mod = (_silu(c) @ w_mod).reshape(c.shape[0], 6, 1, -1)
    sa, ca, ga, sb, cb, gb = (mod[:, 0].clone(), mod[:, 1].clone(), mod[:, 2].clone(), mod[:, 3].clone(), mod[:, 4].clone(), mod[:, 5].clone())
    h = _layernorm(x, axis=-1) * (1 + ca) + sa
    x = x + ga * _A_ref(h, A_log_A_real, A_A_imag, A_C_real, A_C_imag, A_log_dt, A_D_skip)
    h = _layernorm(x, axis=-1) * (1 + cb) + sb
    x = x + gb * _B_ref(h, B_w1, B_b1, B_w2, B_b2)
    return x
```

```asm
; @launch kernel=k12_kernel grid=(256,1,1) block=(512,1,1) lds=162624
; @launch kernel=k3_kernel grid=(256,1,1) block=(256,1,1) lds=146432
.amdgcn_target "amdgcn-amd-amdhsa--gfx950"
.text
.globl k12_kernel
.p2align 8
.type k12_kernel,@function
k12_kernel:
s_cmp_ge_u32 s2, 256
s_cbranch_scc1 K2_EXIT
s_load_dwordx8 s[4:11], s[0:1], 8
s_load_dwordx4 s[44:47], s[0:1], 40
s_load_dwordx2 s[14:15], s[0:1], 128
s_load_dwordx2 s[16:17], s[0:1], 0
s_load_dwordx2 s[18:19], s[0:1], 120
s_load_dwordx4 s[20:23], s[0:1], 96
s_load_dwordx2 s[48:49], s[0:1], 64
s_load_dwordx2 s[12:13], s[0:1], 80
v_lshrrev_b32 v1, 6, v0
s_nop 0
v_readfirstlane_b32 s24, v1
v_and_b32 v1, 63, v0
v_lshlrev_b32 v2, 2, v0
v_add_u32 v2, 162560, v2
v_mov_b32 v3, 0
v_cmp_gt_u32 vcc, 16, v0
s_and_saveexec_b64 s[42:43], vcc
ds_write_b32 v2, v3
s_mov_b64 exec, s[42:43]
s_cmp_ge_u32 s24, 4
s_cbranch_scc1 K12_SIDE0
s_lshr_b32 s25, s24, 1
s_and_b32 s26, s24, 1
s_lshl_b32 s62, s2, 1
s_add_u32 s27, s62, s25
s_lshl_b32 s28, s27, 8
s_lshl_b32 s29, s26, 7
s_add_u32 s28, s28, s29
v_lshl_add_u32 v2, v1, 1, s28
s_lshl_b32 s30, s2, 2
s_waitcnt lgkmcnt(0)
global_load_ushort v4, v2, s[4:5] nt
global_load_ushort v5, v2, s[6:7] nt
global_load_ushort v6, v2, s[8:9] nt
global_load_ushort v7, v2, s[10:11] nt
s_load_dword s29, s[44:45], s30
s_load_dword s56, s[46:47], s30
s_branch K12_CONV0
K12_SIDE0:
s_setprio 3
s_sub_u32 s25, s24, 4
s_and_b32 s28, s2, 7
s_lshr_b32 s29, s2, 3
s_lshr_b32 s26, s29, 3
s_lshl_b32 s27, s28, 2
s_add_u32 s26, s26, s27
s_and_b32 s27, s29, 7
s_lshl_b32 s30, s28, 8
s_lshl_b32 s31, s29, 3
s_add_u32 s30, s30, s31
s_lshl_b32 s31, s25, 1
s_add_u32 s30, s30, s31
s_mul_i32 s57, s25, 11520
s_add_u32 s57, s57, 101248
v_subrev_u32 v30, 256, v0
s_lshl_b32 s28, s26, 16
s_lshl_b32 s29, s27, 7
s_add_u32 s28, s28, s29
v_lshrrev_b32 v2, 3, v30
v_and_b32 v3, 7, v30
v_lshlrev_b32 v4, 10, v2
v_lshl_add_u32 v4, v3, 4, v4
v_add_u32 v4, s28, v4
v_add_u32 v5, 0x8000, v4
s_lshl_b32 s31, s30, 10
v_lshl_add_u32 v6, v1, 4, s31
s_and_b32 s33, s2, 7
s_mul_i32 s33, s33, 6
s_lshr_b32 s34, s2, 5
s_add_u32 s33, s33, s34
s_bfe_u32 s34, s2, 0x20003
s_lshl_b32 s35, s34, 7
v_add_u32 v7, s35, v2
v_mul_u32_u24 v25, 6144, v7
v_lshl_add_u32 v25, v3, 4, v25
s_lshl_b32 s35, s33, 7
v_add_u32 v25, s35, v25
v_add_u32 v26, 196608, v25
v_add_u32 v27, 196608, v26
v_add_u32 v28, 196608, v27
v_lshlrev_b32 v29, 1, v7
s_waitcnt lgkmcnt(0)
global_load_dwordx4 v[8:11], v4, s[16:17]
global_load_dwordx4 v[12:15], v5, s[16:17]
global_load_dwordx4 v[16:19], v6, s[16:17]
global_load_dwordx4 v[20:23], v6, s[16:17] offset:1024
s_cmp_ge_u32 s2, 192
s_cbranch_scc1 K1_nomodld
global_load_ushort v48, v29, s[20:21] offset:0
global_load_ushort v49, v29, s[20:21] offset:64
global_load_ushort v50, v29, s[20:21] offset:128
global_load_ushort v51, v29, s[20:21] offset:192
global_load_dwordx4 v[32:35], v25, s[22:23] nt
global_load_dwordx4 v[36:39], v26, s[22:23] nt
global_load_dwordx4 v[40:43], v27, s[22:23] nt
global_load_dwordx4 v[44:47], v28, s[22:23] nt
K1_nomodld:
s_sub_u32 s65, s2, 192
s_cmp_ge_u32 s65, 16
s_cbranch_scc1 K12_nocpf
s_cmp_lg_u32 s24, 7
s_cbranch_scc1 K12_nocpf
s_getpc_b64 s[66:67]
CPF_k1:
s_sub_u32 s66, s66, CPF_k1-k12_kernel
s_subb_u32 s67, s67, 0
v_lshlrev_b32 v199, 7, v1
s_mov_b64 s[68:69], exec
v_cmp_gt_u32 vcc, K3_EXIT-k12_kernel, v199
s_and_b64 exec, s[68:69], vcc
s_cbranch_execz CPF_k1_done
global_load_dword v200, v199, s[66:67]
v_add_u32 v199, 8192, v199
v_cmp_gt_u32 vcc, K3_EXIT-k12_kernel, v199
s_and_b64 exec, s[68:69], vcc
s_cbranch_execz CPF_k1_done
global_load_dword v201, v199, s[66:67]
v_add_u32 v199, 8192, v199
v_cmp_gt_u32 vcc, K3_EXIT-k12_kernel, v199
s_and_b64 exec, s[68:69], vcc
s_cbranch_execz CPF_k1_done
global_load_dword v202, v199, s[66:67]
v_add_u32 v199, 8192, v199
v_cmp_gt_u32 vcc, K3_EXIT-k12_kernel, v199
s_and_b64 exec, s[68:69], vcc
s_cbranch_execz CPF_k1_done
global_load_dword v203, v199, s[66:67]
v_add_u32 v199, 8192, v199
v_cmp_gt_u32 vcc, K3_EXIT-k12_kernel, v199
s_and_b64 exec, s[68:69], vcc
s_cbranch_execz CPF_k1_done
global_load_dword v204, v199, s[66:67]
v_add_u32 v199, 8192, v199
v_cmp_gt_u32 vcc, K3_EXIT-k12_kernel, v199
s_and_b64 exec, s[68:69], vcc
s_cbranch_execz CPF_k1_done
global_load_dword v205, v199, s[66:67]
v_add_u32 v199, 8192, v199
CPF_k1_done:
s_mov_b64 exec, s[68:69]
K12_nocpf:
s_branch K2_SIDE
K12_CONV0:
s_barrier
s_cmp_eq_u32 s2, 255
s_cselect_b32 s64, 1, 0
s_cmp_eq_u32 s24, 0
s_cselect_b32 s64, s64, 0
s_cmp_eq_u32 s64, 1
s_cbranch_scc0 K12_noinit
v_mov_b32 v64, 0
v_mov_b32 v65, 0
v_mov_b32 v66, 0
v_mov_b32 v67, 0
v_lshlrev_b32 v68, 4, v1
v_add_u32 v68, 6520832, v68
global_store_dwordx4 v68, v[64:67], s[14:15] sc1
v_add_u32 v68, 1024, v68
global_store_dwordx4 v68, v[64:67], s[14:15] sc1
v_add_u32 v68, 1024, v68
global_store_dwordx4 v68, v[64:67], s[14:15] sc1
v_add_u32 v68, 1024, v68
global_store_dwordx4 v68, v[64:67], s[14:15] sc1
v_add_u32 v68, 1024, v68
global_store_dwordx4 v68, v[64:67], s[14:15] sc1
v_add_u32 v68, 1024, v68
global_store_dwordx4 v68, v[64:67], s[14:15] sc1
v_add_u32 v68, 1024, v68
global_store_dwordx4 v68, v[64:67], s[14:15] sc1
v_add_u32 v68, 1024, v68
global_store_dwordx4 v68, v[64:67], s[14:15] sc1
v_add_u32 v68, 1024, v68
global_store_dwordx4 v68, v[64:67], s[14:15] sc1
v_add_u32 v68, 1024, v68
global_store_dwordx4 v68, v[64:67], s[14:15] sc1
v_add_u32 v68, 1024, v68
global_store_dwordx4 v68, v[64:67], s[14:15] sc1
v_add_u32 v68, 1024, v68
global_store_dwordx4 v68, v[64:67], s[14:15] sc1
v_add_u32 v68, 1024, v68
global_store_dwordx4 v68, v[64:67], s[14:15] sc1
v_add_u32 v68, 1024, v68
global_store_dwordx4 v68, v[64:67], s[14:15] sc1
v_add_u32 v68, 1024, v68
global_store_dwordx4 v68, v[64:67], s[14:15] sc1
v_add_u32 v68, 1024, v68
global_store_dwordx4 v68, v[64:67], s[14:15] sc1
K12_noinit:
v_mov_b32 v56, 0
v_mov_b32 v57, 0
v_mov_b32 v58, 0
v_mov_b32 v59, 0
v_mul_u32_u24 v53, 171, v0
v_lshrrev_b32 v53, 9, v53
v_mul_u32_u24 v54, 3, v53
v_sub_u32 v54, v0, v54
v_mul_u32_u24 v53, 4160, v53
v_lshl_add_u32 v53, v54, 4, v53
v_cmp_gt_u32 vcc, 48, v0
s_and_saveexec_b64 s[42:43], vcc
ds_write_b128 v53, v[56:59]
s_mov_b64 exec, s[42:43]
v_lshlrev_b32 v53, 4, v0
v_add_u32 v53, 66560, v53
v_cmp_gt_u32 vcc, 186, v0
s_and_saveexec_b64 s[42:43], vcc
ds_write_b128 v53, v[56:59]
ds_write_b128 v53, v[56:59] offset:9120
s_mov_b64 exec, s[42:43]
v_and_b32 v16, 15, v1
v_cmp_eq_u32 s[32:33], 15, v16
v_lshrrev_b32 v18, 4, v1
v_add_u32 v19, 1, v16
v_cvt_f32_u32 v19, v19
s_lshl_b32 s31, s24, 10
s_add_u32 s31, s31, 147328
v_lshl_add_u32 v17, v18, 6, s31
v_lshl_add_u32 v20, v1, 4, s31
v_mov_b32 v112, 0
v_mov_b32 v113, 0
v_mov_b32 v114, 0
v_mov_b32 v115, 0
v_mov_b32 v116, 0
v_mov_b32 v117, 0
v_mov_b32 v118, 0
v_mov_b32 v119, 0
v_mov_b32 v120, 0
v_mov_b32 v121, 0
v_mov_b32 v122, 0
v_mov_b32 v123, 0
v_mov_b32 v124, 0
v_mov_b32 v125, 0
v_mov_b32 v126, 0
v_mov_b32 v127, 0
s_mul_i32 s39, s25, 1344
s_add_u32 s39, s39, 151432
v_subrev_u32 v21, 7, v16
v_cmp_gt_u32 s[34:35], 8, v21
v_add_u32 v21, 1, v16
v_and_b32 v21, 15, v21
v_lshlrev_b32 v24, 5, v21
v_lshl_add_u32 v24, v18, 3, v24
s_lshl_b32 s40, s26, 9
s_add_u32 s40, s40, s39
v_add_u32 v24, s40, v24
s_cmp_eq_u32 s26, 0
s_cselect_b64 s[36:37], -1, s[34:35]
s_lshl_b32 s40, s24, 12
s_add_u32 s40, s40, 84800
v_lshl_add_u32 v22, v1, 4, s40
s_lshl_b32 s40, s25, 13
s_lshl_b32 s41, s26, 11
s_add_u32 s40, s40, s41
s_add_u32 s40, s40, 84800
v_lshl_add_u32 v23, v1, 4, s40
s_lshl_b32 s40, s26, 6
v_add_u32 v26, s40, v1
v_lshlrev_b32 v27, 3, v26
v_sub_u32 v27, 2047, v27
v_cvt_f32_u32 v28, v27
s_sub_u32 s41, s39, 34050
s_sub_u32 s42, s39, 2
v_mov_b32 v48, v28
v_add_f32 v49, -1.0, v28
v_add_f32 v50, -2.0, v28
v_add_f32 v51, -3.0, v28
v_add_f32 v52, -4.0, v28
v_add_f32 v53, -5.0, v28
v_add_f32 v54, -6.0, v28
v_add_f32 v55, -7.0, v28
v_cvt_pk_bf16_f32 v56, v48, v49
v_cvt_pk_bf16_f32 v57, v50, v51
v_cvt_pk_bf16_f32 v58, v52, v53
v_cvt_pk_bf16_f32 v59, v54, v55
v_and_b32 v48, 0xffff, v56
v_lshrrev_b32 v49, 16, v56
v_and_b32 v50, 0xffff, v57
v_lshrrev_b32 v51, 16, v57
v_and_b32 v52, 0xffff, v58
v_lshrrev_b32 v53, 16, v58
v_and_b32 v54, 0xffff, v59
v_lshrrev_b32 v55, 16, v59
v_lshl_add_u32 v140, v48, 1, s41
v_lshl_add_u32 v141, v49, 1, s41
v_lshl_add_u32 v142, v50, 1, s41
v_lshl_add_u32 v143, v51, 1, s41
v_lshl_add_u32 v144, v52, 1, s41
v_lshl_add_u32 v145, v53, 1, s41
v_lshl_add_u32 v146, v54, 1, s41
v_lshl_add_u32 v147, v55, 1, s41
v_add_f32 v28, 0xc4800000, v28
v_subrev_u32 v27, 1024, v27
v_mov_b32 v48, v28
v_add_f32 v49, -1.0, v28
v_add_f32 v50, -2.0, v28
v_add_f32 v51, -3.0, v28
v_add_f32 v52, -4.0, v28
v_add_f32 v53, -5.0, v28
v_add_f32 v54, -6.0, v28
v_add_f32 v55, -7.0, v28
v_cvt_pk_bf16_f32 v56, v48, v49
v_cvt_pk_bf16_f32 v57, v50, v51
v_cvt_pk_bf16_f32 v58, v52, v53
v_cvt_pk_bf16_f32 v59, v54, v55
v_and_b32 v48, 0xffff, v56
v_lshrrev_b32 v49, 16, v56
v_and_b32 v50, 0xffff, v57
v_lshrrev_b32 v51, 16, v57
v_and_b32 v52, 0xffff, v58
v_lshrrev_b32 v53, 16, v58
v_and_b32 v54, 0xffff, v59
v_lshrrev_b32 v55, 16, v59
v_lshl_add_u32 v148, v48, 1, s41
v_lshl_add_u32 v149, v49, 1, s41
v_lshl_add_u32 v150, v50, 1, s41
v_lshl_add_u32 v151, v51, 1, s41
v_lshl_add_u32 v152, v52, 1, s41
v_lshl_add_u32 v153, v53, 1, s41
v_lshl_add_u32 v154, v54, 1, s41
v_lshl_add_u32 v155, v55, 1, s41
v_cmp_le_u32 vcc, 112, v26
v_subrev_u32 v56, 0, v27
v_lshl_add_u32 v56, v56, 1, s42
v_cndmask_b32 v148, v148, v56, vcc
v_subrev_u32 v57, 1, v27
v_lshl_add_u32 v57, v57, 1, s42
v_cndmask_b32 v149, v149, v57, vcc
v_subrev_u32 v58, 2, v27
v_lshl_add_u32 v58, v58, 1, s42
v_cndmask_b32 v150, v150, v58, vcc
v_subrev_u32 v59, 3, v27
v_lshl_add_u32 v59, v59, 1, s42
v_cndmask_b32 v151, v151, v59, vcc
v_subrev_u32 v56, 4, v27
v_lshl_add_u32 v56, v56, 1, s42
v_cndmask_b32 v152, v152, v56, vcc
v_subrev_u32 v57, 5, v27
v_lshl_add_u32 v57, v57, 1, s42
v_cndmask_b32 v153, v153, v57, vcc
v_subrev_u32 v58, 6, v27
v_lshl_add_u32 v58, v58, 1, s42
v_cndmask_b32 v154, v154, v58, vcc
v_subrev_u32 v59, 7, v27
v_lshl_add_u32 v59, v59, 1, s42
v_cndmask_b32 v155, v155, v59, vcc
s_mul_i32 s40, s25, 4160
s_add_u32 s40, s40, 154240
v_lshl_add_u32 v29, v26, 4, s40
s_add_u32 s41, s40, 4080
v_lshlrev_b32 v30, 4, v26
v_sub_u32 v30, s41, v30
s_mul_i32 s41, s25, 33280
s_add_u32 s41, s41, 48
v_lshl_add_u32 v31, v26, 4, s41
s_waitcnt lgkmcnt(0)
s_lshl_b32 s40, s25, 4
s_lshr_b32 s29, s29, s40
s_lshl_b32 s29, s29, 16
v_mov_b32 v8, 0x3fb8aa3b
v_mul_f32 v9, s29, v8
v_exp_f32 v9, v9
s_nop 0
v_cvt_pk_bf16_f32 v9, v9, v9
v_and_b32 v9, 0xffff0000, v9
s_waitcnt vmcnt(0)
s_cmp_eq_u32 s64, 1
s_cbranch_scc0 K12_nopub
v_mov_b32 v68, 0
v_mov_b32 v69, 1
s_mov_b64 exec, 1
global_store_dword v68, v69, s[18:19] sc1
s_mov_b64 exec, -1
K12_nopub:
v_lshlrev_b32 v4, 16, v4
v_lshlrev_b32 v5, 16, v5
v_lshlrev_b32 v6, 16, v6
v_lshlrev_b32 v7, 16, v7
v_mul_f32 v4, v4, v8
v_exp_f32 v4, v4
v_mul_f32 v13, v5, v9
v_mul_f32 v14, v6, v9
v_cvt_pk_bf16_f32 v4, v4, v4
v_and_b32 v4, 0xffff0000, v4
v_mul_f32 v15, v7, v9
v_mul_f32 v12, v4, v9
v_mul_f32 v13, 0.15915494, v13
v_add_f32 v14, v14, v14
v_add_f32 v15, v15, v15
v_mul_f32 v12, v12, v8
v_mov_b32 v10, v14
v_sub_f32 v12, 0, v12
ds_write_b128 v20, v[12:15]
s_nop 1
v_add_f32_dpp v10, v10, v10 row_shr:1
s_nop 1
v_add_f32_dpp v10, v10, v10 row_shr:2
s_nop 1
v_add_f32_dpp v10, v10, v10 row_shr:4
s_nop 1
v_add_f32_dpp v10, v10, v10 row_shr:8
s_nop 1
v_add_f32_dpp v10, v10, v10 row_bcast:15 row_mask:0xa
s_nop 1
v_add_f32_dpp v10, v10, v10 row_bcast:31 row_mask:0xc
s_waitcnt lgkmcnt(0)
ds_read_b128 v[32:35], v17 offset:0
ds_read_b128 v[36:39], v17 offset:16
ds_read_b128 v[40:43], v17 offset:32
ds_read_b128 v[44:47], v17 offset:48
ds_read_b128 v[48:51], v17 offset:256
ds_read_b128 v[52:55], v17 offset:272
ds_read_b128 v[56:59], v17 offset:288
ds_read_b128 v[60:63], v17 offset:304
s_waitcnt lgkmcnt(4)
v_mul_f32 v80, v32, v19
v_mul_f32 v82, v36, v19
v_mul_f32 v84, v40, v19
v_mul_f32 v86, v44, v19
v_mul_f32 v81, v33, v19
v_mul_f32 v83, v37, v19
v_mul_f32 v85, v41, v19
v_mul_f32 v87, v45, v19
v_exp_f32 v132, v80
v_exp_f32 v134, v82
v_exp_f32 v136, v84
v_exp_f32 v138, v86
v_fract_f32 v81, v81
v_fract_f32 v83, v83
v_fract_f32 v85, v85
v_fract_f32 v87, v87
v_cvt_pk_bf16_f32 v128, v34, -v35
v_cvt_pk_bf16_f32 v129, v38, -v39
v_cvt_pk_bf16_f32 v130, v42, -v43
v_cvt_pk_bf16_f32 v131, v46, -v47
v_cos_f32 v72, v81
v_cos_f32 v74, v83
v_cos_f32 v76, v85
v_cos_f32 v78, v87
v_sin_f32 v73, v81
v_sin_f32 v75, v83
v_sin_f32 v77, v85
v_sin_f32 v79, v87
s_nop 0
v_pk_mul_f32 v[64:65], v[72:73], v[132:133] op_sel:[0,0] op_sel_hi:[1,0]
v_pk_mul_f32 v[66:67], v[74:75], v[134:135] op_sel:[0,0] op_sel_hi:[1,0]
v_pk_mul_f32 v[68:69], v[76:77], v[136:137] op_sel:[0,0] op_sel_hi:[1,0]
v_pk_mul_f32 v[70:71], v[78:79], v[138:139] op_sel:[0,0] op_sel_hi:[1,0]
v_cvt_pk_bf16_f32 v88, v64, v65
v_cvt_pk_bf16_f32 v89, v66, v67
v_cvt_pk_bf16_f32 v90, v68, v69
v_cvt_pk_bf16_f32 v91, v70, v71
v_pk_mul_f32 v[80:81], v[64:65], v[64:65] op_sel:[0,0] op_sel_hi:[1,0]
v_pk_mul_f32 v[82:83], v[66:67], v[66:67] op_sel:[0,0] op_sel_hi:[1,0]
v_pk_mul_f32 v[84:85], v[68:69], v[68:69] op_sel:[0,0] op_sel_hi:[1,0]
v_pk_mul_f32 v[86:87], v[70:71], v[70:71] op_sel:[0,0] op_sel_hi:[1,0]
v_pk_fma_f32 v[72:73], v[64:65], v[64:65], v[80:81] op_sel:[1,1,0] op_sel_hi:[0,1,1] neg_lo:[1,0,0]
v_pk_fma_f32 v[74:75], v[66:67], v[66:67], v[82:83] op_sel:[1,1,0] op_sel_hi:[0,1,1] neg_lo:[1,0,0]
v_pk_fma_f32 v[76:77], v[68:69], v[68:69], v[84:85] op_sel:[1,1,0] op_sel_hi:[0,1,1] neg_lo:[1,0,0]
v_pk_fma_f32 v[78:79], v[70:71], v[70:71], v[86:87] op_sel:[1,1,0] op_sel_hi:[0,1,1] neg_lo:[1,0,0]
v_cvt_pk_bf16_f32 v92, v72, v73
v_cvt_pk_bf16_f32 v93, v74, v75
v_cvt_pk_bf16_f32 v94, v76, v77
v_cvt_pk_bf16_f32 v95, v78, v79
v_pk_mul_f32 v[80:81], v[72:73], v[72:73] op_sel:[0,0] op_sel_hi:[1,0]
v_pk_mul_f32 v[82:83], v[74:75], v[74:75] op_sel:[0,0] op_sel_hi:[1,0]
v_pk_mul_f32 v[84:85], v[76:77], v[76:77] op_sel:[0,0] op_sel_hi:[1,0]
v_pk_mul_f32 v[86:87], v[78:79], v[78:79] op_sel:[0,0] op_sel_hi:[1,0]
v_pk_fma_f32 v[64:65], v[72:73], v[72:73], v[80:81] op_sel:[1,1,0] op_sel_hi:[0,1,1] neg_lo:[1,0,0]
v_pk_fma_f32 v[66:67], v[74:75], v[74:75], v[82:83] op_sel:[1,1,0] op_sel_hi:[0,1,1] neg_lo:[1,0,0]
v_pk_fma_f32 v[68:69], v[76:77], v[76:77], v[84:85] op_sel:[1,1,0] op_sel_hi:[0,1,1] neg_lo:[1,0,0]
v_pk_fma_f32 v[70:71], v[78:79], v[78:79], v[86:87] op_sel:[1,1,0] op_sel_hi:[0,1,1] neg_lo:[1,0,0]
v_cvt_pk_bf16_f32 v96, v64, v65
v_cvt_pk_bf16_f32 v97, v66, v67
v_cvt_pk_bf16_f32 v98, v68, v69
v_cvt_pk_bf16_f32 v99, v70, v71
v_pk_mul_f32 v[80:81], v[64:65], v[64:65] op_sel:[0,0] op_sel_hi:[1,0]
v_pk_mul_f32 v[82:83], v[66:67], v[66:67] op_sel:[0,0] op_sel_hi:[1,0]
v_pk_mul_f32 v[84:85], v[68:69], v[68:69] op_sel:[0,0] op_sel_hi:[1,0]
v_pk_mul_f32 v[86:87], v[70:71], v[70:71] op_sel:[0,0] op_sel_hi:[1,0]
v_pk_fma_f32 v[72:73], v[64:65], v[64:65], v[80:81] op_sel:[1,1,0] op_sel_hi:[0,1,1] neg_lo:[1,0,0]
v_pk_fma_f32 v[74:75], v[66:67], v[66:67], v[82:83] op_sel:[1,1,0] op_sel_hi:[0,1,1] neg_lo:[1,0,0]
v_pk_fma_f32 v[76:77], v[68:69], v[68:69], v[84:85] op_sel:[1,1,0] op_sel_hi:[0,1,1] neg_lo:[1,0,0]
v_pk_fma_f32 v[78:79], v[70:71], v[70:71], v[86:87] op_sel:[1,1,0] op_sel_hi:[0,1,1] neg_lo:[1,0,0]
v_cvt_pk_bf16_f32 v100, v72, v73
v_cvt_pk_bf16_f32 v101, v74, v75
v_cvt_pk_bf16_f32 v102, v76, v77
v_cvt_pk_bf16_f32 v103, v78, v79
v_pk_mul_f32 v[80:81], v[72:73], v[72:73] op_sel:[0,0] op_sel_hi:[1,0]
v_pk_mul_f32 v[82:83], v[74:75], v[74:75] op_sel:[0,0] op_sel_hi:[1,0]
v_pk_mul_f32 v[84:85], v[76:77], v[76:77] op_sel:[0,0] op_sel_hi:[1,0]
v_pk_mul_f32 v[86:87], v[78:79], v[78:79] op_sel:[0,0] op_sel_hi:[1,0]
v_pk_fma_f32 v[64:65], v[72:73], v[72:73], v[80:81] op_sel:[1,1,0] op_sel_hi:[0,1,1] neg_lo:[1,0,0]
v_pk_fma_f32 v[66:67], v[74:75], v[74:75], v[82:83] op_sel:[1,1,0] op_sel_hi:[0,1,1] neg_lo:[1,0,0]
v_pk_fma_f32 v[68:69], v[76:77], v[76:77], v[84:85] op_sel:[1,1,0] op_sel_hi:[0,1,1] neg_lo:[1,0,0]
v_pk_fma_f32 v[70:71], v[78:79], v[78:79], v[86:87] op_sel:[1,1,0] op_sel_hi:[0,1,1] neg_lo:[1,0,0]
v_pk_mul_f32 v[80:81], v[64:65], v[34:35] op_sel:[0,0] op_sel_hi:[1,0] neg_hi:[0,1]
v_pk_mul_f32 v[82:83], v[66:67], v[38:39] op_sel:[0,0] op_sel_hi:[1,0] neg_hi:[0,1]
v_pk_mul_f32 v[84:85], v[68:69], v[42:43] op_sel:[0,0] op_sel_hi:[1,0] neg_hi:[0,1]
v_pk_mul_f32 v[86:87], v[70:71], v[46:47] op_sel:[0,0] op_sel_hi:[1,0] neg_hi:[0,1]
v_pk_fma_f32 v[72:73], v[64:65], v[34:35], v[80:81] op_sel:[1,1,0] op_sel_hi:[0,1,1] neg_lo:[1,0,0] neg_hi:[1,0,0]
v_pk_fma_f32 v[74:75], v[66:67], v[38:39], v[82:83] op_sel:[1,1,0] op_sel_hi:[0,1,1] neg_lo:[1,0,0] neg_hi:[1,0,0]
v_pk_fma_f32 v[76:77], v[68:69], v[42:43], v[84:85] op_sel:[1,1,0] op_sel_hi:[0,1,1] neg_lo:[1,0,0] neg_hi:[1,0,0]
v_pk_fma_f32 v[78:79], v[70:71], v[46:47], v[86:87] op_sel:[1,1,0] op_sel_hi:[0,1,1] neg_lo:[1,0,0] neg_hi:[1,0,0]
v_cvt_pk_bf16_f32 v104, v72, v73
v_cvt_pk_bf16_f32 v105, v74, v75
v_cvt_pk_bf16_f32 v106, v76, v77
v_cvt_pk_bf16_f32 v107, v78, v79
v_cndmask_b32 v104, v104, v128, s[32:33]
v_cndmask_b32 v105, v105, v129, s[32:33]
v_cndmask_b32 v106, v106, v130, s[32:33]
v_cndmask_b32 v107, v107, v131, s[32:33]
v_pk_mul_f32 v[80:81], v[64:65], v[64:65] op_sel:[0,0] op_sel_hi:[1,0]
v_pk_mul_f32 v[82:83], v[66:67], v[66:67] op_sel:[0,0] op_sel_hi:[1,0]
v_pk_mul_f32 v[84:85], v[68:69], v[68:69] op_sel:[0,0] op_sel_hi:[1,0]
v_pk_mul_f32 v[86:87], v[70:71], v[70:71] op_sel:[0,0] op_sel_hi:[1,0]
v_mfma_f32_16x16x32_bf16 v[112:115], v[88:91], v[104:107], v[112:115]
v_pk_fma_f32 v[72:73], v[64:65], v[64:65], v[80:81] op_sel:[1,1,0] op_sel_hi:[0,1,1] neg_lo:[1,0,0]
v_pk_fma_f32 v[74:75], v[66:67], v[66:67], v[82:83] op_sel:[1,1,0] op_sel_hi:[0,1,1] neg_lo:[1,0,0]
v_pk_fma_f32 v[76:77], v[68:69], v[68:69], v[84:85] op_sel:[1,1,0] op_sel_hi:[0,1,1] neg_lo:[1,0,0]
v_pk_fma_f32 v[78:79], v[70:71], v[70:71], v[86:87] op_sel:[1,1,0] op_sel_hi:[0,1,1] neg_lo:[1,0,0]
v_pk_mul_f32 v[80:81], v[72:73], v[34:35] op_sel:[0,0] op_sel_hi:[1,0] neg_hi:[0,1]
v_pk_mul_f32 v[82:83], v[74:75], v[38:39] op_sel:[0,0] op_sel_hi:[1,0] neg_hi:[0,1]
v_pk_mul_f32 v[84:85], v[76:77], v[42:43] op_sel:[0,0] op_sel_hi:[1,0] neg_hi:[0,1]
v_pk_mul_f32 v[86:87], v[78:79], v[46:47] op_sel:[0,0] op_sel_hi:[1,0] neg_hi:[0,1]
v_pk_fma_f32 v[64:65], v[72:73], v[34:35], v[80:81] op_sel:[1,1,0] op_sel_hi:[0,1,1] neg_lo:[1,0,0] neg_hi:[1,0,0]
v_pk_fma_f32 v[66:67], v[74:75], v[38:39], v[82:83] op_sel:[1,1,0] op_sel_hi:[0,1,1] neg_lo:[1,0,0] neg_hi:[1,0,0]
v_pk_fma_f32 v[68:69], v[76:77], v[42:43], v[84:85] op_sel:[1,1,0] op_sel_hi:[0,1,1] neg_lo:[1,0,0] neg_hi:[1,0,0]
v_pk_fma_f32 v[70:71], v[78:79], v[46:47], v[86:87] op_sel:[1,1,0] op_sel_hi:[0,1,1] neg_lo:[1,0,0] neg_hi:[1,0,0]
v_cvt_pk_bf16_f32 v108, v64, v65
v_cvt_pk_bf16_f32 v109, v66, v67
v_cvt_pk_bf16_f32 v110, v68, v69
v_cvt_pk_bf16_f32 v111, v70, v71
v_pk_mul_f32 v[80:81], v[72:73], v[72:73] op_sel:[0,0] op_sel_hi:[1,0]
v_pk_mul_f32 v[82:83], v[74:75], v[74:75] op_sel:[0,0] op_sel_hi:[1,0]
v_pk_mul_f32 v[84:85], v[76:77], v[76:77] op_sel:[0,0] op_sel_hi:[1,0]
v_pk_mul_f32 v[86:87], v[78:79], v[78:79] op_sel:[0,0] op_sel_hi:[1,0]
v_mfma_f32_16x16x32_bf16 v[116:119], v[92:95], v[108:111], v[116:119]
v_pk_fma_f32 v[64:65], v[72:73], v[72:73], v[80:81] op_sel:[1,1,0] op_sel_hi:[0,1,1] neg_lo:[1,0,0]
v_pk_fma_f32 v[66:67], v[74:75], v[74:75], v[82:83] op_sel:[1,1,0] op_sel_hi:[0,1,1] neg_lo:[1,0,0]
v_pk_fma_f32 v[68:69], v[76:77], v[76:77], v[84:85] op_sel:[1,1,0] op_sel_hi:[0,1,1] neg_lo:[1,0,0]
v_pk_fma_f32 v[70:71], v[78:79], v[78:79], v[86:87] op_sel:[1,1,0] op_sel_hi:[0,1,1] neg_lo:[1,0,0]
v_pk_mul_f32 v[80:81], v[64:65], v[34:35] op_sel:[0,0] op_sel_hi:[1,0] neg_hi:[0,1]
v_pk_mul_f32 v[82:83], v[66:67], v[38:39] op_sel:[0,0] op_sel_hi:[1,0] neg_hi:[0,1]
v_pk_mul_f32 v[84:85], v[68:69], v[42:43] op_sel:[0,0] op_sel_hi:[1,0] neg_hi:[0,1]
v_pk_mul_f32 v[86:87], v[70:71], v[46:47] op_sel:[0,0] op_sel_hi:[1,0] neg_hi:[0,1]
v_pk_fma_f32 v[72:73], v[64:65], v[34:35], v[80:81] op_sel:[1,1,0] op_sel_hi:[0,1,1] neg_lo:[1,0,0] neg_hi:[1,0,0]
v_pk_fma_f32 v[74:75], v[66:67], v[38:39], v[82:83] op_sel:[1,1,0] op_sel_hi:[0,1,1] neg_lo:[1,0,0] neg_hi:[1,0,0]
v_pk_fma_f32 v[76:77], v[68:69], v[42:43], v[84:85] op_sel:[1,1,0] op_sel_hi:[0,1,1] neg_lo:[1,0,0] neg_hi:[1,0,0]
v_pk_fma_f32 v[78:79], v[70:71], v[46:47], v[86:87] op_sel:[1,1,0] op_sel_hi:[0,1,1] neg_lo:[1,0,0] neg_hi:[1,0,0]
v_cvt_pk_bf16_f32 v104, v72, v73
v_cvt_pk_bf16_f32 v105, v74, v75
v_cvt_pk_bf16_f32 v106, v76, v77
v_cvt_pk_bf16_f32 v107, v78, v79
v_pk_mul_f32 v[80:81], v[64:65], v[64:65] op_sel:[0,0] op_sel_hi:[1,0]
v_pk_mul_f32 v[82:83], v[66:67], v[66:67] op_sel:[0,0] op_sel_hi:[1,0]
v_pk_mul_f32 v[84:85], v[68:69], v[68:69] op_sel:[0,0] op_sel_hi:[1,0]
v_pk_mul_f32 v[86:87], v[70:71], v[70:71] op_sel:[0,0] op_sel_hi:[1,0]
v_mfma_f32_16x16x32_bf16 v[120:123], v[96:99], v[104:107], v[120:123]
v_pk_fma_f32 v[72:73], v[64:65], v[64:65], v[80:81] op_sel:[1,1,0] op_sel_hi:[0,1,1] neg_lo:[1,0,0]
v_pk_fma_f32 v[74:75], v[66:67], v[66:67], v[82:83] op_sel:[1,1,0] op_sel_hi:[0,1,1] neg_lo:[1,0,0]
v_pk_fma_f32 v[76:77], v[68:69], v[68:69], v[84:85] op_sel:[1,1,0] op_sel_hi:[0,1,1] neg_lo:[1,0,0]
v_pk_fma_f32 v[78:79], v[70:71], v[70:71], v[86:87] op_sel:[1,1,0] op_sel_hi:[0,1,1] neg_lo:[1,0,0]
v_pk_mul_f32 v[80:81], v[72:73], v[34:35] op_sel:[0,0] op_sel_hi:[1,0] neg_hi:[0,1]
v_pk_mul_f32 v[82:83], v[74:75], v[38:39] op_sel:[0,0] op_sel_hi:[1,0] neg_hi:[0,1]
v_pk_mul_f32 v[84:85], v[76:77], v[42:43] op_sel:[0,0] op_sel_hi:[1,0] neg_hi:[0,1]
v_pk_mul_f32 v[86:87], v[78:79], v[46:47] op_sel:[0,0] op_sel_hi:[1,0] neg_hi:[0,1]
v_pk_fma_f32 v[64:65], v[72:73], v[34:35], v[80:81] op_sel:[1,1,0] op_sel_hi:[0,1,1] neg_lo:[1,0,0] neg_hi:[1,0,0]
v_pk_fma_f32 v[66:67], v[74:75], v[38:39], v[82:83] op_sel:[1,1,0] op_sel_hi:[0,1,1] neg_lo:[1,0,0] neg_hi:[1,0,0]
v_pk_fma_f32 v[68:69], v[76:77], v[42:43], v[84:85] op_sel:[1,1,0] op_sel_hi:[0,1,1] neg_lo:[1,0,0] neg_hi:[1,0,0]
v_pk_fma_f32 v[70:71], v[78:79], v[46:47], v[86:87] op_sel:[1,1,0] op_sel_hi:[0,1,1] neg_lo:[1,0,0] neg_hi:[1,0,0]
v_cvt_pk_bf16_f32 v108, v64, v65
v_cvt_pk_bf16_f32 v109, v66, v67
v_cvt_pk_bf16_f32 v110, v68, v69
v_cvt_pk_bf16_f32 v111, v70, v71
s_nop 1
v_mfma_f32_16x16x32_bf16 v[124:127], v[100:103], v[108:111], v[124:127]
ds_read_b128 v[32:35], v17 offset:512
ds_read_b128 v[36:39], v17 offset:528
ds_read_b128 v[40:43], v17 offset:544
ds_read_b128 v[44:47], v17 offset:560
s_waitcnt lgkmcnt(4)
v_mul_f32 v80, v48, v19
v_mul_f32 v82, v52, v19
v_mul_f32 v84, v56, v19
v_mul_f32 v86, v60, v19
v_mul_f32 v81, v49, v19
v_mul_f32 v83, v53, v19
v_mul_f32 v85, v57, v19
v_mul_f32 v87, v61, v19
v_exp_f32 v132, v80
v_exp_f32 v134, v82
v_exp_f32 v136, v84
v_exp_f32 v138, v86
v_fract_f32 v81, v81
v_fract_f32 v83, v83
v_fract_f32 v85, v85
v_fract_f32 v87, v87
v_cvt_pk_bf16_f32 v128, v50, -v51
v_cvt_pk_bf16_f32 v129, v54, -v55
v_cvt_pk_bf16_f32 v130, v58, -v59
v_cvt_pk_bf16_f32 v131, v62, -v63
v_cos_f32 v72, v81
v_cos_f32 v74, v83
v_cos_f32 v76, v85
v_cos_f32 v78, v87
v_sin_f32 v73, v81
v_sin_f32 v75, v83
v_sin_f32 v77, v85
v_sin_f32 v79, v87
s_nop 0
v_pk_mul_f32 v[64:65], v[72:73], v[132:133] op_sel:[0,0] op_sel_hi:[1,0]
v_pk_mul_f32 v[66:67], v[74:75], v[134:135] op_sel:[0,0] op_sel_hi:[1,0]
v_pk_mul_f32 v[68:69], v[76:77], v[136:137] op_sel:[0,0] op_sel_hi:[1,0]
v_pk_mul_f32 v[70:71], v[78:79], v[138:139] op_sel:[0,0] op_sel_hi:[1,0]
v_cvt_pk_bf16_f32 v88, v64, v65
v_cvt_pk_bf16_f32 v89, v66, v67
v_cvt_pk_bf16_f32 v90, v68, v69
v_cvt_pk_bf16_f32 v91, v70, v71
v_pk_mul_f32 v[80:81], v[64:65], v[64:65] op_sel:[0,0] op_sel_hi:[1,0]
v_pk_mul_f32 v[82:83], v[66:67], v[66:67] op_sel:[0,0] op_sel_hi:[1,0]
v_pk_mul_f32 v[84:85], v[68:69], v[68:69] op_sel:[0,0] op_sel_hi:[1,0]
v_pk_mul_f32 v[86:87], v[70:71], v[70:71] op_sel:[0,0] op_sel_hi:[1,0]
v_pk_fma_f32 v[72:73], v[64:65], v[64:65], v[80:81] op_sel:[1,1,0] op_sel_hi:[0,1,1] neg_lo:[1,0,0]
v_pk_fma_f32 v[74:75], v[66:67], v[66:67], v[82:83] op_sel:[1,1,0] op_sel_hi:[0,1,1] neg_lo:[1,0,0]
v_pk_fma_f32 v[76:77], v[68:69], v[68:69], v[84:85] op_sel:[1,1,0] op_sel_hi:[0,1,1] neg_lo:[1,0,0]
v_pk_fma_f32 v[78:79], v[70:71], v[70:71], v[86:87] op_sel:[1,1,0] op_sel_hi:[0,1,1] neg_lo:[1,0,0]
v_cvt_pk_bf16_f32 v92, v72, v73
v_cvt_pk_bf16_f32 v93, v74, v75
v_cvt_pk_bf16_f32 v94, v76, v77
v_cvt_pk_bf16_f32 v95, v78, v79
v_pk_mul_f32 v[80:81], v[72:73], v[72:73] op_sel:[0,0] op_sel_hi:[1,0]
v_pk_mul_f32 v[82:83], v[74:75], v[74:75] op_sel:[0,0] op_sel_hi:[1,0]
v_pk_mul_f32 v[84:85], v[76:77], v[76:77] op_sel:[0,0] op_sel_hi:[1,0]
v_pk_mul_f32 v[86:87], v[78:79], v[78:79] op_sel:[0,0] op_sel_hi:[1,0]
v_pk_fma_f32 v[64:65], v[72:73], v[72:73], v[80:81] op_sel:[1,1,0] op_sel_hi:[0,1,1] neg_lo:[1,0,0]
v_pk_fma_f32 v[66:67], v[74:75], v[74:75], v[82:83] op_sel:[1,1,0] op_sel_hi:[0,1,1] neg_lo:[1,0,0]
v_pk_fma_f32 v[68:69], v[76:77], v[76:77], v[84:85] op_sel:[1,1,0] op_sel_hi:[0,1,1] neg_lo:[1,0,0]
v_pk_fma_f32 v[70:71], v[78:79], v[78:79], v[86:87] op_sel:[1,1,0] op_sel_hi:[0,1,1] neg_lo:[1,0,0]
v_cvt_pk_bf16_f32 v96, v64, v65
v_cvt_pk_bf16_f32 v97, v66, v67
v_cvt_pk_bf16_f32 v98, v68, v69
v_cvt_pk_bf16_f32 v99, v70, v71
v_pk_mul_f32 v[80:81], v[64:65], v[64:65] op_sel:[0,0] op_sel_hi:[1,0]
v_pk_mul_f32 v[82:83], v[66:67], v[66:67] op_sel:[0,0] op_sel_hi:[1,0]
v_pk_mul_f32 v[84:85], v[68:69], v[68:69] op_sel:[0,0] op_sel_hi:[1,0]
v_pk_mul_f32 v[86:87], v[70:71], v[70:71] op_sel:[0,0] op_sel_hi:[1,0]
v_pk_fma_f32 v[72:73], v[64:65], v[64:65], v[80:81] op_sel:[1,1,0] op_sel_hi:[0,1,1] neg_lo:[1,0,0]
v_pk_fma_f32 v[74:75], v[66:67], v[66:67], v[82:83] op_sel:[1,1,0] op_sel_hi:[0,1,1] neg_lo:[1,0,0]
v_pk_fma_f32 v[76:77], v[68:69], v[68:69], v[84:85] op_sel:[1,1,0] op_sel_hi:[0,1,1] neg_lo:[1,0,0]
v_pk_fma_f32 v[78:79], v[70:71], v[70:71], v[86:87] op_sel:[1,1,0] op_sel_hi:[0,1,1] neg_lo:[1,0,0]
v_cvt_pk_bf16_f32 v100, v72, v73
v_cvt_pk_bf16_f32 v101, v74, v75
v_cvt_pk_bf16_f32 v102, v76, v77
v_cvt_pk_bf16_f32 v103, v78, v79
v_pk_mul_f32 v[80:81], v[72:73], v[72:73] op_sel:[0,0] op_sel_hi:[1,0]
v_pk_mul_f32 v[82:83], v[74:75], v[74:75] op_sel:[0,0] op_sel_hi:[1,0]
v_pk_mul_f32 v[84:85], v[76:77], v[76:77] op_sel:[0,0] op_sel_hi:[1,0]
v_pk_mul_f32 v[86:87], v[78:79], v[78:79] op_sel:[0,0] op_sel_hi:[1,0]
v_pk_fma_f32 v[64:65], v[72:73], v[72:73], v[80:81] op_sel:[1,1,0] op_sel_hi:[0,1,1] neg_lo:[1,0,0]
v_pk_fma_f32 v[66:67], v[74:75], v[74:75], v[82:83] op_sel:[1,1,0] op_sel_hi:[0,1,1] neg_lo:[1,0,0]
v_pk_fma_f32 v[68:69], v[76:77], v[76:77], v[84:85] op_sel:[1,1,0] op_sel_hi:[0,1,1] neg_lo:[1,0,0]
v_pk_fma_f32 v[70:71], v[78:79], v[78:79], v[86:87] op_sel:[1,1,0] op_sel_hi:[0,1,1] neg_lo:[1,0,0]
v_pk_mul_f32 v[80:81], v[64:65], v[50:51] op_sel:[0,0] op_sel_hi:[1,0] neg_hi:[0,1]
v_pk_mul_f32 v[82:83], v[66:67], v[54:55] op_sel:[0,0] op_sel_hi:[1,0] neg_hi:[0,1]
v_pk_mul_f32 v[84:85], v[68:69], v[58:59] op_sel:[0,0] op_sel_hi:[1,0] neg_hi:[0,1]
v_pk_mul_f32 v[86:87], v[70:71], v[62:63] op_sel:[0,0] op_sel_hi:[1,0] neg_hi:[0,1]
v_pk_fma_f32 v[72:73], v[64:65], v[50:51], v[80:81] op_sel:[1,1,0] op_sel_hi:[0,1,1] neg_lo:[1,0,0] neg_hi:[1,0,0]
v_pk_fma_f32 v[74:75], v[66:67], v[54:55], v[82:83] op_sel:[1,1,0] op_sel_hi:[0,1,1] neg_lo:[1,0,0] neg_hi:[1,0,0]
v_pk_fma_f32 v[76:77], v[68:69], v[58:59], v[84:85] op_sel:[1,1,0] op_sel_hi:[0,1,1] neg_lo:[1,0,0] neg_hi:[1,0,0]
v_pk_fma_f32 v[78:79], v[70:71], v[62:63], v[86:87] op_sel:[1,1,0] op_sel_hi:[0,1,1] neg_lo:[1,0,0] neg_hi:[1,0,0]
v_cvt_pk_bf16_f32 v104, v72, v73
v_cvt_pk_bf16_f32 v105, v74, v75
v_cvt_pk_bf16_f32 v106, v76, v77
v_cvt_pk_bf16_f32 v107, v78, v79
v_cndmask_b32 v104, v104, v128, s[32:33]
v_cndmask_b32 v105, v105, v129, s[32:33]
v_cndmask_b32 v106, v106, v130, s[32:33]
v_cndmask_b32 v107, v107, v131, s[32:33]
v_pk_mul_f32 v[80:81], v[64:65], v[64:65] op_sel:[0,0] op_sel_hi:[1,0]
v_pk_mul_f32 v[82:83], v[66:67], v[66:67] op_sel:[0,0] op_sel_hi:[1,0]
v_pk_mul_f32 v[84:85], v[68:69], v[68:69] op_sel:[0,0] op_sel_hi:[1,0]
v_pk_mul_f32 v[86:87], v[70:71], v[70:71] op_sel:[0,0] op_sel_hi:[1,0]
v_mfma_f32_16x16x32_bf16 v[112:115], v[88:91], v[104:107], v[112:115]
v_pk_fma_f32 v[72:73], v[64:65], v[64:65], v[80:81] op_sel:[1,1,0] op_sel_hi:[0,1,1] neg_lo:[1,0,0]
v_pk_fma_f32 v[74:75], v[66:67], v[66:67], v[82:83] op_sel:[1,1,0] op_sel_hi:[0,1,1] neg_lo:[1,0,0]
v_pk_fma_f32 v[76:77], v[68:69], v[68:69], v[84:85] op_sel:[1,1,0] op_sel_hi:[0,1,1] neg_lo:[1,0,0]
v_pk_fma_f32 v[78:79], v[70:71], v[70:71], v[86:87] op_sel:[1,1,0] op_sel_hi:[0,1,1] neg_lo:[1,0,0]
v_pk_mul_f32 v[80:81], v[72:73], v[50:51] op_sel:[0,0] op_sel_hi:[1,0] neg_hi:[0,1]
v_pk_mul_f32 v[82:83], v[74:75], v[54:55] op_sel:[0,0] op_sel_hi:[1,0] neg_hi:[0,1]
v_pk_mul_f32 v[84:85], v[76:77], v[58:59] op_sel:[0,0] op_sel_hi:[1,0] neg_hi:[0,1]
v_pk_mul_f32 v[86:87], v[78:79], v[62:63] op_sel:[0,0] op_sel_hi:[1,0] neg_hi:[0,1]
v_pk_fma_f32 v[64:65], v[72:73], v[50:51], v[80:81] op_sel:[1,1,0] op_sel_hi:[0,1,1] neg_lo:[1,0,0] neg_hi:[1,0,0]
v_pk_fma_f32 v[66:67], v[74:75], v[54:55], v[82:83] op_sel:[1,1,0] op_sel_hi:[0,1,1] neg_lo:[1,0,0] neg_hi:[1,0,0]
v_pk_fma_f32 v[68:69], v[76:77], v[58:59], v[84:85] op_sel:[1,1,0] op_sel_hi:[0,1,1] neg_lo:[1,0,0] neg_hi:[1,0,0]
v_pk_fma_f32 v[70:71], v[78:79], v[62:63], v[86:87] op_sel:[1,1,0] op_sel_hi:[0,1,1] neg_lo:[1,0,0] neg_hi:[1,0,0]
v_cvt_pk_bf16_f32 v108, v64, v65
v_cvt_pk_bf16_f32 v109, v66, v67
v_cvt_pk_bf16_f32 v110, v68, v69
v_cvt_pk_bf16_f32 v111, v70, v71
v_pk_mul_f32 v[80:81], v[72:73], v[72:73] op_sel:[0,0] op_sel_hi:[1,0]
v_pk_mul_f32 v[82:83], v[74:75], v[74:75] op_sel:[0,0] op_sel_hi:[1,0]
v_pk_mul_f32 v[84:85], v[76:77], v[76:77] op_sel:[0,0] op_sel_hi:[1,0]
v_pk_mul_f32 v[86:87], v[78:79], v[78:79] op_sel:[0,0] op_sel_hi:[1,0]
v_mfma_f32_16x16x32_bf16 v[116:119], v[92:95], v[108:111], v[116:119]
v_pk_fma_f32 v[64:65], v[72:73], v[72:73], v[80:81] op_sel:[1,1,0] op_sel_hi:[0,1,1] neg_lo:[1,0,0]
v_pk_fma_f32 v[66:67], v[74:75], v[74:75], v[82:83] op_sel:[1,1,0] op_sel_hi:[0,1,1] neg_lo:[1,0,0]
v_pk_fma_f32 v[68:69], v[76:77], v[76:77], v[84:85] op_sel:[1,1,0] op_sel_hi:[0,1,1] neg_lo:[1,0,0]
v_pk_fma_f32 v[70:71], v[78:79], v[78:79], v[86:87] op_sel:[1,1,0] op_sel_hi:[0,1,1] neg_lo:[1,0,0]
v_pk_mul_f32 v[80:81], v[64:65], v[50:51] op_sel:[0,0] op_sel_hi:[1,0] neg_hi:[0,1]
v_pk_mul_f32 v[82:83], v[66:67], v[54:55] op_sel:[0,0] op_sel_hi:[1,0] neg_hi:[0,1]
v_pk_mul_f32 v[84:85], v[68:69], v[58:59] op_sel:[0,0] op_sel_hi:[1,0] neg_hi:[0,1]
v_pk_mul_f32 v[86:87], v[70:71], v[62:63] op_sel:[0,0] op_sel_hi:[1,0] neg_hi:[0,1]
v_pk_fma_f32 v[72:73], v[64:65], v[50:51], v[80:81] op_sel:[1,1,0] op_sel_hi:[0,1,1] neg_lo:[1,0,0] neg_hi:[1,0,0]
v_pk_fma_f32 v[74:75], v[66:67], v[54:55], v[82:83] op_sel:[1,1,0] op_sel_hi:[0,1,1] neg_lo:[1,0,0] neg_hi:[1,0,0]
v_pk_fma_f32 v[76:77], v[68:69], v[58:59], v[84:85] op_sel:[1,1,0] op_sel_hi:[0,1,1] neg_lo:[1,0,0] neg_hi:[1,0,0]
v_pk_fma_f32 v[78:79], v[70:71], v[62:63], v[86:87] op_sel:[1,1,0] op_sel_hi:[0,1,1] neg_lo:[1,0,0] neg_hi:[1,0,0]
v_cvt_pk_bf16_f32 v104, v72, v73
v_cvt_pk_bf16_f32 v105, v74, v75
v_cvt_pk_bf16_f32 v106, v76, v77
v_cvt_pk_bf16_f32 v107, v78, v79
v_pk_mul_f32 v[80:81], v[64:65], v[64:65] op_sel:[0,0] op_sel_hi:[1,0]
v_pk_mul_f32 v[82:83], v[66:67], v[66:67] op_sel:[0,0] op_sel_hi:[1,0]
v_pk_mul_f32 v[84:85], v[68:69], v[68:69] op_sel:[0,0] op_sel_hi:[1,0]
v_pk_mul_f32 v[86:87], v[70:71], v[70:71] op_sel:[0,0] op_sel_hi:[1,0]
v_mfma_f32_16x16x32_bf16 v[120:123], v[96:99], v[104:107], v[120:123]
v_pk_fma_f32 v[72:73], v[64:65], v[64:65], v[80:81] op_sel:[1,1,0] op_sel_hi:[0,1,1] neg_lo:[1,0,0]
v_pk_fma_f32 v[74:75], v[66:67], v[66:67], v[82:83] op_sel:[1,1,0] op_sel_hi:[0,1,1] neg_lo:[1,0,0]
v_pk_fma_f32 v[76:77], v[68:69], v[68:69], v[84:85] op_sel:[1,1,0] op_sel_hi:[0,1,1] neg_lo:[1,0,0]
v_pk_fma_f32 v[78:79], v[70:71], v[70:71], v[86:87] op_sel:[1,1,0] op_sel_hi:[0,1,1] neg_lo:[1,0,0]
v_pk_mul_f32 v[80:81], v[72:73], v[50:51] op_sel:[0,0] op_sel_hi:[1,0] neg_hi:[0,1]
v_pk_mul_f32 v[82:83], v[74:75], v[54:55] op_sel:[0,0] op_sel_hi:[1,0] neg_hi:[0,1]
v_pk_mul_f32 v[84:85], v[76:77], v[58:59] op_sel:[0,0] op_sel_hi:[1,0] neg_hi:[0,1]
v_pk_mul_f32 v[86:87], v[78:79], v[62:63] op_sel:[0,0] op_sel_hi:[1,0] neg_hi:[0,1]
v_pk_fma_f32 v[64:65], v[72:73], v[50:51], v[80:81] op_sel:[1,1,0] op_sel_hi:[0,1,1] neg_lo:[1,0,0] neg_hi:[1,0,0]
v_pk_fma_f32 v[66:67], v[74:75], v[54:55], v[82:83] op_sel:[1,1,0] op_sel_hi:[0,1,1] neg_lo:[1,0,0] neg_hi:[1,0,0]
v_pk_fma_f32 v[68:69], v[76:77], v[58:59], v[84:85] op_sel:[1,1,0] op_sel_hi:[0,1,1] neg_lo:[1,0,0] neg_hi:[1,0,0]
v_pk_fma_f32 v[70:71], v[78:79], v[62:63], v[86:87] op_sel:[1,1,0] op_sel_hi:[0,1,1] neg_lo:[1,0,0] neg_hi:[1,0,0]
v_cvt_pk_bf16_f32 v108, v64, v65
v_cvt_pk_bf16_f32 v109, v66, v67
v_cvt_pk_bf16_f32 v110, v68, v69
v_cvt_pk_bf16_f32 v111, v70, v71
s_nop 1
v_mfma_f32_16x16x32_bf16 v[124:127], v[100:103], v[108:111], v[124:127]
ds_read_b128 v[48:51], v17 offset:768
ds_read_b128 v[52:55], v17 offset:784
ds_read_b128 v[56:59], v17 offset:800
ds_read_b128 v[60:63], v17 offset:816
s_waitcnt lgkmcnt(4)
v_mul_f32 v80, v32, v19
v_mul_f32 v82, v36, v19
v_mul_f32 v84, v40, v19
v_mul_f32 v86, v44, v19
v_mul_f32 v81, v33, v19
v_mul_f32 v83, v37, v19
v_mul_f32 v85, v41, v19
v_mul_f32 v87, v45, v19
v_exp_f32 v132, v80
v_exp_f32 v134, v82
v_exp_f32 v136, v84
v_exp_f32 v138, v86
v_fract_f32 v81, v81
v_fract_f32 v83, v83
v_fract_f32 v85, v85
v_fract_f32 v87, v87
v_cvt_pk_bf16_f32 v128, v34, -v35
v_cvt_pk_bf16_f32 v129, v38, -v39
v_cvt_pk_bf16_f32 v130, v42, -v43
v_cvt_pk_bf16_f32 v131, v46, -v47
v_cos_f32 v72, v81
v_cos_f32 v74, v83
v_cos_f32 v76, v85
v_cos_f32 v78, v87
v_sin_f32 v73, v81
v_sin_f32 v75, v83
v_sin_f32 v77, v85
v_sin_f32 v79, v87
s_nop 0
v_pk_mul_f32 v[64:65], v[72:73], v[132:133] op_sel:[0,0] op_sel_hi:[1,0]
v_pk_mul_f32 v[66:67], v[74:75], v[134:135] op_sel:[0,0] op_sel_hi:[1,0]
v_pk_mul_f32 v[68:69], v[76:77], v[136:137] op_sel:[0,0] op_sel_hi:[1,0]
v_pk_mul_f32 v[70:71], v[78:79], v[138:139] op_sel:[0,0] op_sel_hi:[1,0]
v_cvt_pk_bf16_f32 v88, v64, v65
v_cvt_pk_bf16_f32 v89, v66, v67
v_cvt_pk_bf16_f32 v90, v68, v69
v_cvt_pk_bf16_f32 v91, v70, v71
v_pk_mul_f32 v[80:81], v[64:65], v[64:65] op_sel:[0,0] op_sel_hi:[1,0]
v_pk_mul_f32 v[82:83], v[66:67], v[66:67] op_sel:[0,0] op_sel_hi:[1,0]
v_pk_mul_f32 v[84:85], v[68:69], v[68:69] op_sel:[0,0] op_sel_hi:[1,0]
v_pk_mul_f32 v[86:87], v[70:71], v[70:71] op_sel:[0,0] op_sel_hi:[1,0]
v_pk_fma_f32 v[72:73], v[64:65], v[64:65], v[80:81] op_sel:[1,1,0] op_sel_hi:[0,1,1] neg_lo:[1,0,0]
v_pk_fma_f32 v[74:75], v[66:67], v[66:67], v[82:83] op_sel:[1,1,0] op_sel_hi:[0,1,1] neg_lo:[1,0,0]
v_pk_fma_f32 v[76:77], v[68:69], v[68:69], v[84:85] op_sel:[1,1,0] op_sel_hi:[0,1,1] neg_lo:[1,0,0]
v_pk_fma_f32 v[78:79], v[70:71], v[70:71], v[86:87] op_sel:[1,1,0] op_sel_hi:[0,1,1] neg_lo:[1,0,0]
v_cvt_pk_bf16_f32 v92, v72, v73
v_cvt_pk_bf16_f32 v93, v74, v75
v_cvt_pk_bf16_f32 v94, v76, v77
v_cvt_pk_bf16_f32 v95, v78, v79
v_pk_mul_f32 v[80:81], v[72:73], v[72:73] op_sel:[0,0] op_sel_hi:[1,0]
v_pk_mul_f32 v[82:83], v[74:75], v[74:75] op_sel:[0,0] op_sel_hi:[1,0]
v_pk_mul_f32 v[84:85], v[76:77], v[76:77] op_sel:[0,0] op_sel_hi:[1,0]
v_pk_mul_f32 v[86:87], v[78:79], v[78:79] op_sel:[0,0] op_sel_hi:[1,0]
v_pk_fma_f32 v[64:65], v[72:73], v[72:73], v[80:81] op_sel:[1,1,0] op_sel_hi:[0,1,1] neg_lo:[1,0,0]
v_pk_fma_f32 v[66:67], v[74:75], v[74:75], v[82:83] op_sel:[1,1,0] op_sel_hi:[0,1,1] neg_lo:[1,0,0]
v_pk_fma_f32 v[68:69], v[76:77], v[76:77], v[84:85] op_sel:[1,1,0] op_sel_hi:[0,1,1] neg_lo:[1,0,0]
v_pk_fma_f32 v[70:71], v[78:79], v[78:79], v[86:87] op_sel:[1,1,0] op_sel_hi:[0,1,1] neg_lo:[1,0,0]
v_cvt_pk_bf16_f32 v96, v64, v65
v_cvt_pk_bf16_f32 v97, v66, v67
v_cvt_pk_bf16_f32 v98, v68, v69
v_cvt_pk_bf16_f32 v99, v70, v71
v_pk_mul_f32 v[80:81], v[64:65], v[64:65] op_sel:[0,0] op_sel_hi:[1,0]
v_pk_mul_f32 v[82:83], v[66:67], v[66:67] op_sel:[0,0] op_sel_hi:[1,0]
v_pk_mul_f32 v[84:85], v[68:69], v[68:69] op_sel:[0,0] op_sel_hi:[1,0]
v_pk_mul_f32 v[86:87], v[70:71], v[70:71] op_sel:[0,0] op_sel_hi:[1,0]
v_pk_fma_f32 v[72:73], v[64:65], v[64:65], v[80:81] op_sel:[1,1,0] op_sel_hi:[0,1,1] neg_lo:[1,0,0]
v_pk_fma_f32 v[74:75], v[66:67], v[66:67], v[82:83] op_sel:[1,1,0] op_sel_hi:[0,1,1] neg_lo:[1,0,0]
v_pk_fma_f32 v[76:77], v[68:69], v[68:69], v[84:85] op_sel:[1,1,0] op_sel_hi:[0,1,1] neg_lo:[1,0,0]
v_pk_fma_f32 v[78:79], v[70:71], v[70:71], v[86:87] op_sel:[1,1,0] op_sel_hi:[0,1,1] neg_lo:[1,0,0]
v_cvt_pk_bf16_f32 v100, v72, v73
v_cvt_pk_bf16_f32 v101, v74, v75
v_cvt_pk_bf16_f32 v102, v76, v77
v_cvt_pk_bf16_f32 v103, v78, v79
v_pk_mul_f32 v[80:81], v[72:73], v[72:73] op_sel:[0,0] op_sel_hi:[1,0]
v_pk_mul_f32 v[82:83], v[74:75], v[74:75] op_sel:[0,0] op_sel_hi:[1,0]
v_pk_mul_f32 v[84:85], v[76:77], v[76:77] op_sel:[0,0] op_sel_hi:[1,0]
v_pk_mul_f32 v[86:87], v[78:79], v[78:79] op_sel:[0,0] op_sel_hi:[1,0]
v_pk_fma_f32 v[64:65], v[72:73], v[72:73], v[80:81] op_sel:[1,1,0] op_sel_hi:[0,1,1] neg_lo:[1,0,0]
v_pk_fma_f32 v[66:67], v[74:75], v[74:75], v[82:83] op_sel:[1,1,0] op_sel_hi:[0,1,1] neg_lo:[1,0,0]
v_pk_fma_f32 v[68:69], v[76:77], v[76:77], v[84:85] op_sel:[1,1,0] op_sel_hi:[0,1,1] neg_lo:[1,0,0]
v_pk_fma_f32 v[70:71], v[78:79], v[78:79], v[86:87] op_sel:[1,1,0] op_sel_hi:[0,1,1] neg_lo:[1,0,0]
v_pk_mul_f32 v[80:81], v[64:65], v[34:35] op_sel:[0,0] op_sel_hi:[1,0] neg_hi:[0,1]
v_pk_mul_f32 v[82:83], v[66:67], v[38:39] op_sel:[0,0] op_sel_hi:[1,0] neg_hi:[0,1]
v_pk_mul_f32 v[84:85], v[68:69], v[42:43] op_sel:[0,0] op_sel_hi:[1,0] neg_hi:[0,1]
v_pk_mul_f32 v[86:87], v[70:71], v[46:47] op_sel:[0,0] op_sel_hi:[1,0] neg_hi:[0,1]
v_pk_fma_f32 v[72:73], v[64:65], v[34:35], v[80:81] op_sel:[1,1,0] op_sel_hi:[0,1,1] neg_lo:[1,0,0] neg_hi:[1,0,0]
v_pk_fma_f32 v[74:75], v[66:67], v[38:39], v[82:83] op_sel:[1,1,0] op_sel_hi:[0,1,1] neg_lo:[1,0,0] neg_hi:[1,0,0]
v_pk_fma_f32 v[76:77], v[68:69], v[42:43], v[84:85] op_sel:[1,1,0] op_sel_hi:[0,1,1] neg_lo:[1,0,0] neg_hi:[1,0,0]
v_pk_fma_f32 v[78:79], v[70:71], v[46:47], v[86:87] op_sel:[1,1,0] op_sel_hi:[0,1,1] neg_lo:[1,0,0] neg_hi:[1,0,0]
v_cvt_pk_bf16_f32 v104, v72, v73
v_cvt_pk_bf16_f32 v105, v74, v75
v_cvt_pk_bf16_f32 v106, v76, v77
v_cvt_pk_bf16_f32 v107, v78, v79
v_cndmask_b32 v104, v104, v128, s[32:33]
v_cndmask_b32 v105, v105, v129, s[32:33]
v_cndmask_b32 v106, v106, v130, s[32:33]
v_cndmask_b32 v107, v107, v131, s[32:33]
v_pk_mul_f32 v[80:81], v[64:65], v[64:65] op_sel:[0,0] op_sel_hi:[1,0]
v_pk_mul_f32 v[82:83], v[66:67], v[66:67] op_sel:[0,0] op_sel_hi:[1,0]
v_pk_mul_f32 v[84:85], v[68:69], v[68:69] op_sel:[0,0] op_sel_hi:[1,0]
v_pk_mul_f32 v[86:87], v[70:71], v[70:71] op_sel:[0,0] op_sel_hi:[1,0]
v_mfma_f32_16x16x32_bf16 v[112:115], v[88:91], v[104:107], v[112:115]
v_pk_fma_f32 v[72:73], v[64:65], v[64:65], v[80:81] op_sel:[1,1,0] op_sel_hi:[0,1,1] neg_lo:[1,0,0]
v_pk_fma_f32 v[74:75], v[66:67], v[66:67], v[82:83] op_sel:[1,1,0] op_sel_hi:[0,1,1] neg_lo:[1,0,0]
v_pk_fma_f32 v[76:77], v[68:69], v[68:69], v[84:85] op_sel:[1,1,0] op_sel_hi:[0,1,1] neg_lo:[1,0,0]
v_pk_fma_f32 v[78:79], v[70:71], v[70:71], v[86:87] op_sel:[1,1,0] op_sel_hi:[0,1,1] neg_lo:[1,0,0]
v_pk_mul_f32 v[80:81], v[72:73], v[34:35] op_sel:[0,0] op_sel_hi:[1,0] neg_hi:[0,1]
v_pk_mul_f32 v[82:83], v[74:75], v[38:39] op_sel:[0,0] op_sel_hi:[1,0] neg_hi:[0,1]
v_pk_mul_f32 v[84:85], v[76:77], v[42:43] op_sel:[0,0] op_sel_hi:[1,0] neg_hi:[0,1]
v_pk_mul_f32 v[86:87], v[78:79], v[46:47] op_sel:[0,0] op_sel_hi:[1,0] neg_hi:[0,1]
v_pk_fma_f32 v[64:65], v[72:73], v[34:35], v[80:81] op_sel:[1,1,0] op_sel_hi:[0,1,1] neg_lo:[1,0,0] neg_hi:[1,0,0]
v_pk_fma_f32 v[66:67], v[74:75], v[38:39], v[82:83] op_sel:[1,1,0] op_sel_hi:[0,1,1] neg_lo:[1,0,0] neg_hi:[1,0,0]
v_pk_fma_f32 v[68:69], v[76:77], v[42:43], v[84:85] op_sel:[1,1,0] op_sel_hi:[0,1,1] neg_lo:[1,0,0] neg_hi:[1,0,0]
v_pk_fma_f32 v[70:71], v[78:79], v[46:47], v[86:87] op_sel:[1,1,0] op_sel_hi:[0,1,1] neg_lo:[1,0,0] neg_hi:[1,0,0]
v_cvt_pk_bf16_f32 v108, v64, v65
v_cvt_pk_bf16_f32 v109, v66, v67
v_cvt_pk_bf16_f32 v110, v68, v69
v_cvt_pk_bf16_f32 v111, v70, v71
v_pk_mul_f32 v[80:81], v[72:73], v[72:73] op_sel:[0,0] op_sel_hi:[1,0]
v_pk_mul_f32 v[82:83], v[74:75], v[74:75] op_sel:[0,0] op_sel_hi:[1,0]
v_pk_mul_f32 v[84:85], v[76:77], v[76:77] op_sel:[0,0] op_sel_hi:[1,0]
v_pk_mul_f32 v[86:87], v[78:79], v[78:79] op_sel:[0,0] op_sel_hi:[1,0]
v_mfma_f32_16x16x32_bf16 v[116:119], v[92:95], v[108:111], v[116:119]
v_pk_fma_f32 v[64:65], v[72:73], v[72:73], v[80:81] op_sel:[1,1,0] op_sel_hi:[0,1,1] neg_lo:[1,0,0]
v_pk_fma_f32 v[66:67], v[74:75], v[74:75], v[82:83] op_sel:[1,1,0] op_sel_hi:[0,1,1] neg_lo:[1,0,0]
v_pk_fma_f32 v[68:69], v[76:77], v[76:77], v[84:85] op_sel:[1,1,0] op_sel_hi:[0,1,1] neg_lo:[1,0,0]
v_pk_fma_f32 v[70:71], v[78:79], v[78:79], v[86:87] op_sel:[1,1,0] op_sel_hi:[0,1,1] neg_lo:[1,0,0]
v_pk_mul_f32 v[80:81], v[64:65], v[34:35] op_sel:[0,0] op_sel_hi:[1,0] neg_hi:[0,1]
v_pk_mul_f32 v[82:83], v[66:67], v[38:39] op_sel:[0,0] op_sel_hi:[1,0] neg_hi:[0,1]
v_pk_mul_f32 v[84:85], v[68:69], v[42:43] op_sel:[0,0] op_sel_hi:[1,0] neg_hi:[0,1]
v_pk_mul_f32 v[86:87], v[70:71], v[46:47] op_sel:[0,0] op_sel_hi:[1,0] neg_hi:[0,1]
v_pk_fma_f32 v[72:73], v[64:65], v[34:35], v[80:81] op_sel:[1,1,0] op_sel_hi:[0,1,1] neg_lo:[1,0,0] neg_hi:[1,0,0]
v_pk_fma_f32 v[74:75], v[66:67], v[38:39], v[82:83] op_sel:[1,1,0] op_sel_hi:[0,1,1] neg_lo:[1,0,0] neg_hi:[1,0,0]
v_pk_fma_f32 v[76:77], v[68:69], v[42:43], v[84:85] op_sel:[1,1,0] op_sel_hi:[0,1,1] neg_lo:[1,0,0] neg_hi:[1,0,0]
v_pk_fma_f32 v[78:79], v[70:71], v[46:47], v[86:87] op_sel:[1,1,0] op_sel_hi:[0,1,1] neg_lo:[1,0,0] neg_hi:[1,0,0]
v_cvt_pk_bf16_f32 v104, v72, v73
v_cvt_pk_bf16_f32 v105, v74, v75
v_cvt_pk_bf16_f32 v106, v76, v77
v_cvt_pk_bf16_f32 v107, v78, v79
v_pk_mul_f32 v[80:81], v[64:65], v[64:65] op_sel:[0,0] op_sel_hi:[1,0]
v_pk_mul_f32 v[82:83], v[66:67], v[66:67] op_sel:[0,0] op_sel_hi:[1,0]
v_pk_mul_f32 v[84:85], v[68:69], v[68:69] op_sel:[0,0] op_sel_hi:[1,0]
v_pk_mul_f32 v[86:87], v[70:71], v[70:71] op_sel:[0,0] op_sel_hi:[1,0]
v_mfma_f32_16x16x32_bf16 v[120:123], v[96:99], v[104:107], v[120:123]
v_pk_fma_f32 v[72:73], v[64:65], v[64:65], v[80:81] op_sel:[1,1,0] op_sel_hi:[0,1,1] neg_lo:[1,0,0]
v_pk_fma_f32 v[74:75], v[66:67], v[66:67], v[82:83] op_sel:[1,1,0] op_sel_hi:[0,1,1] neg_lo:[1,0,0]
v_pk_fma_f32 v[76:77], v[68:69], v[68:69], v[84:85] op_sel:[1,1,0] op_sel_hi:[0,1,1] neg_lo:[1,0,0]
v_pk_fma_f32 v[78:79], v[70:71], v[70:71], v[86:87] op_sel:[1,1,0] op_sel_hi:[0,1,1] neg_lo:[1,0,0]
v_pk_mul_f32 v[80:81], v[72:73], v[34:35] op_sel:[0,0] op_sel_hi:[1,0] neg_hi:[0,1]
v_pk_mul_f32 v[82:83], v[74:75], v[38:39] op_sel:[0,0] op_sel_hi:[1,0] neg_hi:[0,1]
v_pk_mul_f32 v[84:85], v[76:77], v[42:43] op_sel:[0,0] op_sel_hi:[1,0] neg_hi:[0,1]
v_pk_mul_f32 v[86:87], v[78:79], v[46:47] op_sel:[0,0] op_sel_hi:[1,0] neg_hi:[0,1]
v_pk_fma_f32 v[64:65], v[72:73], v[34:35], v[80:81] op_sel:[1,1,0] op_sel_hi:[0,1,1] neg_lo:[1,0,0] neg_hi:[1,0,0]
v_pk_fma_f32 v[66:67], v[74:75], v[38:39], v[82:83] op_sel:[1,1,0] op_sel_hi:[0,1,1] neg_lo:[1,0,0] neg_hi:[1,0,0]
v_pk_fma_f32 v[68:69], v[76:77], v[42:43], v[84:85] op_sel:[1,1,0] op_sel_hi:[0,1,1] neg_lo:[1,0,0] neg_hi:[1,0,0]
v_pk_fma_f32 v[70:71], v[78:79], v[46:47], v[86:87] op_sel:[1,1,0] op_sel_hi:[0,1,1] neg_lo:[1,0,0] neg_hi:[1,0,0]
v_cvt_pk_bf16_f32 v108, v64, v65
v_cvt_pk_bf16_f32 v109, v66, v67
v_cvt_pk_bf16_f32 v110, v68, v69
v_cvt_pk_bf16_f32 v111, v70, v71
s_nop 1
v_mfma_f32_16x16x32_bf16 v[124:127], v[100:103], v[108:111], v[124:127]
s_waitcnt lgkmcnt(0)
v_mul_f32 v80, v48, v19
v_mul_f32 v82, v52, v19
v_mul_f32 v84, v56, v19
v_mul_f32 v86, v60, v19
v_mul_f32 v81, v49, v19
v_mul_f32 v83, v53, v19
v_mul_f32 v85, v57, v19
v_mul_f32 v87, v61, v19
v_exp_f32 v132, v80
v_exp_f32 v134, v82
v_exp_f32 v136, v84
v_exp_f32 v138, v86
v_fract_f32 v81, v81
v_fract_f32 v83, v83
v_fract_f32 v85, v85
v_fract_f32 v87, v87
v_cvt_pk_bf16_f32 v128, v50, -v51
v_cvt_pk_bf16_f32 v129, v54, -v55
v_cvt_pk_bf16_f32 v130, v58, -v59
v_cvt_pk_bf16_f32 v131, v62, -v63
v_cos_f32 v72, v81
v_cos_f32 v74, v83
v_cos_f32 v76, v85
v_cos_f32 v78, v87
v_sin_f32 v73, v81
v_sin_f32 v75, v83
v_sin_f32 v77, v85
v_sin_f32 v79, v87
s_nop 0
v_pk_mul_f32 v[64:65], v[72:73], v[132:133] op_sel:[0,0] op_sel_hi:[1,0]
v_pk_mul_f32 v[66:67], v[74:75], v[134:135] op_sel:[0,0] op_sel_hi:[1,0]
v_pk_mul_f32 v[68:69], v[76:77], v[136:137] op_sel:[0,0] op_sel_hi:[1,0]
v_pk_mul_f32 v[70:71], v[78:79], v[138:139] op_sel:[0,0] op_sel_hi:[1,0]
v_cvt_pk_bf16_f32 v88, v64, v65
v_cvt_pk_bf16_f32 v89, v66, v67
v_cvt_pk_bf16_f32 v90, v68, v69
v_cvt_pk_bf16_f32 v91, v70, v71
v_pk_mul_f32 v[80:81], v[64:65], v[64:65] op_sel:[0,0] op_sel_hi:[1,0]
v_pk_mul_f32 v[82:83], v[66:67], v[66:67] op_sel:[0,0] op_sel_hi:[1,0]
v_pk_mul_f32 v[84:85], v[68:69], v[68:69] op_sel:[0,0] op_sel_hi:[1,0]
v_pk_mul_f32 v[86:87], v[70:71], v[70:71] op_sel:[0,0] op_sel_hi:[1,0]
v_pk_fma_f32 v[72:73], v[64:65], v[64:65], v[80:81] op_sel:[1,1,0] op_sel_hi:[0,1,1] neg_lo:[1,0,0]
v_pk_fma_f32 v[74:75], v[66:67], v[66:67], v[82:83] op_sel:[1,1,0] op_sel_hi:[0,1,1] neg_lo:[1,0,0]
v_pk_fma_f32 v[76:77], v[68:69], v[68:69], v[84:85] op_sel:[1,1,0] op_sel_hi:[0,1,1] neg_lo:[1,0,0]
v_pk_fma_f32 v[78:79], v[70:71], v[70:71], v[86:87] op_sel:[1,1,0] op_sel_hi:[0,1,1] neg_lo:[1,0,0]
v_cvt_pk_bf16_f32 v92, v72, v73
v_cvt_pk_bf16_f32 v93, v74, v75
v_cvt_pk_bf16_f32 v94, v76, v77
v_cvt_pk_bf16_f32 v95, v78, v79
v_pk_mul_f32 v[80:81], v[72:73], v[72:73] op_sel:[0,0] op_sel_hi:[1,0]
v_pk_mul_f32 v[82:83], v[74:75], v[74:75] op_sel:[0,0] op_sel_hi:[1,0]
v_pk_mul_f32 v[84:85], v[76:77], v[76:77] op_sel:[0,0] op_sel_hi:[1,0]
v_pk_mul_f32 v[86:87], v[78:79], v[78:79] op_sel:[0,0] op_sel_hi:[1,0]
v_pk_fma_f32 v[64:65], v[72:73], v[72:73], v[80:81] op_sel:[1,1,0] op_sel_hi:[0,1,1] neg_lo:[1,0,0]
v_pk_fma_f32 v[66:67], v[74:75], v[74:75], v[82:83] op_sel:[1,1,0] op_sel_hi:[0,1,1] neg_lo:[1,0,0]
v_pk_fma_f32 v[68:69], v[76:77], v[76:77], v[84:85] op_sel:[1,1,0] op_sel_hi:[0,1,1] neg_lo:[1,0,0]
v_pk_fma_f32 v[70:71], v[78:79], v[78:79], v[86:87] op_sel:[1,1,0] op_sel_hi:[0,1,1] neg_lo:[1,0,0]
v_cvt_pk_bf16_f32 v96, v64, v65
v_cvt_pk_bf16_f32 v97, v66, v67
v_cvt_pk_bf16_f32 v98, v68, v69
v_cvt_pk_bf16_f32 v99, v70, v71
v_pk_mul_f32 v[80:81], v[64:65], v[64:65] op_sel:[0,0] op_sel_hi:[1,0]
v_pk_mul_f32 v[82:83], v[66:67], v[66:67] op_sel:[0,0] op_sel_hi:[1,0]
v_pk_mul_f32 v[84:85], v[68:69], v[68:69] op_sel:[0,0] op_sel_hi:[1,0]
v_pk_mul_f32 v[86:87], v[70:71], v[70:71] op_sel:[0,0] op_sel_hi:[1,0]
v_pk_fma_f32 v[72:73], v[64:65], v[64:65], v[80:81] op_sel:[1,1,0] op_sel_hi:[0,1,1] neg_lo:[1,0,0]
v_pk_fma_f32 v[74:75], v[66:67], v[66:67], v[82:83] op_sel:[1,1,0] op_sel_hi:[0,1,1] neg_lo:[1,0,0]
v_pk_fma_f32 v[76:77], v[68:69], v[68:69], v[84:85] op_sel:[1,1,0] op_sel_hi:[0,1,1] neg_lo:[1,0,0]
v_pk_fma_f32 v[78:79], v[70:71], v[70:71], v[86:87] op_sel:[1,1,0] op_sel_hi:[0,1,1] neg_lo:[1,0,0]
v_cvt_pk_bf16_f32 v100, v72, v73
v_cvt_pk_bf16_f32 v101, v74, v75
v_cvt_pk_bf16_f32 v102, v76, v77
v_cvt_pk_bf16_f32 v103, v78, v79
v_pk_mul_f32 v[80:81], v[72:73], v[72:73] op_sel:[0,0] op_sel_hi:[1,0]
v_pk_mul_f32 v[82:83], v[74:75], v[74:75] op_sel:[0,0] op_sel_hi:[1,0]
v_pk_mul_f32 v[84:85], v[76:77], v[76:77] op_sel:[0,0] op_sel_hi:[1,0]
v_pk_mul_f32 v[86:87], v[78:79], v[78:79] op_sel:[0,0] op_sel_hi:[1,0]
v_pk_fma_f32 v[64:65], v[72:73], v[72:73], v[80:81] op_sel:[1,1,0] op_sel_hi:[0,1,1] neg_lo:[1,0,0]
v_pk_fma_f32 v[66:67], v[74:75], v[74:75], v[82:83] op_sel:[1,1,0] op_sel_hi:[0,1,1] neg_lo:[1,0,0]
v_pk_fma_f32 v[68:69], v[76:77], v[76:77], v[84:85] op_sel:[1,1,0] op_sel_hi:[0,1,1] neg_lo:[1,0,0]
v_pk_fma_f32 v[70:71], v[78:79], v[78:79], v[86:87] op_sel:[1,1,0] op_sel_hi:[0,1,1] neg_lo:[1,0,0]
v_pk_mul_f32 v[80:81], v[64:65], v[50:51] op_sel:[0,0] op_sel_hi:[1,0] neg_hi:[0,1]
v_pk_mul_f32 v[82:83], v[66:67], v[54:55] op_sel:[0,0] op_sel_hi:[1,0] neg_hi:[0,1]
v_pk_mul_f32 v[84:85], v[68:69], v[58:59] op_sel:[0,0] op_sel_hi:[1,0] neg_hi:[0,1]
v_pk_mul_f32 v[86:87], v[70:71], v[62:63] op_sel:[0,0] op_sel_hi:[1,0] neg_hi:[0,1]
v_pk_fma_f32 v[72:73], v[64:65], v[50:51], v[80:81] op_sel:[1,1,0] op_sel_hi:[0,1,1] neg_lo:[1,0,0] neg_hi:[1,0,0]
v_pk_fma_f32 v[74:75], v[66:67], v[54:55], v[82:83] op_sel:[1,1,0] op_sel_hi:[0,1,1] neg_lo:[1,0,0] neg_hi:[1,0,0]
v_pk_fma_f32 v[76:77], v[68:69], v[58:59], v[84:85] op_sel:[1,1,0] op_sel_hi:[0,1,1] neg_lo:[1,0,0] neg_hi:[1,0,0]
v_pk_fma_f32 v[78:79], v[70:71], v[62:63], v[86:87] op_sel:[1,1,0] op_sel_hi:[0,1,1] neg_lo:[1,0,0] neg_hi:[1,0,0]
v_cvt_pk_bf16_f32 v104, v72, v73
v_cvt_pk_bf16_f32 v105, v74, v75
v_cvt_pk_bf16_f32 v106, v76, v77
v_cvt_pk_bf16_f32 v107, v78, v79
v_cndmask_b32 v104, v104, v128, s[32:33]
v_cndmask_b32 v105, v105, v129, s[32:33]
v_cndmask_b32 v106, v106, v130, s[32:33]
v_cndmask_b32 v107, v107, v131, s[32:33]
v_pk_mul_f32 v[80:81], v[64:65], v[64:65] op_sel:[0,0] op_sel_hi:[1,0]
v_pk_mul_f32 v[82:83], v[66:67], v[66:67] op_sel:[0,0] op_sel_hi:[1,0]
v_pk_mul_f32 v[84:85], v[68:69], v[68:69] op_sel:[0,0] op_sel_hi:[1,0]
v_pk_mul_f32 v[86:87], v[70:71], v[70:71] op_sel:[0,0] op_sel_hi:[1,0]
v_mfma_f32_16x16x32_bf16 v[112:115], v[88:91], v[104:107], v[112:115]
v_pk_fma_f32 v[72:73], v[64:65], v[64:65], v[80:81] op_sel:[1,1,0] op_sel_hi:[0,1,1] neg_lo:[1,0,0]
v_pk_fma_f32 v[74:75], v[66:67], v[66:67], v[82:83] op_sel:[1,1,0] op_sel_hi:[0,1,1] neg_lo:[1,0,0]
v_pk_fma_f32 v[76:77], v[68:69], v[68:69], v[84:85] op_sel:[1,1,0] op_sel_hi:[0,1,1] neg_lo:[1,0,0]
v_pk_fma_f32 v[78:79], v[70:71], v[70:71], v[86:87] op_sel:[1,1,0] op_sel_hi:[0,1,1] neg_lo:[1,0,0]
v_pk_mul_f32 v[80:81], v[72:73], v[50:51] op_sel:[0,0] op_sel_hi:[1,0] neg_hi:[0,1]
v_pk_mul_f32 v[82:83], v[74:75], v[54:55] op_sel:[0,0] op_sel_hi:[1,0] neg_hi:[0,1]
v_pk_mul_f32 v[84:85], v[76:77], v[58:59] op_sel:[0,0] op_sel_hi:[1,0] neg_hi:[0,1]
v_pk_mul_f32 v[86:87], v[78:79], v[62:63] op_sel:[0,0] op_sel_hi:[1,0] neg_hi:[0,1]
v_pk_fma_f32 v[64:65], v[72:73], v[50:51], v[80:81] op_sel:[1,1,0] op_sel_hi:[0,1,1] neg_lo:[1,0,0] neg_hi:[1,0,0]
v_pk_fma_f32 v[66:67], v[74:75], v[54:55], v[82:83] op_sel:[1,1,0] op_sel_hi:[0,1,1] neg_lo:[1,0,0] neg_hi:[1,0,0]
v_pk_fma_f32 v[68:69], v[76:77], v[58:59], v[84:85] op_sel:[1,1,0] op_sel_hi:[0,1,1] neg_lo:[1,0,0] neg_hi:[1,0,0]
v_pk_fma_f32 v[70:71], v[78:79], v[62:63], v[86:87] op_sel:[1,1,0] op_sel_hi:[0,1,1] neg_lo:[1,0,0] neg_hi:[1,0,0]
v_cvt_pk_bf16_f32 v108, v64, v65
v_cvt_pk_bf16_f32 v109, v66, v67
v_cvt_pk_bf16_f32 v110, v68, v69
v_cvt_pk_bf16_f32 v111, v70, v71
v_pk_mul_f32 v[80:81], v[72:73], v[72:73] op_sel:[0,0] op_sel_hi:[1,0]
v_pk_mul_f32 v[82:83], v[74:75], v[74:75] op_sel:[0,0] op_sel_hi:[1,0]
v_pk_mul_f32 v[84:85], v[76:77], v[76:77] op_sel:[0,0] op_sel_hi:[1,0]
v_pk_mul_f32 v[86:87], v[78:79], v[78:79] op_sel:[0,0] op_sel_hi:[1,0]
v_mfma_f32_16x16x32_bf16 v[116:119], v[92:95], v[108:111], v[116:119]
v_pk_fma_f32 v[64:65], v[72:73], v[72:73], v[80:81] op_sel:[1,1,0] op_sel_hi:[0,1,1] neg_lo:[1,0,0]
v_pk_fma_f32 v[66:67], v[74:75], v[74:75], v[82:83] op_sel:[1,1,0] op_sel_hi:[0,1,1] neg_lo:[1,0,0]
v_pk_fma_f32 v[68:69], v[76:77], v[76:77], v[84:85] op_sel:[1,1,0] op_sel_hi:[0,1,1] neg_lo:[1,0,0]
v_pk_fma_f32 v[70:71], v[78:79], v[78:79], v[86:87] op_sel:[1,1,0] op_sel_hi:[0,1,1] neg_lo:[1,0,0]
v_pk_mul_f32 v[80:81], v[64:65], v[50:51] op_sel:[0,0] op_sel_hi:[1,0] neg_hi:[0,1]
v_pk_mul_f32 v[82:83], v[66:67], v[54:55] op_sel:[0,0] op_sel_hi:[1,0] neg_hi:[0,1]
v_pk_mul_f32 v[84:85], v[68:69], v[58:59] op_sel:[0,0] op_sel_hi:[1,0] neg_hi:[0,1]
v_pk_mul_f32 v[86:87], v[70:71], v[62:63] op_sel:[0,0] op_sel_hi:[1,0] neg_hi:[0,1]
v_pk_fma_f32 v[72:73], v[64:65], v[50:51], v[80:81] op_sel:[1,1,0] op_sel_hi:[0,1,1] neg_lo:[1,0,0] neg_hi:[1,0,0]
v_pk_fma_f32 v[74:75], v[66:67], v[54:55], v[82:83] op_sel:[1,1,0] op_sel_hi:[0,1,1] neg_lo:[1,0,0] neg_hi:[1,0,0]
v_pk_fma_f32 v[76:77], v[68:69], v[58:59], v[84:85] op_sel:[1,1,0] op_sel_hi:[0,1,1] neg_lo:[1,0,0] neg_hi:[1,0,0]
v_pk_fma_f32 v[78:79], v[70:71], v[62:63], v[86:87] op_sel:[1,1,0] op_sel_hi:[0,1,1] neg_lo:[1,0,0] neg_hi:[1,0,0]
v_cvt_pk_bf16_f32 v104, v72, v73
v_cvt_pk_bf16_f32 v105, v74, v75
v_cvt_pk_bf16_f32 v106, v76, v77
v_cvt_pk_bf16_f32 v107, v78, v79
v_pk_mul_f32 v[80:81], v[64:65], v[64:65] op_sel:[0,0] op_sel_hi:[1,0]
v_pk_mul_f32 v[82:83], v[66:67], v[66:67] op_sel:[0,0] op_sel_hi:[1,0]
v_pk_mul_f32 v[84:85], v[68:69], v[68:69] op_sel:[0,0] op_sel_hi:[1,0]
v_pk_mul_f32 v[86:87], v[70:71], v[70:71] op_sel:[0,0] op_sel_hi:[1,0]
v_mfma_f32_16x16x32_bf16 v[120:123], v[96:99], v[104:107], v[120:123]
v_pk_fma_f32 v[72:73], v[64:65], v[64:65], v[80:81] op_sel:[1,1,0] op_sel_hi:[0,1,1] neg_lo:[1,0,0]
v_pk_fma_f32 v[74:75], v[66:67], v[66:67], v[82:83] op_sel:[1,1,0] op_sel_hi:[0,1,1] neg_lo:[1,0,0]
v_pk_fma_f32 v[76:77], v[68:69], v[68:69], v[84:85] op_sel:[1,1,0] op_sel_hi:[0,1,1] neg_lo:[1,0,0]
v_pk_fma_f32 v[78:79], v[70:71], v[70:71], v[86:87] op_sel:[1,1,0] op_sel_hi:[0,1,1] neg_lo:[1,0,0]
v_pk_mul_f32 v[80:81], v[72:73], v[50:51] op_sel:[0,0] op_sel_hi:[1,0] neg_hi:[0,1]
v_pk_mul_f32 v[82:83], v[74:75], v[54:55] op_sel:[0,0] op_sel_hi:[1,0] neg_hi:[0,1]
v_pk_mul_f32 v[84:85], v[76:77], v[58:59] op_sel:[0,0] op_sel_hi:[1,0] neg_hi:[0,1]
v_pk_mul_f32 v[86:87], v[78:79], v[62:63] op_sel:[0,0] op_sel_hi:[1,0] neg_hi:[0,1]
v_pk_fma_f32 v[64:65], v[72:73], v[50:51], v[80:81] op_sel:[1,1,0] op_sel_hi:[0,1,1] neg_lo:[1,0,0] neg_hi:[1,0,0]
v_pk_fma_f32 v[66:67], v[74:75], v[54:55], v[82:83] op_sel:[1,1,0] op_sel_hi:[0,1,1] neg_lo:[1,0,0] neg_hi:[1,0,0]
v_pk_fma_f32 v[68:69], v[76:77], v[58:59], v[84:85] op_sel:[1,1,0] op_sel_hi:[0,1,1] neg_lo:[1,0,0] neg_hi:[1,0,0]
v_pk_fma_f32 v[70:71], v[78:79], v[62:63], v[86:87] op_sel:[1,1,0] op_sel_hi:[0,1,1] neg_lo:[1,0,0] neg_hi:[1,0,0]
v_cvt_pk_bf16_f32 v108, v64, v65
v_cvt_pk_bf16_f32 v109, v66, v67
v_cvt_pk_bf16_f32 v110, v68, v69
v_cvt_pk_bf16_f32 v111, v70, v71
s_nop 1
v_mfma_f32_16x16x32_bf16 v[124:127], v[100:103], v[108:111], v[124:127]
v_readlane_b32 s40, v10, 63
s_lshl_b32 s41, s24, 2
s_add_u32 s41, s41, 154128
v_mov_b32 v11, s41
v_mov_b32 v10, s40
s_nop 1
ds_write_b128 v22, v[112:115] offset:0
ds_write_b128 v22, v[116:119] offset:1024
ds_write_b128 v22, v[120:123] offset:2048
ds_write_b128 v22, v[124:127] offset:3072
ds_write_b32 v11, v10
s_lshl_b32 s57, s25, 2
s_add_u32 s41, s57, 162560
s_waitcnt lgkmcnt(0)
v_mov_b32 v2, s41
v_mov_b32 v3, 1
s_mov_b64 exec, 1
ds_add_u32 v2, v3
s_mov_b64 exec, -1
s_mov_b32 s63, 0x400000
WS_1:
ds_read_b32 v3, v2
s_waitcnt lgkmcnt(0)
v_readfirstlane_b32 s40, v3
s_sub_u32 s63, s63, 1
s_cmp_eq_u32 s63, 0
s_cbranch_scc1 WS_1_x
s_cmp_ge_u32 s40, 2
s_cbranch_scc0 WS_1
WS_1_x:
ds_read_b128 v[32:35], v23
ds_read_b128 v[36:39], v23 offset:4096
ds_read_b128 v[40:43], v23 offset:1024
ds_read_b128 v[44:47], v23 offset:5120
s_lshl_b32 s41, s25, 3
s_add_u32 s41, s41, 154128
v_mov_b32 v11, s41
ds_read_b64 v[8:9], v11
s_waitcnt lgkmcnt(0)
v_add_f32 v32, v32, v36
v_add_f32 v33, v33, v37
v_add_f32 v34, v34, v38
v_add_f32 v35, v35, v39
v_add_f32 v40, v40, v44
v_add_f32 v41, v41, v45
v_add_f32 v42, v42, v46
v_add_f32 v43, v43, v47
v_add_f32 v8, v8, v9
v_cvt_pk_bf16_f32 v32, v32, v33
v_cvt_pk_bf16_f32 v33, v34, v35
v_cvt_pk_bf16_f32 v40, v40, v41
v_cvt_pk_bf16_f32 v41, v42, v43
v_cvt_pk_bf16_f32 v8, v8, v8
s_sub_u32 s41, s39, 2
v_mov_b32 v11, s41
s_mov_b64 exec, s[36:37]
ds_write_b64 v24, v[32:33]
s_mov_b64 exec, s[34:35]
ds_write_b64 v24, v[40:41] offset:256
s_mov_b64 exec, -1
ds_write_b16 v11, v8
s_add_u32 s41, s57, 162568
s_waitcnt lgkmcnt(0)
v_mov_b32 v2, s41
v_mov_b32 v3, 1
s_mov_b64 exec, 1
ds_add_u32 v2, v3
s_mov_b64 exec, -1
s_mov_b32 s63, 0x400000
WS_2:
ds_read_b32 v3, v2
s_waitcnt lgkmcnt(0)
v_readfirstlane_b32 s40, v3
s_sub_u32 s63, s63, 1
s_cmp_eq_u32 s63, 0
s_cbranch_scc1 WS_2_x
s_cmp_ge_u32 s40, 2
s_cbranch_scc0 WS_2
WS_2_x:
ds_read_u16 v76, v140
ds_read_u16 v77, v141
ds_read_u16 v78, v142
ds_read_u16 v79, v143
ds_read_u16 v80, v144
ds_read_u16 v81, v145
ds_read_u16 v82, v146
ds_read_u16 v83, v147
v_mov_b32 v72, 0
v_mov_b32 v73, 0
v_mov_b32 v74, 0
v_mov_b32 v75, 0
ds_read_u16 v84, v148
ds_read_u16 v85, v149
ds_read_u16 v86, v150
ds_read_u16 v87, v151
ds_read_u16 v88, v152
ds_read_u16 v89, v153
ds_read_u16 v90, v154
ds_read_u16 v91, v155
s_waitcnt lgkmcnt(8)
v_lshl_or_b32 v64, v77, 16, v76
v_lshl_or_b32 v65, v79, 16, v78
v_lshl_or_b32 v66, v81, 16, v80
v_lshl_or_b32 v67, v83, 16, v82
ds_write_b128 v29, v[64:67]
s_waitcnt lgkmcnt(1)
v_lshl_or_b32 v68, v85, 16, v84
v_lshl_or_b32 v69, v87, 16, v86
v_lshl_or_b32 v70, v89, 16, v88
v_lshl_or_b32 v71, v91, 16, v90
ds_write_b128 v29, v[68:71] offset:2048
v_cmp_gt_u32 vcc, 4, v26
s_and_saveexec_b64 s[42:43], vcc
ds_write_b128 v29, v[72:75] offset:4096
s_mov_b64 exec, s[42:43]
s_add_u32 s41, s57, 162576
s_waitcnt lgkmcnt(0)
v_mov_b32 v2, s41
v_mov_b32 v3, 1
s_mov_b64 exec, 1
ds_add_u32 v2, v3
s_mov_b64 exec, -1
s_mov_b32 s63, 0x400000
WS_3:
ds_read_b32 v3, v2
s_waitcnt lgkmcnt(0)
v_readfirstlane_b32 s40, v3
s_sub_u32 s63, s63, 1
s_cmp_eq_u32 s63, 0
s_cbranch_scc1 WS_3_x
s_cmp_ge_u32 s40, 2
s_cbranch_scc0 WS_3
WS_3_x:
v_subrev_u32 v33, 2048, v30
ds_read_b128 v[36:39], v30
ds_read_b128 v[40:43], v30 offset:16
ds_read_b128 v[44:47], v33
ds_read_b128 v[48:51], v33 offset:16
s_waitcnt lgkmcnt(2)
v_alignbit_b32 v60, v37, v36, 16
v_alignbit_b32 v61, v38, v37, 16
v_alignbit_b32 v62, v39, v38, 16
v_alignbit_b32 v63, v40, v39, 16
v_alignbit_b32 v64, v41, v40, 16
v_alignbit_b32 v65, v42, v41, 16
v_alignbit_b32 v66, v43, v42, 16
v_alignbit_b32 v68, v38, v37, 16
v_alignbit_b32 v69, v39, v38, 16
v_alignbit_b32 v70, v40, v39, 16
v_alignbit_b32 v71, v41, v40, 16
v_alignbit_b32 v72, v42, v41, 16
v_alignbit_b32 v73, v43, v42, 16
v_mov_b32 v76, v37
v_mov_b32 v77, v38
v_mov_b32 v78, v39
v_mov_b32 v79, v40
v_mov_b32 v80, v41
v_mov_b32 v81, v42
ds_write_b128 v31, v[36:39] offset:29120
ds_write_b128 v31, v[38:41] offset:12480
ds_write_b128 v31, v[60:63] offset:24960
ds_write_b128 v31, v[62:65] offset:8320
ds_write_b128 v31, v[68:71] offset:16640
ds_write_b128 v31, v[70:73] offset:0
ds_write_b128 v31, v[76:79] offset:20800
ds_write_b128 v31, v[78:81] offset:4160
s_waitcnt lgkmcnt(8)
v_alignbit_b32 v60, v45, v44, 16
v_alignbit_b32 v61, v46, v45, 16
v_alignbit_b32 v62, v47, v46, 16
v_alignbit_b32 v63, v48, v47, 16
v_alignbit_b32 v64, v49, v48, 16
v_alignbit_b32 v65, v50, v49, 16
v_alignbit_b32 v66, v51, v50, 16
v_alignbit_b32 v68, v46, v45, 16
v_alignbit_b32 v69, v47, v46, 16
v_alignbit_b32 v70, v48, v47, 16
v_alignbit_b32 v71, v49, v48, 16
v_alignbit_b32 v72, v50, v49, 16
v_alignbit_b32 v73, v51, v50, 16
v_mov_b32 v76, v45
v_mov_b32 v77, v46
v_mov_b32 v78, v47
v_mov_b32 v79, v48
v_mov_b32 v80, v49
v_mov_b32 v81, v50
ds_write_b128 v31, v[44:47] offset:31168
ds_write_b128 v31, v[46:49] offset:14528
ds_write_b128 v31, v[60:63] offset:27008
ds_write_b128 v31, v[62:65] offset:10368
ds_write_b128 v31, v[68:71] offset:18688
ds_write_b128 v31, v[70:73] offset:2048
ds_write_b128 v31, v[76:79] offset:22848
ds_write_b128 v31, v[78:81] offset:6208
s_lshl_b32 s28, s62, 12
v_lshl_add_u32 v160, v0, 4, s28
v_add_u32 v161, 4096, v160
v_lshlrev_b32 v162, 5, v0
v_add_u32 v162, 6422528, v162
v_add_u32 v163, 8192, v162
v_and_b32 v50, 15, v1
v_lshrrev_b32 v51, 4, v1
s_lshl_b32 s30, s25, 12
s_add_u32 s30, s30, s28
s_lshl_b32 s31, s26, 11
s_add_u32 s30, s30, s31
v_lshlrev_b32 v164, 6, v50
v_lshl_add_u32 v164, v51, 3, v164
v_add_u32 v164, s30, v164
v_and_b32 v165, 3, v1
v_mul_u32_u24 v165, 12288, v165
v_bfe_u32 v54, v1, 2, 1
v_lshl_add_u32 v165, v54, 2, v165
v_lshrrev_b32 v54, 3, v1
v_min_u32 v54, 2, v54
v_lshl_add_u32 v165, v54, 11, v165
s_lshl_b32 s32, s62, 2
s_add_u32 s32, s32, 6684672
v_add_u32 v165, s32, v165
v_and_b32 v54, 7, v50
v_lshrrev_b32 v55, 3, v50
v_mul_u32_u24 v2, 4160, v54
v_sub_u32 v55, v55, v51
v_add_u32 v55, 3, v55
v_lshl_add_u32 v2, v55, 4, v2
s_mul_i32 s38, s25, 33280
v_add_u32 v2, s38, v2
v_mul_u32_u24 v3, 96, v50
v_lshl_add_u32 v3, v51, 4, v3
s_mul_i32 s38, s25, 9120
s_add_u32 s38, s38, 66560
v_add_u32 v3, s38, v3
v_lshrrev_b32 v166, 2, v0
v_mul_u32_u24 v166, 96, v166
v_and_b32 v63, 3, v0
v_lshl_add_u32 v166, v63, 4, v166
v_add_u32 v166, 69536, v166
s_lshl_b32 s38, s24, 12
s_add_u32 s38, s38, 84800
v_lshl_add_u32 v4, v1, 4, s38
s_xor_b32 s39, s24, 1
s_lshl_b32 s38, s39, 12
s_add_u32 s38, s38, 84800
v_lshl_add_u32 v5, v1, 4, s38
s_lshl_b32 s38, s24, 2
s_add_u32 s38, s38, 162592
v_mov_b32 v7, s38
s_lshl_b32 s38, s39, 2
s_add_u32 s38, s38, 162592
v_mov_b32 v8, s38
v_mul_u32_u24 v6, 96, v50
v_lshl_add_u32 v6, v51, 3, v6
s_mul_i32 s38, s25, 9120
s_mul_i32 s39, s26, 3072
s_add_u32 s38, s38, s39
s_add_u32 s38, s38, 69536
v_add_u32 v6, s38, v6
s_lshl_b32 s38, s27, 7
s_lshl_b32 s39, s26, 20
s_add_u32 s38, s38, s39
s_add_u32 s38, s38, 2097152
v_lshrrev_b32 v9, 3, v1
v_lshlrev_b32 v9, 16, v9
v_and_b32 v63, 7, v1
v_lshl_add_u32 v9, v63, 4, v9
v_add_u32 v9, s38, v9
v_add_u32 v12, 0x80000, v9
s_mul_i32 s38, s25, 33280
s_mul_i32 s39, s26, 2560
s_add_u32 s38, s38, s39
v_mul_u32_u24 v10, 80, v50
v_lshl_add_u32 v10, v51, 3, v10
v_add_u32 v10, s38, v10
v_lshrrev_b32 v11, 2, v1
v_mul_u32_u24 v11, 80, v11
v_and_b32 v63, 3, v1
v_lshl_add_u32 v11, v63, 4, v11
v_add_u32 v11, s38, v11
v_mov_b32 v32, 0
v_mov_b32 v33, 0
v_mov_b32 v34, 0
v_mov_b32 v35, 0
v_mov_b32 v36, 0
v_mov_b32 v37, 0
v_mov_b32 v38, 0
v_mov_b32 v39, 0
v_mov_b32 v40, 0
v_mov_b32 v41, 0
v_mov_b32 v42, 0
v_mov_b32 v43, 0
v_mov_b32 v44, 0
v_mov_b32 v45, 0
v_mov_b32 v46, 0
v_mov_b32 v47, 0
v_mov_b32 v48, 0
v_mov_b32 v49, 0
v_mov_b32 v50, 0
v_mov_b32 v51, 0
v_mov_b32 v52, 0
v_mov_b32 v53, 0
v_mov_b32 v54, 0
v_mov_b32 v55, 0
v_mov_b32 v56, 0
v_mov_b32 v57, 0
v_mov_b32 v58, 0
v_mov_b32 v59, 0
v_mov_b32 v60, 0
v_mov_b32 v61, 0
v_mov_b32 v62, 0
v_mov_b32 v63, 0
s_lshl_b32 s38, s25, 4
s_lshr_b32 s36, s56, s38
s_lshl_b32 s36, s36, 16
s_waitcnt lgkmcnt(0)
s_barrier
global_load_dword v13, v165, s[14:15] sc1
global_load_dwordx4 v[168:171], v160, s[14:15] sc1
global_load_dwordx4 v[172:175], v161, s[14:15] sc1
global_load_dwordx4 v[176:179], v162, s[14:15] sc1
global_load_dwordx4 v[180:183], v162, s[14:15] offset:16 sc1
global_load_dwordx4 v[184:187], v163, s[14:15] sc1
global_load_dwordx4 v[188:191], v163, s[14:15] offset:16 sc1
global_load_dwordx2 v[144:145], v164, s[14:15] offset:0 sc1
global_load_dwordx2 v[146:147], v164, s[14:15] offset:32 sc1
global_load_dwordx2 v[148:149], v164, s[14:15] offset:1024 sc1
global_load_dwordx2 v[150:151], v164, s[14:15] offset:1056 sc1
s_waitcnt vmcnt(10)
v_add_f32_dpp v13, v13, v13 quad_perm:[1,0,3,2] row_mask:0xf bank_mask:0xf
s_nop 1
v_add_f32_dpp v13, v13, v13 quad_perm:[2,3,0,1] row_mask:0xf bank_mask:0xf
v_cvt_pk_bf16_f32 v13, v13, v13
v_and_b32 v13, 0xffff0000, v13
v_add_f32 v14, 1.0, v13
v_cvt_pk_bf16_f32 v14, v14, v14
v_and_b32 v14, 0xffff0000, v14
v_readlane_b32 s59, v13, 0
v_readlane_b32 s61, v13, 4
v_readlane_b32 s54, v13, 16
v_readlane_b32 s55, v13, 20
v_readlane_b32 s58, v14, 8
v_readlane_b32 s60, v14, 12
s_cmp_eq_u32 s25, 0
s_cselect_b32 s37, s54, s55
s_waitcnt vmcnt(4)
v_lshlrev_b32 v64, 16, v168
v_and_b32 v65, 0xffff0000, v168
v_lshlrev_b32 v66, 16, v169
v_and_b32 v67, 0xffff0000, v169
v_lshlrev_b32 v68, 16, v170
v_and_b32 v69, 0xffff0000, v170
v_lshlrev_b32 v70, 16, v171
v_and_b32 v71, 0xffff0000, v171
v_pk_fma_f32 v[64:65], v[64:65], v[176:177], v[184:185]
v_pk_fma_f32 v[66:67], v[66:67], v[178:179], v[186:187]
v_pk_fma_f32 v[68:69], v[68:69], v[180:181], v[188:189]
v_pk_fma_f32 v[70:71], v[70:71], v[182:183], v[190:191]
v_pk_fma_f32 v[64:65], v[64:65], s[58:59], s[58:59] op_sel:[0,0,1] op_sel_hi:[1,0,1]
v_pk_fma_f32 v[66:67], v[66:67], s[58:59], s[58:59] op_sel:[0,0,1] op_sel_hi:[1,0,1]
v_pk_fma_f32 v[68:69], v[68:69], s[58:59], s[58:59] op_sel:[0,0,1] op_sel_hi:[1,0,1]
v_pk_fma_f32 v[70:71], v[70:71], s[58:59], s[58:59] op_sel:[0,0,1] op_sel_hi:[1,0,1]
v_cvt_pk_bf16_f32 v72, v64, v65
v_cvt_pk_bf16_f32 v73, v66, v67
v_cvt_pk_bf16_f32 v74, v68, v69
v_cvt_pk_bf16_f32 v75, v70, v71
ds_write_b128 v166, v[72:75] offset:0
v_lshlrev_b32 v64, 16, v172
v_and_b32 v65, 0xffff0000, v172
v_lshlrev_b32 v66, 16, v173
v_and_b32 v67, 0xffff0000, v173
v_lshlrev_b32 v68, 16, v174
v_and_b32 v69, 0xffff0000, v174
v_lshlrev_b32 v70, 16, v175
v_and_b32 v71, 0xffff0000, v175
v_pk_fma_f32 v[64:65], v[64:65], v[176:177], v[184:185]
v_pk_fma_f32 v[66:67], v[66:67], v[178:179], v[186:187]
v_pk_fma_f32 v[68:69], v[68:69], v[180:181], v[188:189]
v_pk_fma_f32 v[70:71], v[70:71], v[182:183], v[190:191]
v_pk_fma_f32 v[64:65], v[64:65], s[60:61], s[60:61] op_sel:[0,0,1] op_sel_hi:[1,0,1]
v_pk_fma_f32 v[66:67], v[66:67], s[60:61], s[60:61] op_sel:[0,0,1] op_sel_hi:[1,0,1]
v_pk_fma_f32 v[68:69], v[68:69], s[60:61], s[60:61] op_sel:[0,0,1] op_sel_hi:[1,0,1]
v_pk_fma_f32 v[70:71], v[70:71], s[60:61], s[60:61] op_sel:[0,0,1] op_sel_hi:[1,0,1]
v_cvt_pk_bf16_f32 v76, v64, v65
v_cvt_pk_bf16_f32 v77, v66, v67
v_cvt_pk_bf16_f32 v78, v68, v69
v_cvt_pk_bf16_f32 v79, v70, v71
ds_write_b128 v166, v[76:79] offset:9120
s_waitcnt lgkmcnt(0)
v_mov_b32 v14, 162612
v_mov_b32 v15, 1
s_mov_b64 exec, 1
ds_add_u32 v14, v15
s_mov_b64 exec, -1
s_mov_b32 s63, 0x400000
WS_4:
ds_read_b32 v15, v14
s_waitcnt lgkmcnt(0)
v_readfirstlane_b32 s40, v15
s_sub_u32 s63, s63, 1
s_cmp_eq_u32 s63, 0
s_cbranch_scc1 WS_4_x
s_cmp_ge_u32 s40, 4
s_cbranch_scc0 WS_4
WS_4_x:
s_cmp_eq_u32 s26, 0
s_cbranch_scc0 K2_B
ds_read_b128 v[64:67], v2 offset:0
ds_read_b128 v[68:71], v2 offset:32
ds_read_b128 v[72:75], v3 offset:2976
ds_read_b128 v[76:79], v3 offset:4512
ds_read_b128 v[80:83], v3 offset:6048
ds_read_b128 v[84:87], v3 offset:7584
ds_read_b128 v[88:91], v2 offset:64
ds_read_b128 v[92:95], v2 offset:96
ds_read_b128 v[96:99], v3 offset:2880
ds_read_b128 v[100:103], v3 offset:4416
ds_read_b128 v[104:107], v3 offset:5952
ds_read_b128 v[108:111], v3 offset:7488
s_waitcnt lgkmcnt(6)
v_mfma_f32_16x16x32_bf16 v[32:35], v[64:67], v[72:75], v[32:35]
ds_read_b128 v[112:115], v2 offset:128
v_mfma_f32_16x16x32_bf16 v[36:39], v[68:71], v[72:75], v[36:39]
ds_read_b128 v[116:119], v2 offset:160
v_mfma_f32_16x16x32_bf16 v[40:43], v[64:67], v[76:79], v[40:43]
ds_read_b128 v[120:123], v3 offset:2784
v_mfma_f32_16x16x32_bf16 v[44:47], v[68:71], v[76:79], v[44:47]
ds_read_b128 v[124:127], v3 offset:4320
v_mfma_f32_16x16x32_bf16 v[48:51], v[64:67], v[80:83], v[48:51]
ds_read_b128 v[128:131], v3 offset:5856
v_mfma_f32_16x16x32_bf16 v[52:55], v[68:71], v[80:83], v[52:55]
ds_read_b128 v[132:135], v3 offset:7392
v_mfma_f32_16x16x32_bf16 v[56:59], v[64:67], v[84:87], v[56:59]
v_mfma_f32_16x16x32_bf16 v[60:63], v[68:71], v[84:87], v[60:63]
s_waitcnt lgkmcnt(6)
v_mfma_f32_16x16x32_bf16 v[32:35], v[88:91], v[96:99], v[32:35]
ds_read_b128 v[64:67], v2 offset:192
v_mfma_f32_16x16x32_bf16 v[36:39], v[92:95], v[96:99], v[36:39]
ds_read_b128 v[68:71], v2 offset:224
v_mfma_f32_16x16x32_bf16 v[40:43], v[88:91], v[100:103], v[40:43]
ds_read_b128 v[72:75], v3 offset:2688
v_mfma_f32_16x16x32_bf16 v[44:47], v[92:95], v[100:103], v[44:47]
ds_read_b128 v[76:79], v3 offset:4224
v_mfma_f32_16x16x32_bf16 v[48:51], v[88:91], v[104:107], v[48:51]
ds_read_b128 v[80:83], v3 offset:5760
v_mfma_f32_16x16x32_bf16 v[52:55], v[92:95], v[104:107], v[52:55]
ds_read_b128 v[84:87], v3 offset:7296
v_mfma_f32_16x16x32_bf16 v[56:59], v[88:91], v[108:111], v[56:59]
v_mfma_f32_16x16x32_bf16 v[60:63], v[92:95], v[108:111], v[60:63]
s_waitcnt lgkmcnt(6)
v_mfma_f32_16x16x32_bf16 v[32:35], v[112:115], v[120:123], v[32:35]
ds_read_b128 v[88:91], v2 offset:256
v_mfma_f32_16x16x32_bf16 v[36:39], v[116:119], v[120:123], v[36:39]
ds_read_b128 v[92:95], v2 offset:288
v_mfma_f32_16x16x32_bf16 v[40:43], v[112:115], v[124:127], v[40:43]
ds_read_b128 v[96:99], v3 offset:2592
v_mfma_f32_16x16x32_bf16 v[44:47], v[116:119], v[124:127], v[44:47]
ds_read_b128 v[100:103], v3 offset:4128
v_mfma_f32_16x16x32_bf16 v[48:51], v[112:115], v[128:131], v[48:51]
ds_read_b128 v[104:107], v3 offset:5664
v_mfma_f32_16x16x32_bf16 v[52:55], v[116:119], v[128:131], v[52:55]
ds_read_b128 v[108:111], v3 offset:7200
v_mfma_f32_16x16x32_bf16 v[56:59], v[112:115], v[132:135], v[56:59]
v_mfma_f32_16x16x32_bf16 v[60:63], v[116:119], v[132:135], v[60:63]
s_waitcnt lgkmcnt(6)
v_mfma_f32_16x16x32_bf16 v[32:35], v[64:67], v[72:75], v[32:35]
ds_read_b128 v[112:115], v2 offset:320
v_mfma_f32_16x16x32_bf16 v[36:39], v[68:71], v[72:75], v[36:39]
ds_read_b128 v[116:119], v2 offset:352
v_mfma_f32_16x16x32_bf16 v[40:43], v[64:67], v[76:79], v[40:43]
ds_read_b128 v[120:123], v3 offset:2496
v_mfma_f32_16x16x32_bf16 v[44:47], v[68:71], v[76:79], v[44:47]
ds_read_b128 v[124:127], v3 offset:4032
v_mfma_f32_16x16x32_bf16 v[48:51], v[64:67], v[80:83], v[48:51]
ds_read_b128 v[128:131], v3 offset:5568
v_mfma_f32_16x16x32_bf16 v[52:55], v[68:71], v[80:83], v[52:55]
ds_read_b128 v[132:135], v3 offset:7104
v_mfma_f32_16x16x32_bf16 v[56:59], v[64:67], v[84:87], v[56:59]
v_mfma_f32_16x16x32_bf16 v[60:63], v[68:71], v[84:87], v[60:63]
s_waitcnt lgkmcnt(6)
v_mfma_f32_16x16x32_bf16 v[32:35], v[88:91], v[96:99], v[32:35]
ds_read_b128 v[64:67], v2 offset:384
v_mfma_f32_16x16x32_bf16 v[36:39], v[92:95], v[96:99], v[36:39]
ds_read_b128 v[68:71], v2 offset:416
v_mfma_f32_16x16x32_bf16 v[40:43], v[88:91], v[100:103], v[40:43]
ds_read_b128 v[72:75], v3 offset:2400
v_mfma_f32_16x16x32_bf16 v[44:47], v[92:95], v[100:103], v[44:47]
ds_read_b128 v[76:79], v3 offset:3936
v_mfma_f32_16x16x32_bf16 v[48:51], v[88:91], v[104:107], v[48:51]
ds_read_b128 v[80:83], v3 offset:5472
v_mfma_f32_16x16x32_bf16 v[52:55], v[92:95], v[104:107], v[52:55]
ds_read_b128 v[84:87], v3 offset:7008
v_mfma_f32_16x16x32_bf16 v[56:59], v[88:91], v[108:111], v[56:59]
v_mfma_f32_16x16x32_bf16 v[60:63], v[92:95], v[108:111], v[60:63]
s_waitcnt lgkmcnt(6)
v_mfma_f32_16x16x32_bf16 v[32:35], v[112:115], v[120:123], v[32:35]
ds_read_b128 v[88:91], v2 offset:448
v_mfma_f32_16x16x32_bf16 v[36:39], v[116:119], v[120:123], v[36:39]
ds_read_b128 v[92:95], v2 offset:480
v_mfma_f32_16x16x32_bf16 v[40:43], v[112:115], v[124:127], v[40:43]
ds_read_b128 v[96:99], v3 offset:2304
v_mfma_f32_16x16x32_bf16 v[44:47], v[116:119], v[124:127], v[44:47]
ds_read_b128 v[100:103], v3 offset:3840
v_mfma_f32_16x16x32_bf16 v[48:51], v[112:115], v[128:131], v[48:51]
ds_read_b128 v[104:107], v3 offset:5376
v_mfma_f32_16x16x32_bf16 v[52:55], v[116:119], v[128:131], v[52:55]
ds_read_b128 v[108:111], v3 offset:6912
v_mfma_f32_16x16x32_bf16 v[56:59], v[112:115], v[132:135], v[56:59]
v_mfma_f32_16x16x32_bf16 v[60:63], v[116:119], v[132:135], v[60:63]
s_waitcnt lgkmcnt(6)
v_mfma_f32_16x16x32_bf16 v[32:35], v[64:67], v[72:75], v[32:35]
ds_read_b128 v[112:115], v2 offset:512
v_mfma_f32_16x16x32_bf16 v[36:39], v[68:71], v[72:75], v[36:39]
ds_read_b128 v[116:119], v2 offset:544
v_mfma_f32_16x16x32_bf16 v[40:43], v[64:67], v[76:79], v[40:43]
ds_read_b128 v[120:123], v3 offset:2208
v_mfma_f32_16x16x32_bf16 v[44:47], v[68:71], v[76:79], v[44:47]
ds_read_b128 v[124:127], v3 offset:3744
v_mfma_f32_16x16x32_bf16 v[48:51], v[64:67], v[80:83], v[48:51]
ds_read_b128 v[128:131], v3 offset:5280
v_mfma_f32_16x16x32_bf16 v[52:55], v[68:71], v[80:83], v[52:55]
ds_read_b128 v[132:135], v3 offset:6816
v_mfma_f32_16x16x32_bf16 v[56:59], v[64:67], v[84:87], v[56:59]
v_mfma_f32_16x16x32_bf16 v[60:63], v[68:71], v[84:87], v[60:63]
s_waitcnt lgkmcnt(6)
v_mfma_f32_16x16x32_bf16 v[32:35], v[88:91], v[96:99], v[32:35]
ds_read_b128 v[64:67], v2 offset:576
v_mfma_f32_16x16x32_bf16 v[36:39], v[92:95], v[96:99], v[36:39]
ds_read_b128 v[68:71], v2 offset:608
v_mfma_f32_16x16x32_bf16 v[40:43], v[88:91], v[100:103], v[40:43]
ds_read_b128 v[72:75], v3 offset:2112
v_mfma_f32_16x16x32_bf16 v[44:47], v[92:95], v[100:103], v[44:47]
ds_read_b128 v[76:79], v3 offset:3648
v_mfma_f32_16x16x32_bf16 v[48:51], v[88:91], v[104:107], v[48:51]
ds_read_b128 v[80:83], v3 offset:5184
v_mfma_f32_16x16x32_bf16 v[52:55], v[92:95], v[104:107], v[52:55]
ds_read_b128 v[84:87], v3 offset:6720
v_mfma_f32_16x16x32_bf16 v[56:59], v[88:91], v[108:111], v[56:59]
v_mfma_f32_16x16x32_bf16 v[60:63], v[92:95], v[108:111], v[60:63]
s_waitcnt lgkmcnt(6)
v_mfma_f32_16x16x32_bf16 v[32:35], v[112:115], v[120:123], v[32:35]
ds_read_b128 v[88:91], v2 offset:640
v_mfma_f32_16x16x32_bf16 v[36:39], v[116:119], v[120:123], v[36:39]
ds_read_b128 v[92:95], v2 offset:672
v_mfma_f32_16x16x32_bf16 v[40:43], v[112:115], v[124:127], v[40:43]
ds_read_b128 v[96:99], v3 offset:2016
v_mfma_f32_16x16x32_bf16 v[44:47], v[116:119], v[124:127], v[44:47]
ds_read_b128 v[100:103], v3 offset:3552
v_mfma_f32_16x16x32_bf16 v[48:51], v[112:115], v[128:131], v[48:51]
ds_read_b128 v[104:107], v3 offset:5088
v_mfma_f32_16x16x32_bf16 v[52:55], v[116:119], v[128:131], v[52:55]
ds_read_b128 v[108:111], v3 offset:6624
v_mfma_f32_16x16x32_bf16 v[56:59], v[112:115], v[132:135], v[56:59]
v_mfma_f32_16x16x32_bf16 v[60:63], v[116:119], v[132:135], v[60:63]
s_waitcnt lgkmcnt(6)
v_mfma_f32_16x16x32_bf16 v[32:35], v[64:67], v[72:75], v[32:35]
ds_read_b128 v[112:115], v2 offset:704
v_mfma_f32_16x16x32_bf16 v[36:39], v[68:71], v[72:75], v[36:39]
ds_read_b128 v[116:119], v2 offset:736
v_mfma_f32_16x16x32_bf16 v[40:43], v[64:67], v[76:79], v[40:43]
ds_read_b128 v[120:123], v3 offset:1920
v_mfma_f32_16x16x32_bf16 v[44:47], v[68:71], v[76:79], v[44:47]
ds_read_b128 v[124:127], v3 offset:3456
v_mfma_f32_16x16x32_bf16 v[48:51], v[64:67], v[80:83], v[48:51]
ds_read_b128 v[128:131], v3 offset:4992
v_mfma_f32_16x16x32_bf16 v[52:55], v[68:71], v[80:83], v[52:55]
ds_read_b128 v[132:135], v3 offset:6528
v_mfma_f32_16x16x32_bf16 v[56:59], v[64:67], v[84:87], v[56:59]
v_mfma_f32_16x16x32_bf16 v[60:63], v[68:71], v[84:87], v[60:63]
s_waitcnt lgkmcnt(6)
v_mfma_f32_16x16x32_bf16 v[32:35], v[88:91], v[96:99], v[32:35]
ds_read_b128 v[64:67], v2 offset:768
v_mfma_f32_16x16x32_bf16 v[36:39], v[92:95], v[96:99], v[36:39]
ds_read_b128 v[68:71], v2 offset:800
v_mfma_f32_16x16x32_bf16 v[40:43], v[88:91], v[100:103], v[40:43]
ds_read_b128 v[72:75], v3 offset:1824
v_mfma_f32_16x16x32_bf16 v[44:47], v[92:95], v[100:103], v[44:47]
ds_read_b128 v[76:79], v3 offset:3360
v_mfma_f32_16x16x32_bf16 v[48:51], v[88:91], v[104:107], v[48:51]
ds_read_b128 v[80:83], v3 offset:4896
v_mfma_f32_16x16x32_bf16 v[52:55], v[92:95], v[104:107], v[52:55]
ds_read_b128 v[84:87], v3 offset:6432
v_mfma_f32_16x16x32_bf16 v[56:59], v[88:91], v[108:111], v[56:59]
v_mfma_f32_16x16x32_bf16 v[60:63], v[92:95], v[108:111], v[60:63]
s_waitcnt lgkmcnt(6)
v_mfma_f32_16x16x32_bf16 v[32:35], v[112:115], v[120:123], v[32:35]
ds_read_b128 v[88:91], v2 offset:832
v_mfma_f32_16x16x32_bf16 v[36:39], v[116:119], v[120:123], v[36:39]
ds_read_b128 v[92:95], v2 offset:864
v_mfma_f32_16x16x32_bf16 v[40:43], v[112:115], v[124:127], v[40:43]
ds_read_b128 v[96:99], v3 offset:1728
v_mfma_f32_16x16x32_bf16 v[44:47], v[116:119], v[124:127], v[44:47]
ds_read_b128 v[100:103], v3 offset:3264
v_mfma_f32_16x16x32_bf16 v[48:51], v[112:115], v[128:131], v[48:51]
ds_read_b128 v[104:107], v3 offset:4800
v_mfma_f32_16x16x32_bf16 v[52:55], v[116:119], v[128:131], v[52:55]
ds_read_b128 v[108:111], v3 offset:6336
v_mfma_f32_16x16x32_bf16 v[56:59], v[112:115], v[132:135], v[56:59]
v_mfma_f32_16x16x32_bf16 v[60:63], v[116:119], v[132:135], v[60:63]
s_waitcnt lgkmcnt(6)
v_mfma_f32_16x16x32_bf16 v[32:35], v[64:67], v[72:75], v[32:35]
ds_read_b128 v[112:115], v2 offset:896
v_mfma_f32_16x16x32_bf16 v[36:39], v[68:71], v[72:75], v[36:39]
ds_read_b128 v[116:119], v2 offset:928
v_mfma_f32_16x16x32_bf16 v[40:43], v[64:67], v[76:79], v[40:43]
ds_read_b128 v[120:123], v3 offset:1632
v_mfma_f32_16x16x32_bf16 v[44:47], v[68:71], v[76:79], v[44:47]
ds_read_b128 v[124:127], v3 offset:3168
v_mfma_f32_16x16x32_bf16 v[48:51], v[64:67], v[80:83], v[48:51]
ds_read_b128 v[128:131], v3 offset:4704
v_mfma_f32_16x16x32_bf16 v[52:55], v[68:71], v[80:83], v[52:55]
ds_read_b128 v[132:135], v3 offset:6240
v_mfma_f32_16x16x32_bf16 v[56:59], v[64:67], v[84:87], v[56:59]
v_mfma_f32_16x16x32_bf16 v[60:63], v[68:71], v[84:87], v[60:63]
s_waitcnt lgkmcnt(6)
v_mfma_f32_16x16x32_bf16 v[32:35], v[88:91], v[96:99], v[32:35]
ds_read_b128 v[64:67], v2 offset:960
v_mfma_f32_16x16x32_bf16 v[36:39], v[92:95], v[96:99], v[36:39]
ds_read_b128 v[68:71], v2 offset:992
v_mfma_f32_16x16x32_bf16 v[40:43], v[88:91], v[100:103], v[40:43]
ds_read_b128 v[72:75], v3 offset:1536
v_mfma_f32_16x16x32_bf16 v[44:47], v[92:95], v[100:103], v[44:47]
ds_read_b128 v[76:79], v3 offset:3072
v_mfma_f32_16x16x32_bf16 v[48:51], v[88:91], v[104:107], v[48:51]
ds_read_b128 v[80:83], v3 offset:4608
v_mfma_f32_16x16x32_bf16 v[52:55], v[92:95], v[104:107], v[52:55]
ds_read_b128 v[84:87], v3 offset:6144
v_mfma_f32_16x16x32_bf16 v[56:59], v[88:91], v[108:111], v[56:59]
v_mfma_f32_16x16x32_bf16 v[60:63], v[92:95], v[108:111], v[60:63]
s_waitcnt lgkmcnt(6)
v_mfma_f32_16x16x32_bf16 v[32:35], v[112:115], v[120:123], v[32:35]
ds_read_b128 v[88:91], v2 offset:1024
v_mfma_f32_16x16x32_bf16 v[36:39], v[116:119], v[120:123], v[36:39]
ds_read_b128 v[92:95], v2 offset:1056
v_mfma_f32_16x16x32_bf16 v[40:43], v[112:115], v[124:127], v[40:43]
ds_read_b128 v[96:99], v3 offset:2976
v_mfma_f32_16x16x32_bf16 v[44:47], v[116:119], v[124:127], v[44:47]
ds_read_b128 v[100:103], v3 offset:4512
v_mfma_f32_16x16x32_bf16 v[48:51], v[112:115], v[128:131], v[48:51]
ds_read_b128 v[104:107], v3 offset:6048
v_mfma_f32_16x16x32_bf16 v[52:55], v[116:119], v[128:131], v[52:55]
v_mfma_f32_16x16x32_bf16 v[56:59], v[112:115], v[132:135], v[56:59]
v_mfma_f32_16x16x32_bf16 v[60:63], v[116:119], v[132:135], v[60:63]
s_waitcnt lgkmcnt(5)
v_mfma_f32_16x16x32_bf16 v[32:35], v[64:67], v[72:75], v[32:35]
ds_read_b128 v[112:115], v2 offset:1088
v_mfma_f32_16x16x32_bf16 v[36:39], v[68:71], v[72:75], v[36:39]
ds_read_b128 v[116:119], v2 offset:1120
v_mfma_f32_16x16x32_bf16 v[40:43], v[64:67], v[76:79], v[40:43]
ds_read_b128 v[120:123], v3 offset:2880
v_mfma_f32_16x16x32_bf16 v[44:47], v[68:71], v[76:79], v[44:47]
ds_read_b128 v[124:127], v3 offset:4416
v_mfma_f32_16x16x32_bf16 v[48:51], v[64:67], v[80:83], v[48:51]
ds_read_b128 v[128:131], v3 offset:5952
v_mfma_f32_16x16x32_bf16 v[52:55], v[68:71], v[80:83], v[52:55]
v_mfma_f32_16x16x32_bf16 v[56:59], v[64:67], v[84:87], v[56:59]
v_mfma_f32_16x16x32_bf16 v[60:63], v[68:71], v[84:87], v[60:63]
s_waitcnt lgkmcnt(5)
v_mfma_f32_16x16x32_bf16 v[40:43], v[88:91], v[96:99], v[40:43]
ds_read_b128 v[64:67], v2 offset:1152
v_mfma_f32_16x16x32_bf16 v[44:47], v[92:95], v[96:99], v[44:47]
ds_read_b128 v[68:71], v2 offset:1184
v_mfma_f32_16x16x32_bf16 v[48:51], v[88:91], v[100:103], v[48:51]
ds_read_b128 v[72:75], v3 offset:2784
v_mfma_f32_16x16x32_bf16 v[52:55], v[92:95], v[100:103], v[52:55]
ds_read_b128 v[76:79], v3 offset:4320
v_mfma_f32_16x16x32_bf16 v[56:59], v[88:91], v[104:107], v[56:59]
ds_read_b128 v[80:83], v3 offset:5856
v_mfma_f32_16x16x32_bf16 v[60:63], v[92:95], v[104:107], v[60:63]
s_waitcnt lgkmcnt(5)
v_mfma_f32_16x16x32_bf16 v[40:43], v[112:115], v[120:123], v[40:43]
ds_read_b128 v[88:91], v2 offset:1216
v_mfma_f32_16x16x32_bf16 v[44:47], v[116:119], v[120:123], v[44:47]
ds_read_b128 v[92:95], v2 offset:1248
v_mfma_f32_16x16x32_bf16 v[48:51], v[112:115], v[124:127], v[48:51]
ds_read_b128 v[96:99], v3 offset:2688
v_mfma_f32_16x16x32_bf16 v[52:55], v[116:119], v[124:127], v[52:55]
ds_read_b128 v[100:103], v3 offset:4224
v_mfma_f32_16x16x32_bf16 v[56:59], v[112:115], v[128:131], v[56:59]
ds_read_b128 v[104:107], v3 offset:5760
v_mfma_f32_16x16x32_bf16 v[60:63], v[116:119], v[128:131], v[60:63]
s_waitcnt lgkmcnt(5)
v_mfma_f32_16x16x32_bf16 v[40:43], v[64:67], v[72:75], v[40:43]
ds_read_b128 v[112:115], v2 offset:1280
v_mfma_f32_16x16x32_bf16 v[44:47], v[68:71], v[72:75], v[44:47]
ds_read_b128 v[116:119], v2 offset:1312
v_mfma_f32_16x16x32_bf16 v[48:51], v[64:67], v[76:79], v[48:51]
ds_read_b128 v[120:123], v3 offset:2592
v_mfma_f32_16x16x32_bf16 v[52:55], v[68:71], v[76:79], v[52:55]
ds_read_b128 v[124:127], v3 offset:4128
v_mfma_f32_16x16x32_bf16 v[56:59], v[64:67], v[80:83], v[56:59]
ds_read_b128 v[128:131], v3 offset:5664
v_mfma_f32_16x16x32_bf16 v[60:63], v[68:71], v[80:83], v[60:63]
s_waitcnt lgkmcnt(5)
v_mfma_f32_16x16x32_bf16 v[40:43], v[88:91], v[96:99], v[40:43]
ds_read_b128 v[64:67], v2 offset:1344
v_mfma_f32_16x16x32_bf16 v[44:47], v[92:95], v[96:99], v[44:47]
ds_read_b128 v[68:71], v2 offset:1376
v_mfma_f32_16x16x32_bf16 v[48:51], v[88:91], v[100:103], v[48:51]
ds_read_b128 v[72:75], v3 offset:2496
v_mfma_f32_16x16x32_bf16 v[52:55], v[92:95], v[100:103], v[52:55]
ds_read_b128 v[76:79], v3 offset:4032
v_mfma_f32_16x16x32_bf16 v[56:59], v[88:91], v[104:107], v[56:59]
ds_read_b128 v[80:83], v3 offset:5568
v_mfma_f32_16x16x32_bf16 v[60:63], v[92:95], v[104:107], v[60:63]
s_waitcnt lgkmcnt(5)
v_mfma_f32_16x16x32_bf16 v[40:43], v[112:115], v[120:123], v[40:43]
ds_read_b128 v[88:91], v2 offset:1408
v_mfma_f32_16x16x32_bf16 v[44:47], v[116:119], v[120:123], v[44:47]
ds_read_b128 v[92:95], v2 offset:1440
v_mfma_f32_16x16x32_bf16 v[48:51], v[112:115], v[124:127], v[48:51]
ds_read_b128 v[96:99], v3 offset:2400
v_mfma_f32_16x16x32_bf16 v[52:55], v[116:119], v[124:127], v[52:55]
ds_read_b128 v[100:103], v3 offset:3936
v_mfma_f32_16x16x32_bf16 v[56:59], v[112:115], v[128:131], v[56:59]
ds_read_b128 v[104:107], v3 offset:5472
v_mfma_f32_16x16x32_bf16 v[60:63], v[116:119], v[128:131], v[60:63]
s_waitcnt lgkmcnt(5)
v_mfma_f32_16x16x32_bf16 v[40:43], v[64:67], v[72:75], v[40:43]
v_mfma_f32_16x16x32_bf16 v[44:47], v[68:71], v[72:75], v[44:47]
v_mfma_f32_16x16x32_bf16 v[48:51], v[64:67], v[76:79], v[48:51]
v_mfma_f32_16x16x32_bf16 v[52:55], v[68:71], v[76:79], v[52:55]
v_mfma_f32_16x16x32_bf16 v[56:59], v[64:67], v[80:83], v[56:59]
v_mfma_f32_16x16x32_bf16 v[60:63], v[68:71], v[80:83], v[60:63]
s_waitcnt lgkmcnt(0)
v_mfma_f32_16x16x32_bf16 v[40:43], v[88:91], v[96:99], v[40:43]
v_mfma_f32_16x16x32_bf16 v[44:47], v[92:95], v[96:99], v[44:47]
v_mfma_f32_16x16x32_bf16 v[48:51], v[88:91], v[100:103], v[48:51]
v_mfma_f32_16x16x32_bf16 v[52:55], v[92:95], v[100:103], v[52:55]
v_mfma_f32_16x16x32_bf16 v[56:59], v[88:91], v[104:107], v[56:59]
v_mfma_f32_16x16x32_bf16 v[60:63], v[92:95], v[104:107], v[60:63]
s_nop 7
s_nop 3
ds_write_b128 v4, v[48:51] offset:0
ds_write_b128 v4, v[52:55] offset:1024
ds_write_b128 v4, v[56:59] offset:2048
ds_write_b128 v4, v[60:63] offset:3072
ds_read_b64 v[64:65], v6 offset:0
ds_read_b64 v[66:67], v6 offset:32
ds_read_b64 v[68:69], v6 offset:1536
ds_read_b64 v[70:71], v6 offset:1568
s_waitcnt lgkmcnt(0)
v_mov_b32 v72, 1
ds_write_b32 v7, v72
s_mov_b32 s63, 0x400000
K2_pollA:
ds_read_b32 v73, v8
s_waitcnt lgkmcnt(0)
v_readfirstlane_b32 s40, v73
s_sub_u32 s63, s63, 1
s_cmp_eq_u32 s63, 0
s_cbranch_scc1 K2_pollxA
s_cmp_eq_u32 s40, 1
s_cbranch_scc0 K2_pollA
K2_pollxA:
ds_read_b128 v[80:83], v5 offset:0
ds_read_b128 v[84:87], v5 offset:1024
ds_read_b128 v[88:91], v5 offset:2048
ds_read_b128 v[92:95], v5 offset:3072
v_lshlrev_b32 v96, 16, v64
v_and_b32 v97, 0xffff0000, v64
v_lshlrev_b32 v98, 16, v65
v_and_b32 v99, 0xffff0000, v65
v_lshlrev_b32 v100, 16, v66
v_and_b32 v101, 0xffff0000, v66
v_lshlrev_b32 v102, 16, v67
v_and_b32 v103, 0xffff0000, v67
v_lshlrev_b32 v104, 16, v68
v_and_b32 v105, 0xffff0000, v68
v_lshlrev_b32 v106, 16, v69
v_and_b32 v107, 0xffff0000, v69
v_lshlrev_b32 v108, 16, v70
v_and_b32 v109, 0xffff0000, v70
v_lshlrev_b32 v110, 16, v71
v_and_b32 v111, 0xffff0000, v71
s_waitcnt vmcnt(0)
v_lshlrev_b32 v112, 16, v144
v_and_b32 v113, 0xffff0000, v144
v_lshlrev_b32 v114, 16, v145
v_and_b32 v115, 0xffff0000, v145
v_lshlrev_b32 v116, 16, v146
v_and_b32 v117, 0xffff0000, v146
v_lshlrev_b32 v118, 16, v147
v_and_b32 v119, 0xffff0000, v147
v_lshlrev_b32 v120, 16, v148
v_and_b32 v121, 0xffff0000, v148
v_lshlrev_b32 v122, 16, v149
v_and_b32 v123, 0xffff0000, v149
v_lshlrev_b32 v124, 16, v150
v_and_b32 v125, 0xffff0000, v150
v_lshlrev_b32 v126, 16, v151
v_and_b32 v127, 0xffff0000, v151
s_waitcnt lgkmcnt(0)
v_pk_add_f32 v[32:33], v[32:33], v[80:81]
v_pk_add_f32 v[34:35], v[34:35], v[82:83]
v_pk_add_f32 v[36:37], v[36:37], v[84:85]
v_pk_add_f32 v[38:39], v[38:39], v[86:87]
v_pk_add_f32 v[40:41], v[40:41], v[88:89]
v_pk_add_f32 v[42:43], v[42:43], v[90:91]
v_pk_add_f32 v[44:45], v[44:45], v[92:93]
v_pk_add_f32 v[46:47], v[46:47], v[94:95]
v_pk_fma_f32 v[32:33], v[96:97], s[36:37], v[32:33] op_sel_hi:[1,0,1]
v_pk_fma_f32 v[34:35], v[98:99], s[36:37], v[34:35] op_sel_hi:[1,0,1]
v_pk_fma_f32 v[36:37], v[100:101], s[36:37], v[36:37] op_sel_hi:[1,0,1]
v_pk_fma_f32 v[38:39], v[102:103], s[36:37], v[38:39] op_sel_hi:[1,0,1]
v_pk_fma_f32 v[40:41], v[104:105], s[36:37], v[40:41] op_sel_hi:[1,0,1]
v_pk_fma_f32 v[42:43], v[106:107], s[36:37], v[42:43] op_sel_hi:[1,0,1]
v_pk_fma_f32 v[44:45], v[108:109], s[36:37], v[44:45] op_sel_hi:[1,0,1]
v_pk_fma_f32 v[46:47], v[110:111], s[36:37], v[46:47] op_sel_hi:[1,0,1]
v_pk_fma_f32 v[32:33], v[32:33], s[36:37], v[112:113] op_sel:[0,1,0] op_sel_hi:[1,1,1]
v_pk_fma_f32 v[34:35], v[34:35], s[36:37], v[114:115] op_sel:[0,1,0] op_sel_hi:[1,1,1]
v_pk_fma_f32 v[36:37], v[36:37], s[36:37], v[116:117] op_sel:[0,1,0] op_sel_hi:[1,1,1]
v_pk_fma_f32 v[38:39], v[38:39], s[36:37], v[118:119] op_sel:[0,1,0] op_sel_hi:[1,1,1]
v_pk_fma_f32 v[40:41], v[40:41], s[36:37], v[120:121] op_sel:[0,1,0] op_sel_hi:[1,1,1]
v_pk_fma_f32 v[42:43], v[42:43], s[36:37], v[122:123] op_sel:[0,1,0] op_sel_hi:[1,1,1]
v_pk_fma_f32 v[44:45], v[44:45], s[36:37], v[124:125] op_sel:[0,1,0] op_sel_hi:[1,1,1]
v_pk_fma_f32 v[46:47], v[46:47], s[36:37], v[126:127] op_sel:[0,1,0] op_sel_hi:[1,1,1]
v_cvt_pk_bf16_f32 v64, v32, v33
v_cvt_pk_bf16_f32 v65, v34, v35
v_cvt_pk_bf16_f32 v66, v36, v37
v_cvt_pk_bf16_f32 v67, v38, v39
v_cvt_pk_bf16_f32 v68, v40, v41
v_cvt_pk_bf16_f32 v69, v42, v43
v_cvt_pk_bf16_f32 v70, v44, v45
v_cvt_pk_bf16_f32 v71, v46, v47
ds_write_b64 v10, v[64:65] offset:0
ds_write_b64 v10, v[66:67] offset:32
ds_write_b64 v10, v[68:69] offset:1280
ds_write_b64 v10, v[70:71] offset:1312
s_waitcnt lgkmcnt(0)
ds_read_b128 v[72:75], v11
ds_read_b128 v[76:79], v11 offset:1280
s_waitcnt lgkmcnt(1)
global_store_dwordx4 v9, v[72:75], s[14:15] sc1
s_waitcnt lgkmcnt(0)
global_store_dwordx4 v12, v[76:79], s[14:15] sc1
s_branch K2_END
K2_B:
ds_read_b128 v[64:67], v2 offset:1472
ds_read_b128 v[68:71], v2 offset:1504
ds_read_b128 v[72:75], v3 offset:2304
ds_read_b128 v[76:79], v3 offset:3840
ds_read_b128 v[80:83], v3 offset:5376
ds_read_b128 v[84:87], v2 offset:1536
ds_read_b128 v[88:91], v2 offset:1568
ds_read_b128 v[92:95], v3 offset:2208
ds_read_b128 v[96:99], v3 offset:3744
ds_read_b128 v[100:103], v3 offset:5280
ds_read_b128 v[104:107], v2 offset:1600
ds_read_b128 v[108:111], v2 offset:1632
ds_read_b128 v[112:115], v3 offset:2112
ds_read_b128 v[116:119], v3 offset:3648
ds_read_b128 v[120:123], v3 offset:5184
s_waitcnt lgkmcnt(10)
v_mfma_f32_16x16x32_bf16 v[40:43], v[64:67], v[72:75], v[40:43]
ds_read_b128 v[124:127], v2 offset:1664
v_mfma_f32_16x16x32_bf16 v[44:47], v[68:71], v[72:75], v[44:47]
ds_read_b128 v[128:131], v2 offset:1696
v_mfma_f32_16x16x32_bf16 v[48:51], v[64:67], v[76:79], v[48:51]
ds_read_b128 v[132:135], v3 offset:2016
v_mfma_f32_16x16x32_bf16 v[52:55], v[68:71], v[76:79], v[52:55]
ds_read_b128 v[136:139], v3 offset:3552
v_mfma_f32_16x16x32_bf16 v[56:59], v[64:67], v[80:83], v[56:59]
ds_read_b128 v[140:143], v3 offset:5088
v_mfma_f32_16x16x32_bf16 v[60:63], v[68:71], v[80:83], v[60:63]
s_waitcnt lgkmcnt(10)
v_mfma_f32_16x16x32_bf16 v[40:43], v[84:87], v[92:95], v[40:43]
ds_read_b128 v[64:67], v2 offset:1728
v_mfma_f32_16x16x32_bf16 v[44:47], v[88:91], v[92:95], v[44:47]
ds_read_b128 v[68:71], v2 offset:1760
v_mfma_f32_16x16x32_bf16 v[48:51], v[84:87], v[96:99], v[48:51]
ds_read_b128 v[72:75], v3 offset:1920
v_mfma_f32_16x16x32_bf16 v[52:55], v[88:91], v[96:99], v[52:55]
ds_read_b128 v[76:79], v3 offset:3456
v_mfma_f32_16x16x32_bf16 v[56:59], v[84:87], v[100:103], v[56:59]
ds_read_b128 v[80:83], v3 offset:4992
v_mfma_f32_16x16x32_bf16 v[60:63], v[88:91], v[100:103], v[60:63]
s_waitcnt lgkmcnt(10)
v_mfma_f32_16x16x32_bf16 v[40:43], v[104:107], v[112:115], v[40:43]
ds_read_b128 v[84:87], v2 offset:1792
v_mfma_f32_16x16x32_bf16 v[44:47], v[108:111], v[112:115], v[44:47]
ds_read_b128 v[88:91], v2 offset:1824
v_mfma_f32_16x16x32_bf16 v[48:51], v[104:107], v[116:119], v[48:51]
ds_read_b128 v[92:95], v3 offset:1824
v_mfma_f32_16x16x32_bf16 v[52:55], v[108:111], v[116:119], v[52:55]
ds_read_b128 v[96:99], v3 offset:3360
v_mfma_f32_16x16x32_bf16 v[56:59], v[104:107], v[120:123], v[56:59]
ds_read_b128 v[100:103], v3 offset:4896
v_mfma_f32_16x16x32_bf16 v[60:63], v[108:111], v[120:123], v[60:63]
s_waitcnt lgkmcnt(10)
v_mfma_f32_16x16x32_bf16 v[40:43], v[124:127], v[132:135], v[40:43]
ds_read_b128 v[104:107], v2 offset:1856
v_mfma_f32_16x16x32_bf16 v[44:47], v[128:131], v[132:135], v[44:47]
ds_read_b128 v[108:111], v2 offset:1888
v_mfma_f32_16x16x32_bf16 v[48:51], v[124:127], v[136:139], v[48:51]
ds_read_b128 v[112:115], v3 offset:1728
v_mfma_f32_16x16x32_bf16 v[52:55], v[128:131], v[136:139], v[52:55]
ds_read_b128 v[116:119], v3 offset:3264
v_mfma_f32_16x16x32_bf16 v[56:59], v[124:127], v[140:143], v[56:59]
ds_read_b128 v[120:123], v3 offset:4800
v_mfma_f32_16x16x32_bf16 v[60:63], v[128:131], v[140:143], v[60:63]
s_waitcnt lgkmcnt(10)
v_mfma_f32_16x16x32_bf16 v[40:43], v[64:67], v[72:75], v[40:43]
ds_read_b128 v[124:127], v2 offset:1920
v_mfma_f32_16x16x32_bf16 v[44:47], v[68:71], v[72:75], v[44:47]
ds_read_b128 v[128:131], v2 offset:1952
v_mfma_f32_16x16x32_bf16 v[48:51], v[64:67], v[76:79], v[48:51]
ds_read_b128 v[132:135], v3 offset:1632
v_mfma_f32_16x16x32_bf16 v[52:55], v[68:71], v[76:79], v[52:55]
ds_read_b128 v[136:139], v3 offset:3168
v_mfma_f32_16x16x32_bf16 v[56:59], v[64:67], v[80:83], v[56:59]
ds_read_b128 v[140:143], v3 offset:4704
v_mfma_f32_16x16x32_bf16 v[60:63], v[68:71], v[80:83], v[60:63]
s_waitcnt lgkmcnt(10)
v_mfma_f32_16x16x32_bf16 v[40:43], v[84:87], v[92:95], v[40:43]
ds_read_b128 v[64:67], v2 offset:1984
v_mfma_f32_16x16x32_bf16 v[44:47], v[88:91], v[92:95], v[44:47]
ds_read_b128 v[68:71], v2 offset:2016
v_mfma_f32_16x16x32_bf16 v[48:51], v[84:87], v[96:99], v[48:51]
ds_read_b128 v[72:75], v3 offset:1536
v_mfma_f32_16x16x32_bf16 v[52:55], v[88:91], v[96:99], v[52:55]
ds_read_b128 v[76:79], v3 offset:3072
v_mfma_f32_16x16x32_bf16 v[56:59], v[84:87], v[100:103], v[56:59]
ds_read_b128 v[80:83], v3 offset:4608
v_mfma_f32_16x16x32_bf16 v[60:63], v[88:91], v[100:103], v[60:63]
s_waitcnt lgkmcnt(10)
v_mfma_f32_16x16x32_bf16 v[40:43], v[104:107], v[112:115], v[40:43]
ds_read_b128 v[84:87], v2 offset:2048
v_mfma_f32_16x16x32_bf16 v[44:47], v[108:111], v[112:115], v[44:47]
ds_read_b128 v[88:91], v2 offset:2080
v_mfma_f32_16x16x32_bf16 v[48:51], v[104:107], v[116:119], v[48:51]
ds_read_b128 v[92:95], v3 offset:2976
v_mfma_f32_16x16x32_bf16 v[52:55], v[108:111], v[116:119], v[52:55]
ds_read_b128 v[96:99], v3 offset:4512
v_mfma_f32_16x16x32_bf16 v[56:59], v[104:107], v[120:123], v[56:59]
v_mfma_f32_16x16x32_bf16 v[60:63], v[108:111], v[120:123], v[60:63]
s_waitcnt lgkmcnt(9)
v_mfma_f32_16x16x32_bf16 v[40:43], v[124:127], v[132:135], v[40:43]
ds_read_b128 v[104:107], v2 offset:2112
v_mfma_f32_16x16x32_bf16 v[44:47], v[128:131], v[132:135], v[44:47]
ds_read_b128 v[108:111], v2 offset:2144
v_mfma_f32_16x16x32_bf16 v[48:51], v[124:127], v[136:139], v[48:51]
ds_read_b128 v[112:115], v3 offset:2880
v_mfma_f32_16x16x32_bf16 v[52:55], v[128:131], v[136:139], v[52:55]
ds_read_b128 v[116:119], v3 offset:4416
v_mfma_f32_16x16x32_bf16 v[56:59], v[124:127], v[140:143], v[56:59]
v_mfma_f32_16x16x32_bf16 v[60:63], v[128:131], v[140:143], v[60:63]
s_waitcnt lgkmcnt(8)
v_mfma_f32_16x16x32_bf16 v[40:43], v[64:67], v[72:75], v[40:43]
ds_read_b128 v[124:127], v2 offset:2176
v_mfma_f32_16x16x32_bf16 v[44:47], v[68:71], v[72:75], v[44:47]
ds_read_b128 v[128:131], v2 offset:2208
v_mfma_f32_16x16x32_bf16 v[48:51], v[64:67], v[76:79], v[48:51]
ds_read_b128 v[132:135], v3 offset:2784
v_mfma_f32_16x16x32_bf16 v[52:55], v[68:71], v[76:79], v[52:55]
ds_read_b128 v[136:139], v3 offset:4320
v_mfma_f32_16x16x32_bf16 v[56:59], v[64:67], v[80:83], v[56:59]
v_mfma_f32_16x16x32_bf16 v[60:63], v[68:71], v[80:83], v[60:63]
s_waitcnt lgkmcnt(8)
v_mfma_f32_16x16x32_bf16 v[48:51], v[84:87], v[92:95], v[48:51]
ds_read_b128 v[64:67], v2 offset:2240
v_mfma_f32_16x16x32_bf16 v[52:55], v[88:91], v[92:95], v[52:55]
ds_read_b128 v[68:71], v2 offset:2272
v_mfma_f32_16x16x32_bf16 v[56:59], v[84:87], v[96:99], v[56:59]
ds_read_b128 v[72:75], v3 offset:2688
v_mfma_f32_16x16x32_bf16 v[60:63], v[88:91], v[96:99], v[60:63]
ds_read_b128 v[76:79], v3 offset:4224
s_waitcnt lgkmcnt(8)
v_mfma_f32_16x16x32_bf16 v[48:51], v[104:107], v[112:115], v[48:51]
ds_read_b128 v[84:87], v2 offset:2304
v_mfma_f32_16x16x32_bf16 v[52:55], v[108:111], v[112:115], v[52:55]
ds_read_b128 v[88:91], v2 offset:2336
v_mfma_f32_16x16x32_bf16 v[56:59], v[104:107], v[116:119], v[56:59]
ds_read_b128 v[92:95], v3 offset:2592
v_mfma_f32_16x16x32_bf16 v[60:63], v[108:111], v[116:119], v[60:63]
ds_read_b128 v[96:99], v3 offset:4128
s_waitcnt lgkmcnt(8)
v_mfma_f32_16x16x32_bf16 v[48:51], v[124:127], v[132:135], v[48:51]
ds_read_b128 v[104:107], v2 offset:2368
v_mfma_f32_16x16x32_bf16 v[52:55], v[128:131], v[132:135], v[52:55]
ds_read_b128 v[108:111], v2 offset:2400
v_mfma_f32_16x16x32_bf16 v[56:59], v[124:127], v[136:139], v[56:59]
ds_read_b128 v[112:115], v3 offset:2496
v_mfma_f32_16x16x32_bf16 v[60:63], v[128:131], v[136:139], v[60:63]
ds_read_b128 v[116:119], v3 offset:4032
s_waitcnt lgkmcnt(8)
v_mfma_f32_16x16x32_bf16 v[48:51], v[64:67], v[72:75], v[48:51]
ds_read_b128 v[124:127], v2 offset:2432
v_mfma_f32_16x16x32_bf16 v[52:55], v[68:71], v[72:75], v[52:55]
ds_read_b128 v[128:131], v2 offset:2464
v_mfma_f32_16x16x32_bf16 v[56:59], v[64:67], v[76:79], v[56:59]
ds_read_b128 v[132:135], v3 offset:2400
v_mfma_f32_16x16x32_bf16 v[60:63], v[68:71], v[76:79], v[60:63]
ds_read_b128 v[136:139], v3 offset:3936
s_waitcnt lgkmcnt(8)
v_mfma_f32_16x16x32_bf16 v[48:51], v[84:87], v[92:95], v[48:51]
ds_read_b128 v[64:67], v2 offset:2496
v_mfma_f32_16x16x32_bf16 v[52:55], v[88:91], v[92:95], v[52:55]
ds_read_b128 v[68:71], v2 offset:2528
v_mfma_f32_16x16x32_bf16 v[56:59], v[84:87], v[96:99], v[56:59]
ds_read_b128 v[72:75], v3 offset:2304
v_mfma_f32_16x16x32_bf16 v[60:63], v[88:91], v[96:99], v[60:63]
ds_read_b128 v[76:79], v3 offset:3840
s_waitcnt lgkmcnt(8)
v_mfma_f32_16x16x32_bf16 v[48:51], v[104:107], v[112:115], v[48:51]
ds_read_b128 v[84:87], v2 offset:2560
v_mfma_f32_16x16x32_bf16 v[52:55], v[108:111], v[112:115], v[52:55]
ds_read_b128 v[88:91], v2 offset:2592
v_mfma_f32_16x16x32_bf16 v[56:59], v[104:107], v[116:119], v[56:59]
ds_read_b128 v[92:95], v3 offset:2208
v_mfma_f32_16x16x32_bf16 v[60:63], v[108:111], v[116:119], v[60:63]
ds_read_b128 v[96:99], v3 offset:3744
s_waitcnt lgkmcnt(8)
v_mfma_f32_16x16x32_bf16 v[48:51], v[124:127], v[132:135], v[48:51]
ds_read_b128 v[104:107], v2 offset:2624
v_mfma_f32_16x16x32_bf16 v[52:55], v[128:131], v[132:135], v[52:55]
ds_read_b128 v[108:111], v2 offset:2656
v_mfma_f32_16x16x32_bf16 v[56:59], v[124:127], v[136:139], v[56:59]
ds_read_b128 v[112:115], v3 offset:2112
v_mfma_f32_16x16x32_bf16 v[60:63], v[128:131], v[136:139], v[60:63]
ds_read_b128 v[116:119], v3 offset:3648
s_waitcnt lgkmcnt(8)
v_mfma_f32_16x16x32_bf16 v[48:51], v[64:67], v[72:75], v[48:51]
ds_read_b128 v[124:127], v2 offset:2688
v_mfma_f32_16x16x32_bf16 v[52:55], v[68:71], v[72:75], v[52:55]
ds_read_b128 v[128:131], v2 offset:2720
v_mfma_f32_16x16x32_bf16 v[56:59], v[64:67], v[76:79], v[56:59]
ds_read_b128 v[132:135], v3 offset:2016
v_mfma_f32_16x16x32_bf16 v[60:63], v[68:71], v[76:79], v[60:63]
ds_read_b128 v[136:139], v3 offset:3552
s_waitcnt lgkmcnt(8)
v_mfma_f32_16x16x32_bf16 v[48:51], v[84:87], v[92:95], v[48:51]
ds_read_b128 v[64:67], v2 offset:2752
v_mfma_f32_16x16x32_bf16 v[52:55], v[88:91], v[92:95], v[52:55]
ds_read_b128 v[68:71], v2 offset:2784
v_mfma_f32_16x16x32_bf16 v[56:59], v[84:87], v[96:99], v[56:59]
ds_read_b128 v[72:75], v3 offset:1920
v_mfma_f32_16x16x32_bf16 v[60:63], v[88:91], v[96:99], v[60:63]
ds_read_b128 v[76:79], v3 offset:3456
s_waitcnt lgkmcnt(8)
v_mfma_f32_16x16x32_bf16 v[48:51], v[104:107], v[112:115], v[48:51]
ds_read_b128 v[84:87], v2 offset:2816
v_mfma_f32_16x16x32_bf16 v[52:55], v[108:111], v[112:115], v[52:55]
ds_read_b128 v[88:91], v2 offset:2848
v_mfma_f32_16x16x32_bf16 v[56:59], v[104:107], v[116:119], v[56:59]
ds_read_b128 v[92:95], v3 offset:1824
v_mfma_f32_16x16x32_bf16 v[60:63], v[108:111], v[116:119], v[60:63]
ds_read_b128 v[96:99], v3 offset:3360
s_waitcnt lgkmcnt(8)
v_mfma_f32_16x16x32_bf16 v[48:51], v[124:127], v[132:135], v[48:51]
ds_read_b128 v[104:107], v2 offset:2880
v_mfma_f32_16x16x32_bf16 v[52:55], v[128:131], v[132:135], v[52:55]
ds_read_b128 v[108:111], v2 offset:2912
v_mfma_f32_16x16x32_bf16 v[56:59], v[124:127], v[136:139], v[56:59]
ds_read_b128 v[112:115], v3 offset:1728
v_mfma_f32_16x16x32_bf16 v[60:63], v[128:131], v[136:139], v[60:63]
ds_read_b128 v[116:119], v3 offset:3264
s_waitcnt lgkmcnt(8)
v_mfma_f32_16x16x32_bf16 v[48:51], v[64:67], v[72:75], v[48:51]
ds_read_b128 v[124:127], v2 offset:2944
v_mfma_f32_16x16x32_bf16 v[52:55], v[68:71], v[72:75], v[52:55]
ds_read_b128 v[128:131], v2 offset:2976
v_mfma_f32_16x16x32_bf16 v[56:59], v[64:67], v[76:79], v[56:59]
ds_read_b128 v[132:135], v3 offset:1632
v_mfma_f32_16x16x32_bf16 v[60:63], v[68:71], v[76:79], v[60:63]
ds_read_b128 v[136:139], v3 offset:3168
s_waitcnt lgkmcnt(8)
v_mfma_f32_16x16x32_bf16 v[48:51], v[84:87], v[92:95], v[48:51]
ds_read_b128 v[64:67], v2 offset:3008
v_mfma_f32_16x16x32_bf16 v[52:55], v[88:91], v[92:95], v[52:55]
ds_read_b128 v[68:71], v2 offset:3040
v_mfma_f32_16x16x32_bf16 v[56:59], v[84:87], v[96:99], v[56:59]
ds_read_b128 v[72:75], v3 offset:1536
v_mfma_f32_16x16x32_bf16 v[60:63], v[88:91], v[96:99], v[60:63]
ds_read_b128 v[76:79], v3 offset:3072
s_waitcnt lgkmcnt(8)
v_mfma_f32_16x16x32_bf16 v[48:51], v[104:107], v[112:115], v[48:51]
ds_read_b128 v[84:87], v2 offset:3072
v_mfma_f32_16x16x32_bf16 v[52:55], v[108:111], v[112:115], v[52:55]
ds_read_b128 v[88:91], v2 offset:3104
v_mfma_f32_16x16x32_bf16 v[56:59], v[104:107], v[116:119], v[56:59]
ds_read_b128 v[92:95], v3 offset:2976
v_mfma_f32_16x16x32_bf16 v[60:63], v[108:111], v[116:119], v[60:63]
s_waitcnt lgkmcnt(7)
v_mfma_f32_16x16x32_bf16 v[48:51], v[124:127], v[132:135], v[48:51]
ds_read_b128 v[104:107], v2 offset:3136
v_mfma_f32_16x16x32_bf16 v[52:55], v[128:131], v[132:135], v[52:55]
ds_read_b128 v[108:111], v2 offset:3168
v_mfma_f32_16x16x32_bf16 v[56:59], v[124:127], v[136:139], v[56:59]
ds_read_b128 v[112:115], v3 offset:2880
v_mfma_f32_16x16x32_bf16 v[60:63], v[128:131], v[136:139], v[60:63]
s_waitcnt lgkmcnt(6)
v_mfma_f32_16x16x32_bf16 v[48:51], v[64:67], v[72:75], v[48:51]
ds_read_b128 v[124:127], v2 offset:3200
v_mfma_f32_16x16x32_bf16 v[52:55], v[68:71], v[72:75], v[52:55]
ds_read_b128 v[128:131], v2 offset:3232
v_mfma_f32_16x16x32_bf16 v[56:59], v[64:67], v[76:79], v[56:59]
ds_read_b128 v[132:135], v3 offset:2784
v_mfma_f32_16x16x32_bf16 v[60:63], v[68:71], v[76:79], v[60:63]
s_waitcnt lgkmcnt(6)
v_mfma_f32_16x16x32_bf16 v[56:59], v[84:87], v[92:95], v[56:59]
ds_read_b128 v[64:67], v2 offset:3264
ds_read_b128 v[68:71], v2 offset:3296
v_mfma_f32_16x16x32_bf16 v[60:63], v[88:91], v[92:95], v[60:63]
ds_read_b128 v[72:75], v3 offset:2688
s_waitcnt lgkmcnt(6)
v_mfma_f32_16x16x32_bf16 v[56:59], v[104:107], v[112:115], v[56:59]
ds_read_b128 v[84:87], v2 offset:3328
ds_read_b128 v[88:91], v2 offset:3360
v_mfma_f32_16x16x32_bf16 v[60:63], v[108:111], v[112:115], v[60:63]
ds_read_b128 v[92:95], v3 offset:2592
s_waitcnt lgkmcnt(6)
v_mfma_f32_16x16x32_bf16 v[56:59], v[124:127], v[132:135], v[56:59]
ds_read_b128 v[104:107], v2 offset:3392
ds_read_b128 v[108:111], v2 offset:3424
v_mfma_f32_16x16x32_bf16 v[60:63], v[128:131], v[132:135], v[60:63]
ds_read_b128 v[112:115], v3 offset:2496
s_waitcnt lgkmcnt(6)
v_mfma_f32_16x16x32_bf16 v[56:59], v[64:67], v[72:75], v[56:59]
ds_read_b128 v[124:127], v2 offset:3456
ds_read_b128 v[128:131], v2 offset:3488
v_mfma_f32_16x16x32_bf16 v[60:63], v[68:71], v[72:75], v[60:63]
ds_read_b128 v[132:135], v3 offset:2400
s_waitcnt lgkmcnt(6)
v_mfma_f32_16x16x32_bf16 v[56:59], v[84:87], v[92:95], v[56:59]
ds_read_b128 v[64:67], v2 offset:3520
ds_read_b128 v[68:71], v2 offset:3552
v_mfma_f32_16x16x32_bf16 v[60:63], v[88:91], v[92:95], v[60:63]
ds_read_b128 v[72:75], v3 offset:2304
s_waitcnt lgkmcnt(6)
v_mfma_f32_16x16x32_bf16 v[56:59], v[104:107], v[112:115], v[56:59]
ds_read_b128 v[84:87], v2 offset:3584
ds_read_b128 v[88:91], v2 offset:3616
v_mfma_f32_16x16x32_bf16 v[60:63], v[108:111], v[112:115], v[60:63]
ds_read_b128 v[92:95], v3 offset:2208
s_waitcnt lgkmcnt(6)
v_mfma_f32_16x16x32_bf16 v[56:59], v[124:127], v[132:135], v[56:59]
ds_read_b128 v[104:107], v2 offset:3648
ds_read_b128 v[108:111], v2 offset:3680
v_mfma_f32_16x16x32_bf16 v[60:63], v[128:131], v[132:135], v[60:63]
ds_read_b128 v[112:115], v3 offset:2112
s_waitcnt lgkmcnt(6)
v_mfma_f32_16x16x32_bf16 v[56:59], v[64:67], v[72:75], v[56:59]
ds_read_b128 v[124:127], v2 offset:3712
ds_read_b128 v[128:131], v2 offset:3744
v_mfma_f32_16x16x32_bf16 v[60:63], v[68:71], v[72:75], v[60:63]
ds_read_b128 v[132:135], v3 offset:2016
s_waitcnt lgkmcnt(6)
v_mfma_f32_16x16x32_bf16 v[56:59], v[84:87], v[92:95], v[56:59]
ds_read_b128 v[64:67], v2 offset:3776
ds_read_b128 v[68:71], v2 offset:3808
v_mfma_f32_16x16x32_bf16 v[60:63], v[88:91], v[92:95], v[60:63]
ds_read_b128 v[72:75], v3 offset:1920
s_waitcnt lgkmcnt(6)
v_mfma_f32_16x16x32_bf16 v[56:59], v[104:107], v[112:115], v[56:59]
ds_read_b128 v[84:87], v2 offset:3840
ds_read_b128 v[88:91], v2 offset:3872
v_mfma_f32_16x16x32_bf16 v[60:63], v[108:111], v[112:115], v[60:63]
ds_read_b128 v[92:95], v3 offset:1824
s_waitcnt lgkmcnt(6)
v_mfma_f32_16x16x32_bf16 v[56:59], v[124:127], v[132:135], v[56:59]
ds_read_b128 v[104:107], v2 offset:3904
ds_read_b128 v[108:111], v2 offset:3936
v_mfma_f32_16x16x32_bf16 v[60:63], v[128:131], v[132:135], v[60:63]
ds_read_b128 v[112:115], v3 offset:1728
s_waitcnt lgkmcnt(6)
v_mfma_f32_16x16x32_bf16 v[56:59], v[64:67], v[72:75], v[56:59]
ds_read_b128 v[124:127], v2 offset:3968
ds_read_b128 v[128:131], v2 offset:4000
v_mfma_f32_16x16x32_bf16 v[60:63], v[68:71], v[72:75], v[60:63]
ds_read_b128 v[132:135], v3 offset:1632
s_waitcnt lgkmcnt(6)
v_mfma_f32_16x16x32_bf16 v[56:59], v[84:87], v[92:95], v[56:59]
ds_read_b128 v[64:67], v2 offset:4032
ds_read_b128 v[68:71], v2 offset:4064
v_mfma_f32_16x16x32_bf16 v[60:63], v[88:91], v[92:95], v[60:63]
ds_read_b128 v[72:75], v3 offset:1536
s_waitcnt lgkmcnt(6)
v_mfma_f32_16x16x32_bf16 v[56:59], v[104:107], v[112:115], v[56:59]
v_mfma_f32_16x16x32_bf16 v[60:63], v[108:111], v[112:115], v[60:63]
s_waitcnt lgkmcnt(3)
v_mfma_f32_16x16x32_bf16 v[56:59], v[124:127], v[132:135], v[56:59]
v_mfma_f32_16x16x32_bf16 v[60:63], v[128:131], v[132:135], v[60:63]
s_waitcnt lgkmcnt(0)
v_mfma_f32_16x16x32_bf16 v[56:59], v[64:67], v[72:75], v[56:59]
v_mfma_f32_16x16x32_bf16 v[60:63], v[68:71], v[72:75], v[60:63]
s_nop 7
s_nop 3
ds_write_b128 v4, v[32:35] offset:0
ds_write_b128 v4, v[36:39] offset:1024
ds_write_b128 v4, v[40:43] offset:2048
ds_write_b128 v4, v[44:47] offset:3072
ds_read_b64 v[64:65], v6 offset:0
ds_read_b64 v[66:67], v6 offset:32
ds_read_b64 v[68:69], v6 offset:1536
ds_read_b64 v[70:71], v6 offset:1568
s_waitcnt lgkmcnt(0)
v_mov_b32 v72, 1
ds_write_b32 v7, v72
s_mov_b32 s63, 0x400000
K2_pollB:
ds_read_b32 v73, v8
s_waitcnt lgkmcnt(0)
v_readfirstlane_b32 s40, v73
s_sub_u32 s63, s63, 1
s_cmp_eq_u32 s63, 0
s_cbranch_scc1 K2_pollxB
s_cmp_eq_u32 s40, 1
s_cbranch_scc0 K2_pollB
K2_pollxB:
ds_read_b128 v[80:83], v5 offset:0
ds_read_b128 v[84:87], v5 offset:1024
ds_read_b128 v[88:91], v5 offset:2048
ds_read_b128 v[92:95], v5 offset:3072
v_lshlrev_b32 v96, 16, v64
v_and_b32 v97, 0xffff0000, v64
v_lshlrev_b32 v98, 16, v65
v_and_b32 v99, 0xffff0000, v65
v_lshlrev_b32 v100, 16, v66
v_and_b32 v101, 0xffff0000, v66
v_lshlrev_b32 v102, 16, v67
v_and_b32 v103, 0xffff0000, v67
v_lshlrev_b32 v104, 16, v68
v_and_b32 v105, 0xffff0000, v68
v_lshlrev_b32 v106, 16, v69
v_and_b32 v107, 0xffff0000, v69
v_lshlrev_b32 v108, 16, v70
v_and_b32 v109, 0xffff0000, v70
v_lshlrev_b32 v110, 16, v71
v_and_b32 v111, 0xffff0000, v71
s_waitcnt vmcnt(0)
v_lshlrev_b32 v112, 16, v144
v_and_b32 v113, 0xffff0000, v144
v_lshlrev_b32 v114, 16, v145
v_and_b32 v115, 0xffff0000, v145
v_lshlrev_b32 v116, 16, v146
v_and_b32 v117, 0xffff0000, v146
v_lshlrev_b32 v118, 16, v147
v_and_b32 v119, 0xffff0000, v147
v_lshlrev_b32 v120, 16, v148
v_and_b32 v121, 0xffff0000, v148
v_lshlrev_b32 v122, 16, v149
v_and_b32 v123, 0xffff0000, v149
v_lshlrev_b32 v124, 16, v150
v_and_b32 v125, 0xffff0000, v150
v_lshlrev_b32 v126, 16, v151
v_and_b32 v127, 0xffff0000, v151
s_waitcnt lgkmcnt(0)
v_pk_add_f32 v[48:49], v[48:49], v[80:81]
v_pk_add_f32 v[50:51], v[50:51], v[82:83]
v_pk_add_f32 v[52:53], v[52:53], v[84:85]
v_pk_add_f32 v[54:55], v[54:55], v[86:87]
v_pk_add_f32 v[56:57], v[56:57], v[88:89]
v_pk_add_f32 v[58:59], v[58:59], v[90:91]
v_pk_add_f32 v[60:61], v[60:61], v[92:93]
v_pk_add_f32 v[62:63], v[62:63], v[94:95]
v_pk_fma_f32 v[48:49], v[96:97], s[36:37], v[48:49] op_sel_hi:[1,0,1]
v_pk_fma_f32 v[50:51], v[98:99], s[36:37], v[50:51] op_sel_hi:[1,0,1]
v_pk_fma_f32 v[52:53], v[100:101], s[36:37], v[52:53] op_sel_hi:[1,0,1]
v_pk_fma_f32 v[54:55], v[102:103], s[36:37], v[54:55] op_sel_hi:[1,0,1]
v_pk_fma_f32 v[56:57], v[104:105], s[36:37], v[56:57] op_sel_hi:[1,0,1]
v_pk_fma_f32 v[58:59], v[106:107], s[36:37], v[58:59] op_sel_hi:[1,0,1]
v_pk_fma_f32 v[60:61], v[108:109], s[36:37], v[60:61] op_sel_hi:[1,0,1]
v_pk_fma_f32 v[62:63], v[110:111], s[36:37], v[62:63] op_sel_hi:[1,0,1]
v_pk_fma_f32 v[48:49], v[48:49], s[36:37], v[112:113] op_sel:[0,1,0] op_sel_hi:[1,1,1]
v_pk_fma_f32 v[50:51], v[50:51], s[36:37], v[114:115] op_sel:[0,1,0] op_sel_hi:[1,1,1]
v_pk_fma_f32 v[52:53], v[52:53], s[36:37], v[116:117] op_sel:[0,1,0] op_sel_hi:[1,1,1]
v_pk_fma_f32 v[54:55], v[54:55], s[36:37], v[118:119] op_sel:[0,1,0] op_sel_hi:[1,1,1]
v_pk_fma_f32 v[56:57], v[56:57], s[36:37], v[120:121] op_sel:[0,1,0] op_sel_hi:[1,1,1]
v_pk_fma_f32 v[58:59], v[58:59], s[36:37], v[122:123] op_sel:[0,1,0] op_sel_hi:[1,1,1]
v_pk_fma_f32 v[60:61], v[60:61], s[36:37], v[124:125] op_sel:[0,1,0] op_sel_hi:[1,1,1]
v_pk_fma_f32 v[62:63], v[62:63], s[36:37], v[126:127] op_sel:[0,1,0] op_sel_hi:[1,1,1]
v_cvt_pk_bf16_f32 v64, v48, v49
v_cvt_pk_bf16_f32 v65, v50, v51
v_cvt_pk_bf16_f32 v66, v52, v53
v_cvt_pk_bf16_f32 v67, v54, v55
v_cvt_pk_bf16_f32 v68, v56, v57
v_cvt_pk_bf16_f32 v69, v58, v59
v_cvt_pk_bf16_f32 v70, v60, v61
v_cvt_pk_bf16_f32 v71, v62, v63
ds_write_b64 v10, v[64:65] offset:0
ds_write_b64 v10, v[66:67] offset:32
ds_write_b64 v10, v[68:69] offset:1280
ds_write_b64 v10, v[70:71] offset:1312
s_waitcnt lgkmcnt(0)
ds_read_b128 v[72:75], v11
ds_read_b128 v[76:79], v11 offset:1280
s_waitcnt lgkmcnt(1)
global_store_dwordx4 v9, v[72:75], s[14:15] sc1
s_waitcnt lgkmcnt(0)
global_store_dwordx4 v12, v[76:79], s[14:15] sc1
s_branch K2_END
K2_SIDE:
s_barrier
v_mul_u32_u24 v30, 160, v2
v_lshl_add_u32 v30, v3, 4, v30
v_add_u32 v30, 112768, v30
s_cmp_ge_u32 s2, 192
s_cbranch_scc1 K1_w0
s_waitcnt vmcnt(10)
s_branch K1_w1
K1_w0:
s_waitcnt vmcnt(2)
K1_w1:
ds_write_b128 v30, v[8:11]
ds_write_b128 v30, v[12:15] offset:5120
s_waitcnt lgkmcnt(0)
v_mov_b32 v2, 162608
v_mov_b32 v3, 1
s_mov_b64 exec, 1
ds_add_u32 v2, v3
s_mov_b64 exec, -1
s_mov_b32 s63, 0x400000
WS_5:
ds_read_b32 v3, v2
s_waitcnt lgkmcnt(0)
v_readfirstlane_b32 s40, v3
s_sub_u32 s63, s63, 1
s_cmp_eq_u32 s63, 0
s_cbranch_scc1 WS_5_x
s_cmp_ge_u32 s40, 4
s_cbranch_scc0 WS_5
WS_5_x:
v_lshrrev_b32 v2, 4, v1
v_bfe_u32 v3, v1, 2, 2
v_and_b32 v4, 3, v1
v_lshl_add_u32 v5, v2, 3, v3
v_mul_u32_u24 v5, 160, v5
v_lshl_add_u32 v5, v4, 3, v5
s_lshl_b32 s31, s25, 5
s_add_u32 s31, s31, 112768
v_add_u32 v5, s31, v5
ds_read_b64_tr_b16 v[8:9], v5
ds_read_b64_tr_b16 v[10:11], v5 offset:640
ds_read_b64_tr_b16 v[12:13], v5 offset:5120
ds_read_b64_tr_b16 v[14:15], v5 offset:5760
v_and_b32 v6, 15, v1
v_lshlrev_b32 v6, 12, v6
v_lshl_add_u32 v6, v2, 4, v6
s_lshl_b32 s31, s27, 18
s_lshl_b32 s32, s25, 16
s_add_u32 s31, s31, s32
s_lshl_b32 s32, s26, 7
s_add_u32 s31, s31, s32
v_add_u32 v6, s31, v6
s_waitcnt lgkmcnt(2)
global_store_dwordx4 v6, v[8:11], s[14:15] sc1
s_waitcnt lgkmcnt(0)
global_store_dwordx4 v6, v[12:15], s[14:15] offset:64 sc1
s_cmp_ge_u32 s2, 192
s_cbranch_scc1 K1_w2
s_waitcnt vmcnt(10)
s_branch K1_w3
K1_w2:
s_waitcnt vmcnt(2)
K1_w3:
v_mov_b32 v31, 0x3f803f80
v_mov_b32 v52, 0
v_mov_b32 v53, 0
v_mov_b32 v54, 0
v_mov_b32 v55, 0
v_dot2_f32_bf16 v52, v16, v31, v52
v_dot2_f32_bf16 v53, v16, v16, v53
v_dot2_f32_bf16 v54, v20, v31, v54
v_dot2_f32_bf16 v55, v20, v20, v55
v_dot2_f32_bf16 v52, v17, v31, v52
v_dot2_f32_bf16 v53, v17, v17, v53
v_dot2_f32_bf16 v54, v21, v31, v54
v_dot2_f32_bf16 v55, v21, v21, v55
v_dot2_f32_bf16 v52, v18, v31, v52
v_dot2_f32_bf16 v53, v18, v18, v53
v_dot2_f32_bf16 v54, v22, v31, v54
v_dot2_f32_bf16 v55, v22, v22, v55
v_dot2_f32_bf16 v52, v19, v31, v52
v_dot2_f32_bf16 v53, v19, v19, v53
v_dot2_f32_bf16 v54, v23, v31, v54
v_dot2_f32_bf16 v55, v23, v23, v55
s_nop 1
v_add_f32_dpp v52, v52, v52 row_shr:1
v_add_f32_dpp v53, v53, v53 row_shr:1
v_add_f32_dpp v54, v54, v54 row_shr:1
v_add_f32_dpp v55, v55, v55 row_shr:1
v_add_f32_dpp v52, v52, v52 row_shr:2
v_add_f32_dpp v53, v53, v53 row_shr:2
v_add_f32_dpp v54, v54, v54 row_shr:2
v_add_f32_dpp v55, v55, v55 row_shr:2
v_add_f32_dpp v52, v52, v52 row_shr:4
v_add_f32_dpp v53, v53, v53 row_shr:4
v_add_f32_dpp v54, v54, v54 row_shr:4
v_add_f32_dpp v55, v55, v55 row_shr:4
v_add_f32_dpp v52, v52, v52 row_shr:8
v_add_f32_dpp v53, v53, v53 row_shr:8
v_add_f32_dpp v54, v54, v54 row_shr:8
v_add_f32_dpp v55, v55, v55 row_shr:8
v_add_f32_dpp v52, v52, v52 row_bcast:15 row_mask:0xa
v_add_f32_dpp v53, v53, v53 row_bcast:15 row_mask:0xa
v_add_f32_dpp v54, v54, v54 row_bcast:15 row_mask:0xa
v_add_f32_dpp v55, v55, v55 row_bcast:15 row_mask:0xa
v_add_f32_dpp v52, v52, v52 row_bcast:31 row_mask:0xc
v_add_f32_dpp v53, v53, v53 row_bcast:31 row_mask:0xc
v_add_f32_dpp v54, v54, v54 row_bcast:31 row_mask:0xc
v_add_f32_dpp v55, v55, v55 row_bcast:31 row_mask:0xc
s_nop 1
v_readlane_b32 s36, v52, 63
v_readlane_b32 s37, v53, 63
v_readlane_b32 s38, v54, 63
v_readlane_b32 s39, v55, 63
s_nop 1
v_cmp_eq_u32 vcc, 0, v1
v_mov_b32 v56, s38
v_mov_b32 v57, s39
v_mov_b32 v58, s36
v_mov_b32 v59, s37
v_cndmask_b32 v56, v56, v58, vcc
v_cndmask_b32 v57, v57, v59, vcc
v_mul_f32 v56, 0x3b000000, v56
v_mul_f32 v57, 0x3b000000, v57
v_fma_f32 v57, -v56, v56, v57
v_max_f32 v57, 0, v57
v_cvt_pk_bf16_f32 v56, v56, v56
v_and_b32 v56, 0xffff0000, v56
v_cvt_pk_bf16_f32 v57, v57, v57
v_and_b32 v57, 0xffff0000, v57
v_add_f32 v57, 0x3727c5ac, v57
v_cvt_pk_bf16_f32 v57, v57, v57
v_and_b32 v57, 0xffff0000, v57
v_sqrt_f32 v57, v57
s_nop 0
v_cvt_pk_bf16_f32 v57, v57, v57
v_and_b32 v57, 0xffff0000, v57
v_rcp_f32 v58, v57
s_nop 0
v_mul_f32 v59, v56, v58
v_sub_f32 v59, 0, v59
s_lshl_b32 s31, s30, 2
s_add_u32 s31, s31, 6422528
v_lshl_add_u32 v60, v1, 2, s31
v_add_u32 v61, 8192, v60
v_cmp_gt_u32 vcc, 2, v1
s_and_saveexec_b64 s[42:43], vcc
global_store_dword v60, v58, s[14:15] sc1
global_store_dword v61, v59, s[14:15] sc1
s_mov_b64 exec, s[42:43]
s_cmp_ge_u32 s2, 192
s_cbranch_scc1 K1_nomodc
s_waitcnt vmcnt(4)
v_lshlrev_b32 v48, 16, v48
v_lshlrev_b32 v49, 16, v49
v_lshlrev_b32 v50, 16, v50
v_lshlrev_b32 v51, 16, v51
v_mul_f32 v52, 0xbfb8aa3b, v48
v_mul_f32 v53, 0xbfb8aa3b, v49
v_mul_f32 v54, 0xbfb8aa3b, v50
v_mul_f32 v55, 0xbfb8aa3b, v51
v_exp_f32 v52, v52
v_exp_f32 v53, v53
v_exp_f32 v54, v54
v_exp_f32 v55, v55
s_nop 0
v_add_f32 v52, 1.0, v52
v_add_f32 v53, 1.0, v53
v_add_f32 v54, 1.0, v54
v_add_f32 v55, 1.0, v55
v_rcp_f32 v56, v52
v_rcp_f32 v57, v53
v_rcp_f32 v58, v54
v_rcp_f32 v59, v55
s_nop 0
v_mul_f32 v60, v48, v56
v_mul_f32 v61, v49, v57
v_mul_f32 v62, v50, v58
v_mul_f32 v63, v51, v59
v_fma_f32 v48, -v60, v52, v48
v_fma_f32 v49, -v61, v53, v49
v_fma_f32 v50, -v62, v54, v50
v_fma_f32 v51, -v63, v55, v51
v_fma_f32 v48, v48, v56, v60
v_fma_f32 v49, v49, v57, v61
v_fma_f32 v50, v50, v58, v62
v_fma_f32 v51, v51, v59, v63
v_cvt_pk_bf16_f32 v48, v48, v48
v_and_b32 v48, 0xffff0000, v48
v_cvt_pk_bf16_f32 v49, v49, v49
v_and_b32 v49, 0xffff0000, v49
v_cvt_pk_bf16_f32 v50, v50, v50
v_and_b32 v50, 0xffff0000, v50
v_cvt_pk_bf16_f32 v51, v51, v51
v_and_b32 v51, 0xffff0000, v51
v_lshlrev_b32 v62, 16, v32
v_and_b32 v63, 0xffff0000, v32
v_mul_f32 v64, v62, v48
v_mul_f32 v65, v63, v48
v_lshlrev_b32 v62, 16, v33
v_and_b32 v63, 0xffff0000, v33
v_mul_f32 v66, v62, v48
v_mul_f32 v67, v63, v48
v_lshlrev_b32 v62, 16, v34
v_and_b32 v63, 0xffff0000, v34
v_mul_f32 v68, v62, v48
v_mul_f32 v69, v63, v48
v_lshlrev_b32 v62, 16, v35
v_and_b32 v63, 0xffff0000, v35
v_mul_f32 v70, v62, v48
v_mul_f32 v71, v63, v48
v_lshlrev_b32 v62, 16, v36
v_and_b32 v63, 0xffff0000, v36
v_fmac_f32 v64, v62, v49
v_fmac_f32 v65, v63, v49
v_lshlrev_b32 v62, 16, v37
v_and_b32 v63, 0xffff0000, v37
v_fmac_f32 v66, v62, v49
v_fmac_f32 v67, v63, v49
v_lshlrev_b32 v62, 16, v38
v_and_b32 v63, 0xffff0000, v38
v_fmac_f32 v68, v62, v49
v_fmac_f32 v69, v63, v49
v_lshlrev_b32 v62, 16, v39
v_and_b32 v63, 0xffff0000, v39
v_fmac_f32 v70, v62, v49
v_fmac_f32 v71, v63, v49
v_lshlrev_b32 v62, 16, v40
v_and_b32 v63, 0xffff0000, v40
v_fmac_f32 v64, v62, v50
v_fmac_f32 v65, v63, v50
v_lshlrev_b32 v62, 16, v41
v_and_b32 v63, 0xffff0000, v41
v_fmac_f32 v66, v62, v50
v_fmac_f32 v67, v63, v50
v_lshlrev_b32 v62, 16, v42
v_and_b32 v63, 0xffff0000, v42
v_fmac_f32 v68, v62, v50
v_fmac_f32 v69, v63, v50
v_lshlrev_b32 v62, 16, v43
v_and_b32 v63, 0xffff0000, v43
v_fmac_f32 v70, v62, v50
v_fmac_f32 v71, v63, v50
v_lshlrev_b32 v62, 16, v44
v_and_b32 v63, 0xffff0000, v44
v_fmac_f32 v64, v62, v51
v_fmac_f32 v65, v63, v51
v_lshlrev_b32 v62, 16, v45
v_and_b32 v63, 0xffff0000, v45
v_fmac_f32 v66, v62, v51
v_fmac_f32 v67, v63, v51
v_lshlrev_b32 v62, 16, v46
v_and_b32 v63, 0xffff0000, v46
v_fmac_f32 v68, v62, v51
v_fmac_f32 v69, v63, v51
v_lshlrev_b32 v62, 16, v47
v_and_b32 v63, 0xffff0000, v47
v_fmac_f32 v70, v62, v51
v_fmac_f32 v71, v63, v51
v_subrev_u32 v61, 256, v0
v_lshlrev_b32 v61, 5, v61
v_add_u32 v61, 101248, v61
ds_write_b128 v61, v[64:67]
ds_write_b128 v61, v[68:71] offset:16
s_waitcnt lgkmcnt(0)
v_mov_b32 v2, 162584
v_mov_b32 v3, 1
s_mov_b64 exec, 1
ds_add_u32 v2, v3
s_mov_b64 exec, -1
s_mov_b32 s63, 0x400000
WS_6:
ds_read_b32 v3, v2
s_waitcnt lgkmcnt(0)
v_readfirstlane_b32 s40, v3
s_sub_u32 s63, s63, 1
s_cmp_eq_u32 s63, 0
s_cbranch_scc1 WS_6_x
s_cmp_ge_u32 s40, 4
s_cbranch_scc0 WS_6
WS_6_x:
s_cmp_lg_u32 s25, 0
s_cbranch_scc1 K1_nomodc
v_lshlrev_b32 v4, 2, v1
v_add_u32 v4, 101248, v4
ds_read_b32 v16, v4 offset:0
ds_read_b32 v17, v4 offset:256
ds_read_b32 v18, v4 offset:512
ds_read_b32 v19, v4 offset:768
ds_read_b32 v20, v4 offset:1024
ds_read_b32 v21, v4 offset:1280
ds_read_b32 v22, v4 offset:1536
ds_read_b32 v23, v4 offset:1792
ds_read_b32 v24, v4 offset:2048
ds_read_b32 v25, v4 offset:2304
ds_read_b32 v26, v4 offset:2560
ds_read_b32 v27, v4 offset:2816
ds_read_b32 v28, v4 offset:3072
ds_read_b32 v29, v4 offset:3328
ds_read_b32 v30, v4 offset:3584
s_waitcnt lgkmcnt(7)
ds_read_b32 v31, v4 offset:3840
ds_read_b32 v32, v4 offset:4096
ds_read_b32 v33, v4 offset:4352
ds_read_b32 v34, v4 offset:4608
ds_read_b32 v35, v4 offset:4864
ds_read_b32 v36, v4 offset:5120
ds_read_b32 v37, v4 offset:5376
ds_read_b32 v38, v4 offset:5632
ds_read_b32 v39, v4 offset:5888
ds_read_b32 v40, v4 offset:6144
ds_read_b32 v41, v4 offset:6400
ds_read_b32 v42, v4 offset:6656
ds_read_b32 v43, v4 offset:6912
ds_read_b32 v44, v4 offset:7168
ds_read_b32 v45, v4 offset:7424
ds_read_b32 v46, v4 offset:7680
ds_read_b32 v47, v4 offset:7936
s_waitcnt lgkmcnt(0)
v_add_f32 v16, v16, v32
v_add_f32 v17, v17, v33
v_add_f32 v18, v18, v34
v_add_f32 v19, v19, v35
v_add_f32 v20, v20, v36
v_add_f32 v21, v21, v37
v_add_f32 v22, v22, v38
v_add_f32 v23, v23, v39
v_add_f32 v24, v24, v40
v_add_f32 v25, v25, v41
v_add_f32 v26, v26, v42
v_add_f32 v27, v27, v43
v_add_f32 v28, v28, v44
v_add_f32 v29, v29, v45
v_add_f32 v30, v30, v46
v_add_f32 v31, v31, v47
v_add_f32 v16, v16, v24
v_add_f32 v17, v17, v25
v_add_f32 v18, v18, v26
v_add_f32 v19, v19, v27
v_add_f32 v20, v20, v28
v_add_f32 v21, v21, v29
v_add_f32 v22, v22, v30
v_add_f32 v23, v23, v31
v_add_f32 v16, v16, v20
v_add_f32 v17, v17, v21
v_add_f32 v18, v18, v22
v_add_f32 v19, v19, v23
v_add_f32 v16, v16, v18
v_add_f32 v17, v17, v19
v_add_f32 v16, v16, v17
s_mul_i32 s31, s34, 12288
s_lshl_b32 s32, s33, 8
s_add_u32 s31, s31, s32
s_add_u32 s31, s31, 6684672
v_lshl_add_u32 v5, v1, 2, s31
global_store_dword v5, v16, s[14:15] sc1
K1_nomodc:
v_mov_b32 v74, 0
global_load_dword v75, v74, s[18:19] sc1
s_waitcnt vmcnt(0)
v_readfirstlane_b32 s51, v75
v_mov_b32 v2, 162588
v_mov_b32 v3, 1
s_mov_b64 exec, 1
ds_add_u32 v2, v3
s_mov_b64 exec, -1
s_sub_u32 s26, s25, 1
s_lshl_b32 s26, s26, 8
s_add_u32 s26, s26, s2
s_cmp_eq_u32 s25, 0
s_cselect_b32 s26, 1000, s26
s_mov_b32 s27, s57
v_lshrrev_b32 v2, 2, v1
v_and_b32 v3, 3, v1
v_lshrrev_b32 v4, 4, v1
v_bfe_u32 v5, v1, 2, 2
v_mul_u32_u24 v11, 80, v2
v_lshl_add_u32 v11, v3, 4, v11
v_add_u32 v11, s27, v11
v_lshl_add_u32 v12, v4, 2, v5
v_mul_u32_u24 v12, 80, v12
v_lshl_add_u32 v12, v3, 3, v12
v_add_u32 v12, s27, v12
s_cmp_ge_u32 s26, 520
s_cbranch_scc1 K12_noraw
s_cmp_ge_u32 s26, 344
s_cbranch_scc1 K12_rawW2
s_mul_i32 s28, s26, 763
s_lshr_b32 s28, s28, 16
s_mul_i32 s29, s28, 86
s_sub_u32 s29, s26, s29
v_lshrrev_b32 v10, 1, v1
v_and_b32 v13, 1, v1
v_lshlrev_b32 v11, 5, v10
v_lshl_add_u32 v11, v13, 4, v11
v_add_u32 v11, s27, v11
v_mul_u32_u24 v10, 2752, v10
v_lshl_add_u32 v10, v13, 4, v10
v_lshl_add_u32 v12, v4, 2, v5
v_lshlrev_b32 v12, 5, v12
v_lshl_add_u32 v12, v3, 3, v12
v_add_u32 v12, s27, v12
s_mul_i32 s53, s28, 352256
s_lshl_b32 s30, s29, 5
s_add_u32 s53, s53, s30
s_mov_b32 s64, s48
s_mov_b32 s65, s49
s_mov_b32 s66, 1409024
s_mov_b32 s67, 0x20000
buffer_load_dwordx4 v[32:35], v10, s[64:67], s53 offen
s_add_u32 s53, s53, 88064
buffer_load_dwordx4 v[36:39], v10, s[64:67], s53 offen
s_add_u32 s53, s53, 88064
buffer_load_dwordx4 v[40:43], v10, s[64:67], s53 offen
s_add_u32 s53, s53, 88064
buffer_load_dwordx4 v[44:47], v10, s[64:67], s53 offen
s_branch K12_noraw
K12_rawW2:
s_sub_u32 s31, s26, 344
s_and_b32 s29, s31, 15
s_lshr_b32 s28, s31, 4
v_lshlrev_b32 v10, 10, v2
v_lshl_add_u32 v10, v3, 4, v10
s_lshl_b32 s30, s29, 6
s_mov_b32 s64, s12
s_mov_b32 s65, s13
s_mov_b32 s66, 1409024
s_mov_b32 s67, 0x20000
s_lshl_b32 s31, s28, 2
s_add_u32 s31, s31, 0
s_mul_i32 s32, s31, 13
s_lshr_b32 s32, s32, 6
s_mul_i32 s33, s32, 5
s_sub_u32 s33, s31, s33
s_mul_i32 s32, s32, 11
s_min_u32 s32, s32, 76
s_lshl_b32 s33, s33, 1
s_add_u32 s32, s32, s33
s_add_u32 s33, s32, 1
s_sub_u32 s34, s31, 40
s_mul_i32 s34, s34, 22
s_add_u32 s35, s34, 21
s_add_u32 s34, s34, 10
s_cmp_lt_u32 s31, 40
s_cselect_b32 s32, s32, s34
s_cselect_b32 s33, s33, s35
s_lshl_b32 s53, s32, 14
s_add_u32 s53, s53, s30
buffer_load_dwordx4 v[32:35], v10, s[64:67], s53 offen nt
s_lshl_b32 s53, s33, 14
s_add_u32 s53, s53, s30
buffer_load_dwordx4 v[36:39], v10, s[64:67], s53 offen nt
s_lshl_b32 s31, s28, 2
s_add_u32 s31, s31, 1
s_mul_i32 s32, s31, 13
s_lshr_b32 s32, s32, 6
s_mul_i32 s33, s32, 5
s_sub_u32 s33, s31, s33
s_mul_i32 s32, s32, 11
s_min_u32 s32, s32, 76
s_lshl_b32 s33, s33, 1
s_add_u32 s32, s32, s33
s_add_u32 s33, s32, 1
s_sub_u32 s34, s31, 40
s_mul_i32 s34, s34, 22
s_add_u32 s35, s34, 21
s_add_u32 s34, s34, 10
s_cmp_lt_u32 s31, 40
s_cselect_b32 s32, s32, s34
s_cselect_b32 s33, s33, s35
s_lshl_b32 s53, s32, 14
s_add_u32 s53, s53, s30
buffer_load_dwordx4 v[40:43], v10, s[64:67], s53 offen nt
s_lshl_b32 s53, s33, 14
s_add_u32 s53, s53, s30
buffer_load_dwordx4 v[44:47], v10, s[64:67], s53 offen nt
s_lshl_b32 s31, s28, 2
s_add_u32 s31, s31, 2
s_mul_i32 s32, s31, 13
s_lshr_b32 s32, s32, 6
s_mul_i32 s33, s32, 5
s_sub_u32 s33, s31, s33
s_mul_i32 s32, s32, 11
s_min_u32 s32, s32, 76
s_lshl_b32 s33, s33, 1
s_add_u32 s32, s32, s33
s_add_u32 s33, s32, 1
s_sub_u32 s34, s31, 40
s_mul_i32 s34, s34, 22
s_add_u32 s35, s34, 21
s_add_u32 s34, s34, 10
s_cmp_lt_u32 s31, 40
s_cselect_b32 s32, s32, s34
s_cselect_b32 s33, s33, s35
s_lshl_b32 s53, s32, 14
s_add_u32 s53, s53, s30
buffer_load_dwordx4 v[48:51], v10, s[64:67], s53 offen nt
s_lshl_b32 s53, s33, 14
s_add_u32 s53, s53, s30
buffer_load_dwordx4 v[52:55], v10, s[64:67], s53 offen nt
s_lshl_b32 s31, s28, 2
s_add_u32 s31, s31, 3
s_mul_i32 s32, s31, 13
s_lshr_b32 s32, s32, 6
s_mul_i32 s33, s32, 5
s_sub_u32 s33, s31, s33
s_mul_i32 s32, s32, 11
s_min_u32 s32, s32, 76
s_lshl_b32 s33, s33, 1
s_add_u32 s32, s32, s33
s_add_u32 s33, s32, 1
s_sub_u32 s34, s31, 40
s_mul_i32 s34, s34, 22
s_add_u32 s35, s34, 21
s_add_u32 s34, s34, 10
s_cmp_lt_u32 s31, 40
s_cselect_b32 s32, s32, s34
s_cselect_b32 s33, s33, s35
s_lshl_b32 s53, s32, 14
s_add_u32 s53, s53, s30
buffer_load_dwordx4 v[56:59], v10, s[64:67], s53 offen nt
s_lshl_b32 s53, s33, 14
s_add_u32 s53, s53, s30
buffer_load_dwordx4 v[60:63], v10, s[64:67], s53 offen nt
K12_noraw:
s_cmp_lg_u32 s25, 0
s_cbranch_scc1 K12_gbx
s_waitcnt lgkmcnt(0)
v_mov_b32 v70, 162588
s_mov_b32 s63, 0x400000
WS_7:
ds_read_b32 v71, v70
s_waitcnt lgkmcnt(0)
v_readfirstlane_b32 s40, v71
s_sub_u32 s63, s63, 1
s_cmp_eq_u32 s63, 0
s_cbranch_scc1 WS_7_x
s_cmp_ge_u32 s40, 4
s_cbranch_scc0 WS_7
WS_7_x:
s_mov_b64 exec, 1
v_mov_b32 v70, 0
s_mov_b32 s52, 0x200000
s_cmp_eq_u32 s51, 1
s_cbranch_scc1 K12_rdyx
K12_rdy:
global_load_dword v71, v70, s[18:19] sc1
s_waitcnt vmcnt(0)
v_readfirstlane_b32 s40, v71
s_sub_u32 s52, s52, 1
s_cmp_eq_u32 s52, 0
s_cbranch_scc1 K12_gbdone
s_cmp_eq_u32 s40, 1
s_cbranch_scc0 K12_rdy
K12_rdyx:
s_and_b32 s40, s2, 15
s_lshl_b32 s40, s40, 8
s_add_u32 s40, s40, 6524928
v_mov_b32 v70, s40
v_mov_b32 v71, 1
global_atomic_add v71, v70, v71, s[14:15] sc0 sc1
s_waitcnt vmcnt(0)
v_readfirstlane_b32 s40, v71
s_cmp_eq_u32 s40, 15
s_cbranch_scc0 K12_poll
s_mov_b64 exec, 0xff
v_lshlrev_b32 v70, 8, v1
v_add_u32 v70, 6533120, v70
v_mov_b32 v71, 1
global_atomic_add v70, v71, s[14:15] sc1
s_mov_b64 exec, 1
K12_poll:
s_and_b32 s40, s2, 7
s_lshl_b32 s40, s40, 8
s_add_u32 s40, s40, 6533120
v_mov_b32 v70, s40
K12_poll2:
global_load_dword v71, v70, s[14:15] sc1
s_waitcnt vmcnt(0)
v_readfirstlane_b32 s40, v71
s_sub_u32 s52, s52, 1
s_cmp_eq_u32 s52, 0
s_cbranch_scc1 K12_gbdone
s_cmp_ge_u32 s40, 16
s_cbranch_scc0 K12_poll2
K12_gbdone:
s_mov_b64 exec, -1
K12_gbx:
s_setprio 0
s_barrier
s_cmp_gt_u32 s26, 521
s_cbranch_scc1 K2_SIDE_IDLE
s_cmp_ge_u32 s26, 520
s_cbranch_scc1 K2_TAB
s_cmp_ge_u32 s26, 344
s_cbranch_scc1 K2_W2
s_lshl_b32 s31, s28, 9
v_lshl_add_u32 v13, v1, 3, s31
v_add_u32 v13, 6690816, v13
global_load_dwordx2 v[64:65], v13, s[14:15] sc1
global_load_dwordx2 v[66:67], v13, s[14:15] offset:2048 sc1
v_add_u32 v13, 12288, v13
global_load_dwordx2 v[68:69], v13, s[14:15] sc1
global_load_dwordx2 v[70:71], v13, s[14:15] offset:2048 sc1
v_add_u32 v13, 12288, v13
global_load_dwordx2 v[72:73], v13, s[14:15] sc1
global_load_dwordx2 v[74:75], v13, s[14:15] offset:2048 sc1
v_add_u32 v13, 12288, v13
global_load_dwordx2 v[76:77], v13, s[14:15] sc1
global_load_dwordx2 v[78:79], v13, s[14:15] offset:2048 sc1
s_waitcnt vmcnt(8)
ds_write_b128 v11, v[32:35] offset:0
ds_write_b128 v11, v[36:39] offset:1024
ds_write_b128 v11, v[40:43] offset:2048
ds_write_b128 v11, v[44:47] offset:3072
s_waitcnt vmcnt(0)
v_add_f32 v64, v64, v68
v_add_f32 v72, v72, v76
v_add_f32 v64, v64, v72
v_add_f32 v65, v65, v69
v_add_f32 v73, v73, v77
v_add_f32 v65, v65, v73
v_add_f32 v66, v66, v70
v_add_f32 v74, v74, v78
v_add_f32 v66, v66, v74
v_add_f32 v67, v67, v71
v_add_f32 v75, v75, v79
v_add_f32 v67, v67, v75
v_cvt_pk_bf16_f32 v64, v64, v64
v_and_b32 v64, 0xffff0000, v64
v_cvt_pk_bf16_f32 v65, v65, v65
v_and_b32 v65, 0xffff0000, v65
v_cvt_pk_bf16_f32 v66, v66, v66
v_and_b32 v66, 0xffff0000, v66
v_cvt_pk_bf16_f32 v67, v67, v67
v_and_b32 v67, 0xffff0000, v67
v_add_f32 v66, 1.0, v66
v_add_f32 v67, 1.0, v67
v_cvt_pk_bf16_f32 v66, v66, v66
v_and_b32 v66, 0xffff0000, v66
v_cvt_pk_bf16_f32 v67, v67, v67
v_and_b32 v67, 0xffff0000, v67
v_cvt_pk_bf16_f32 v64, v64, v65
v_lshl_add_u32 v15, v1, 3, s27
v_lshl_add_u32 v16, v1, 2, s27
ds_write_b64 v15, v[66:67] offset:10240
ds_write_b32 v16, v64 offset:10752
v_and_b32 v17, 15, v1
v_cmp_eq_u32 s[50:51], 0, v17
v_cmp_eq_u32 s[52:53], 1, v17
v_mov_b32 v18, 0
v_mov_b32 v19, 0x3f803f80
v_cndmask_b32 v18, v18, v19, s[50:51]
v_mov_b32 v19, 0
v_cndmask_b32 v19, v19, -1, s[52:53]
v_lshl_add_u32 v24, v4, 4, s27
v_lshl_add_u32 v25, v4, 3, s27
v_mov_b32 v96, 0
v_mov_b32 v97, 0
v_mov_b32 v98, 0
v_mov_b32 v99, 0
v_mov_b32 v100, 0
v_mov_b32 v101, 0
v_mov_b32 v102, 0
v_mov_b32 v103, 0
v_mov_b32 v104, 0
v_mov_b32 v105, 0
v_mov_b32 v106, 0
v_mov_b32 v107, 0
v_mov_b32 v108, 0
v_mov_b32 v109, 0
v_mov_b32 v110, 0
v_mov_b32 v111, 0
s_lshl_b32 s30, s29, 10
s_mul_i32 s31, s28, 356352
s_add_u32 s30, s30, s31
s_add_u32 s30, s30, 7340032
v_lshl_add_u32 v26, v1, 4, s30
s_waitcnt lgkmcnt(0)
ds_read_b128 v[112:115], v24 offset:10240
ds_read_b128 v[116:119], v24 offset:10304
ds_read_b64 v[120:121], v25 offset:10752
ds_read_b64 v[122:123], v25 offset:10784
ds_read_b64_tr_b16 v[124:125], v12 offset:0
ds_read_b64_tr_b16 v[126:127], v12 offset:512
ds_read_b128 v[128:131], v24 offset:10368
ds_read_b128 v[132:135], v24 offset:10432
ds_read_b64 v[136:137], v25 offset:10816
ds_read_b64 v[138:139], v25 offset:10848
ds_read_b64_tr_b16 v[140:141], v12 offset:1024
ds_read_b64_tr_b16 v[142:143], v12 offset:1536
s_waitcnt lgkmcnt(6)
ds_read_b128 v[144:147], v24 offset:10496
ds_read_b128 v[148:151], v24 offset:10560
ds_read_b64 v[152:153], v25 offset:10880
ds_read_b64 v[154:155], v25 offset:10912
ds_read_b64_tr_b16 v[156:157], v12 offset:2048
ds_read_b64_tr_b16 v[158:159], v12 offset:2560
v_and_or_b32 v120, v120, v19, v18
v_and_or_b32 v121, v121, v19, v18
v_and_or_b32 v122, v122, v19, v18
v_and_or_b32 v123, v123, v19, v18
v_lshlrev_b32 v52, 16, v124
v_and_b32 v53, 0xffff0000, v124
v_lshlrev_b32 v54, 16, v125
v_and_b32 v55, 0xffff0000, v125
v_lshlrev_b32 v56, 16, v126
v_and_b32 v57, 0xffff0000, v126
v_lshlrev_b32 v58, 16, v127
v_and_b32 v59, 0xffff0000, v127
v_mfma_f32_16x16x32_bf16 v[96:99], v[124:127], v[120:123], v[96:99]
v_mul_f32 v52, v52, v112
v_mul_f32 v53, v53, v113
v_mul_f32 v54, v54, v114
v_mul_f32 v55, v55, v115
v_mul_f32 v56, v56, v116
v_mul_f32 v57, v57, v117
v_mul_f32 v58, v58, v118
v_mul_f32 v59, v59, v119
v_cvt_pk_bf16_f32 v60, v52, v53
v_cvt_pk_bf16_f32 v61, v54, v55
v_cvt_pk_bf16_f32 v62, v56, v57
v_cvt_pk_bf16_f32 v63, v58, v59
global_store_dwordx4 v26, v[60:63], s[14:15] sc1
v_add_u32 v26, 89088, v26
s_nop 0
v_mfma_f32_16x16x32_bf16 v[104:107], v[60:63], v[120:123], v[104:107]
s_waitcnt lgkmcnt(6)
ds_read_b128 v[160:163], v24 offset:10624
ds_read_b128 v[164:167], v24 offset:10688
ds_read_b64 v[168:169], v25 offset:10944
ds_read_b64 v[170:171], v25 offset:10976
ds_read_b64_tr_b16 v[172:173], v12 offset:3072
ds_read_b64_tr_b16 v[174:175], v12 offset:3584
v_and_or_b32 v136, v136, v19, v18
v_and_or_b32 v137, v137, v19, v18
v_and_or_b32 v138, v138, v19, v18
v_and_or_b32 v139, v139, v19, v18
v_lshlrev_b32 v52, 16, v140
v_and_b32 v53, 0xffff0000, v140
v_lshlrev_b32 v54, 16, v141
v_and_b32 v55, 0xffff0000, v141
v_lshlrev_b32 v56, 16, v142
v_and_b32 v57, 0xffff0000, v142
v_lshlrev_b32 v58, 16, v143
v_and_b32 v59, 0xffff0000, v143
v_mfma_f32_16x16x32_bf16 v[96:99], v[140:143], v[136:139], v[96:99]
v_mul_f32 v52, v52, v128
v_mul_f32 v53, v53, v129
v_mul_f32 v54, v54, v130
v_mul_f32 v55, v55, v131
v_mul_f32 v56, v56, v132
v_mul_f32 v57, v57, v133
v_mul_f32 v58, v58, v134
v_mul_f32 v59, v59, v135
v_cvt_pk_bf16_f32 v64, v52, v53
v_cvt_pk_bf16_f32 v65, v54, v55
v_cvt_pk_bf16_f32 v66, v56, v57
v_cvt_pk_bf16_f32 v67, v58, v59
global_store_dwordx4 v26, v[64:67], s[14:15] sc1
v_add_u32 v26, 89088, v26
s_nop 0
v_mfma_f32_16x16x32_bf16 v[104:107], v[64:67], v[136:139], v[104:107]
s_waitcnt lgkmcnt(6)
v_and_or_b32 v152, v152, v19, v18
v_and_or_b32 v153, v153, v19, v18
v_and_or_b32 v154, v154, v19, v18
v_and_or_b32 v155, v155, v19, v18
v_lshlrev_b32 v52, 16, v156
v_and_b32 v53, 0xffff0000, v156
v_lshlrev_b32 v54, 16, v157
v_and_b32 v55, 0xffff0000, v157
v_lshlrev_b32 v56, 16, v158
v_and_b32 v57, 0xffff0000, v158
v_lshlrev_b32 v58, 16, v159
v_and_b32 v59, 0xffff0000, v159
v_mfma_f32_16x16x32_bf16 v[96:99], v[156:159], v[152:155], v[96:99]
v_mul_f32 v52, v52, v144
v_mul_f32 v53, v53, v145
v_mul_f32 v54, v54, v146
v_mul_f32 v55, v55, v147
v_mul_f32 v56, v56, v148
v_mul_f32 v57, v57, v149
v_mul_f32 v58, v58, v150
v_mul_f32 v59, v59, v151
v_cvt_pk_bf16_f32 v60, v52, v53
v_cvt_pk_bf16_f32 v61, v54, v55
v_cvt_pk_bf16_f32 v62, v56, v57
v_cvt_pk_bf16_f32 v63, v58, v59
global_store_dwordx4 v26, v[60:63], s[14:15] sc1
v_add_u32 v26, 89088, v26
s_nop 0
v_mfma_f32_16x16x32_bf16 v[104:107], v[60:63], v[152:155], v[104:107]
s_waitcnt lgkmcnt(0)
v_and_or_b32 v168, v168, v19, v18
v_and_or_b32 v169, v169, v19, v18
v_and_or_b32 v170, v170, v19, v18
v_and_or_b32 v171, v171, v19, v18
v_lshlrev_b32 v52, 16, v172
v_and_b32 v53, 0xffff0000, v172
v_lshlrev_b32 v54, 16, v173
v_and_b32 v55, 0xffff0000, v173
v_lshlrev_b32 v56, 16, v174
v_and_b32 v57, 0xffff0000, v174
v_lshlrev_b32 v58, 16, v175
v_and_b32 v59, 0xffff0000, v175
v_mfma_f32_16x16x32_bf16 v[96:99], v[172:175], v[168:171], v[96:99]
v_mul_f32 v52, v52, v160
v_mul_f32 v53, v53, v161
v_mul_f32 v54, v54, v162
v_mul_f32 v55, v55, v163
v_mul_f32 v56, v56, v164
v_mul_f32 v57, v57, v165
v_mul_f32 v58, v58, v166
v_mul_f32 v59, v59, v167
v_cvt_pk_bf16_f32 v64, v52, v53
v_cvt_pk_bf16_f32 v65, v54, v55
v_cvt_pk_bf16_f32 v66, v56, v57
v_cvt_pk_bf16_f32 v67, v58, v59
global_store_dwordx4 v26, v[64:67], s[14:15] sc1
v_add_u32 v26, 89088, v26
s_nop 0
v_mfma_f32_16x16x32_bf16 v[104:107], v[64:67], v[168:171], v[104:107]
s_mul_i32 s30, s28, 16512
s_lshl_b32 s31, s29, 6
s_add_u32 s30, s30, s31
s_add_u32 s30, s30, 6553600
v_lshl_add_u32 v28, v4, 4, s30
v_add_u32 v29, 5504, v28
v_add_u32 v30, 5504, v29
s_nop 7
s_mov_b64 exec, s[50:51]
global_store_dwordx4 v28, v[104:107], s[14:15] sc1
global_store_dwordx4 v30, v[96:99], s[14:15] sc1
s_mov_b64 exec, s[52:53]
global_store_dwordx4 v29, v[96:99], s[14:15] sc1
s_mov_b64 exec, -1
s_branch K12_UDONE
K2_W2:
s_waitcnt vmcnt(0)
ds_write_b128 v11, v[32:35] offset:0
ds_write_b128 v11, v[36:39] offset:1280
ds_write_b128 v11, v[40:43] offset:2560
ds_write_b128 v11, v[44:47] offset:3840
ds_write_b128 v11, v[48:51] offset:5120
ds_write_b128 v11, v[52:55] offset:6400
ds_write_b128 v11, v[56:59] offset:7680
ds_write_b128 v11, v[60:63] offset:8960
s_lshr_b32 s30, s29, 1
s_mul_i32 s30, s30, 43
s_lshl_b32 s31, s28, 2
s_add_u32 s30, s30, s31
s_lshl_b32 s30, s30, 12
s_and_b32 s31, s29, 1
s_lshl_b32 s31, s31, 11
s_add_u32 s30, s30, s31
s_add_u32 s30, s30, 9437184
v_lshl_add_u32 v26, v1, 4, s30
s_waitcnt lgkmcnt(0)
ds_read_b64_tr_b16 v[44:45], v12 offset:0
ds_read_b64_tr_b16 v[46:47], v12 offset:1280
ds_read_b64_tr_b16 v[48:49], v12 offset:32
ds_read_b64_tr_b16 v[50:51], v12 offset:1312
s_waitcnt lgkmcnt(2)
global_store_dwordx4 v26, v[44:47], s[14:15] sc1
s_waitcnt lgkmcnt(0)
global_store_dwordx4 v26, v[48:51], s[14:15] offset:1024 sc1
v_add_u32 v26, 4096, v26
ds_read_b64_tr_b16 v[44:45], v12 offset:2560
ds_read_b64_tr_b16 v[46:47], v12 offset:3840
ds_read_b64_tr_b16 v[48:49], v12 offset:2592
ds_read_b64_tr_b16 v[50:51], v12 offset:3872
s_waitcnt lgkmcnt(2)
global_store_dwordx4 v26, v[44:47], s[14:15] sc1
s_waitcnt lgkmcnt(0)
global_store_dwordx4 v26, v[48:51], s[14:15] offset:1024 sc1
v_add_u32 v26, 4096, v26
ds_read_b64_tr_b16 v[44:45], v12 offset:5120
ds_read_b64_tr_b16 v[46:47], v12 offset:6400
ds_read_b64_tr_b16 v[48:49], v12 offset:5152
ds_read_b64_tr_b16 v[50:51], v12 offset:6432
s_waitcnt lgkmcnt(2)
global_store_dwordx4 v26, v[44:47], s[14:15] sc1
s_waitcnt lgkmcnt(0)
global_store_dwordx4 v26, v[48:51], s[14:15] offset:1024 sc1
v_add_u32 v26, 4096, v26
s_cmp_eq_u32 s28, 10
s_cbranch_scc1 K12_UDONE
ds_read_b64_tr_b16 v[44:45], v12 offset:7680
ds_read_b64_tr_b16 v[46:47], v12 offset:8960
ds_read_b64_tr_b16 v[48:49], v12 offset:7712
ds_read_b64_tr_b16 v[50:51], v12 offset:8992
s_waitcnt lgkmcnt(2)
global_store_dwordx4 v26, v[44:47], s[14:15] sc1
s_waitcnt lgkmcnt(0)
global_store_dwordx4 v26, v[48:51], s[14:15] offset:1024 sc1
v_add_u32 v26, 4096, v26
s_branch K12_UDONE
K2_TAB:
v_lshlrev_b32 v2, 5, v1
v_add_u32 v2, 6690816, v2
v_add_u32 v3, 4096, v2
global_load_dwordx4 v[112:115], v2, s[14:15] offset:0 sc1
global_load_dwordx4 v[116:119], v2, s[14:15] offset:16 sc1
global_load_dwordx4 v[120:123], v2, s[14:15] offset:2048 sc1
global_load_dwordx4 v[124:127], v2, s[14:15] offset:2064 sc1
global_load_dwordx4 v[128:131], v3, s[14:15] sc1
global_load_dwordx4 v[132:135], v3, s[14:15] offset:16 sc1
v_add_u32 v2, 12288, v2
v_add_u32 v3, 12288, v3
global_load_dwordx4 v[136:139], v2, s[14:15] offset:0 sc1
global_load_dwordx4 v[140:143], v2, s[14:15] offset:16 sc1
global_load_dwordx4 v[144:147], v2, s[14:15] offset:2048 sc1
global_load_dwordx4 v[148:151], v2, s[14:15] offset:2064 sc1
global_load_dwordx4 v[152:155], v3, s[14:15] sc1
global_load_dwordx4 v[156:159], v3, s[14:15] offset:16 sc1
v_add_u32 v2, 12288, v2
v_add_u32 v3, 12288, v3
global_load_dwordx4 v[160:163], v2, s[14:15] offset:0 sc1
global_load_dwordx4 v[164:167], v2, s[14:15] offset:16 sc1
global_load_dwordx4 v[168:171], v2, s[14:15] offset:2048 sc1
global_load_dwordx4 v[172:175], v2, s[14:15] offset:2064 sc1
global_load_dwordx4 v[176:179], v3, s[14:15] sc1
global_load_dwordx4 v[180:183], v3, s[14:15] offset:16 sc1
v_add_u32 v2, 12288, v2
v_add_u32 v3, 12288, v3
global_load_dwordx4 v[184:187], v2, s[14:15] offset:0 sc1
global_load_dwordx4 v[188:191], v2, s[14:15] offset:16 sc1
global_load_dwordx4 v[192:195], v2, s[14:15] offset:2048 sc1
global_load_dwordx4 v[196:199], v2, s[14:15] offset:2064 sc1
global_load_dwordx4 v[200:203], v3, s[14:15] sc1
global_load_dwordx4 v[204:207], v3, s[14:15] offset:16 sc1
s_waitcnt vmcnt(0)
v_add_f32 v112, v112, v136
v_add_f32 v160, v160, v184
v_add_f32 v112, v112, v160
v_add_f32 v113, v113, v137
v_add_f32 v161, v161, v185
v_add_f32 v113, v113, v161
v_add_f32 v114, v114, v138
v_add_f32 v162, v162, v186
v_add_f32 v114, v114, v162
v_add_f32 v115, v115, v139
v_add_f32 v163, v163, v187
v_add_f32 v115, v115, v163
v_add_f32 v116, v116, v140
v_add_f32 v164, v164, v188
v_add_f32 v116, v116, v164
v_add_f32 v117, v117, v141
v_add_f32 v165, v165, v189
v_add_f32 v117, v117, v165
v_add_f32 v118, v118, v142
v_add_f32 v166, v166, v190
v_add_f32 v118, v118, v166
v_add_f32 v119, v119, v143
v_add_f32 v167, v167, v191
v_add_f32 v119, v119, v167
v_add_f32 v120, v120, v144
v_add_f32 v168, v168, v192
v_add_f32 v120, v120, v168
v_add_f32 v121, v121, v145
v_add_f32 v169, v169, v193
v_add_f32 v121, v121, v169
v_add_f32 v122, v122, v146
v_add_f32 v170, v170, v194
v_add_f32 v122, v122, v170
v_add_f32 v123, v123, v147
v_add_f32 v171, v171, v195
v_add_f32 v123, v123, v171
v_add_f32 v124, v124, v148
v_add_f32 v172, v172, v196
v_add_f32 v124, v124, v172
v_add_f32 v125, v125, v149
v_add_f32 v173, v173, v197
v_add_f32 v125, v125, v173
v_add_f32 v126, v126, v150
v_add_f32 v174, v174, v198
v_add_f32 v126, v126, v174
v_add_f32 v127, v127, v151
v_add_f32 v175, v175, v199
v_add_f32 v127, v127, v175
v_add_f32 v128, v128, v152
v_add_f32 v176, v176, v200
v_add_f32 v128, v128, v176
v_add_f32 v129, v129, v153
v_add_f32 v177, v177, v201
v_add_f32 v129, v129, v177
v_add_f32 v130, v130, v154
v_add_f32 v178, v178, v202
v_add_f32 v130, v130, v178
v_add_f32 v131, v131, v155
v_add_f32 v179, v179, v203
v_add_f32 v131, v131, v179
v_add_f32 v132, v132, v156
v_add_f32 v180, v180, v204
v_add_f32 v132, v132, v180
v_add_f32 v133, v133, v157
v_add_f32 v181, v181, v205
v_add_f32 v133, v133, v181
v_add_f32 v134, v134, v158
v_add_f32 v182, v182, v206
v_add_f32 v134, v134, v182
v_add_f32 v135, v135, v159
v_add_f32 v183, v183, v207
v_add_f32 v135, v135, v183
v_cvt_pk_bf16_f32 v112, v112, v112
v_and_b32 v112, 0xffff0000, v112
v_cvt_pk_bf16_f32 v113, v113, v113
v_and_b32 v113, 0xffff0000, v113
v_cvt_pk_bf16_f32 v114, v114, v114
v_and_b32 v114, 0xffff0000, v114
v_cvt_pk_bf16_f32 v115, v115, v115
v_and_b32 v115, 0xffff0000, v115
v_cvt_pk_bf16_f32 v116, v116, v116
v_and_b32 v116, 0xffff0000, v116
v_cvt_pk_bf16_f32 v117, v117, v117
v_and_b32 v117, 0xffff0000, v117
v_cvt_pk_bf16_f32 v118, v118, v118
v_and_b32 v118, 0xffff0000, v118
v_cvt_pk_bf16_f32 v119, v119, v119
v_and_b32 v119, 0xffff0000, v119
v_cvt_pk_bf16_f32 v120, v120, v120
v_and_b32 v120, 0xffff0000, v120
v_cvt_pk_bf16_f32 v121, v121, v121
v_and_b32 v121, 0xffff0000, v121
v_cvt_pk_bf16_f32 v122, v122, v122
v_and_b32 v122, 0xffff0000, v122
v_cvt_pk_bf16_f32 v123, v123, v123
v_and_b32 v123, 0xffff0000, v123
v_cvt_pk_bf16_f32 v124, v124, v124
v_and_b32 v124, 0xffff0000, v124
v_cvt_pk_bf16_f32 v125, v125, v125
v_and_b32 v125, 0xffff0000, v125
v_cvt_pk_bf16_f32 v126, v126, v126
v_and_b32 v126, 0xffff0000, v126
v_cvt_pk_bf16_f32 v127, v127, v127
v_and_b32 v127, 0xffff0000, v127
v_cvt_pk_bf16_f32 v128, v128, v128
v_and_b32 v128, 0xffff0000, v128
v_cvt_pk_bf16_f32 v129, v129, v129
v_and_b32 v129, 0xffff0000, v129
v_cvt_pk_bf16_f32 v130, v130, v130
v_and_b32 v130, 0xffff0000, v130
v_cvt_pk_bf16_f32 v131, v131, v131
v_and_b32 v131, 0xffff0000, v131
v_cvt_pk_bf16_f32 v132, v132, v132
v_and_b32 v132, 0xffff0000, v132
v_cvt_pk_bf16_f32 v133, v133, v133
v_and_b32 v133, 0xffff0000, v133
v_cvt_pk_bf16_f32 v134, v134, v134
v_and_b32 v134, 0xffff0000, v134
v_cvt_pk_bf16_f32 v135, v135, v135
v_and_b32 v135, 0xffff0000, v135
v_mov_b32 v32, v112
v_mov_b32 v40, v120
v_mov_b32 v33, v113
v_mov_b32 v41, v121
v_mov_b32 v34, v114
v_mov_b32 v42, v122
v_mov_b32 v35, v115
v_mov_b32 v43, v123
v_mov_b32 v36, v116
v_mov_b32 v44, v124
v_mov_b32 v37, v117
v_mov_b32 v45, v125
v_mov_b32 v38, v118
v_mov_b32 v46, v126
v_mov_b32 v39, v119
v_mov_b32 v47, v127
v_lshlrev_b32 v3, 5, v1
v_add_u32 v3, 6507520, v3
global_store_dwordx4 v3, v[128:131], s[14:15] sc1
global_store_dwordx4 v3, v[132:135], s[14:15] offset:16 sc1
v_add_f32 v40, 1.0, v40
v_add_f32 v41, 1.0, v41
v_add_f32 v42, 1.0, v42
v_add_f32 v43, 1.0, v43
v_add_f32 v44, 1.0, v44
v_add_f32 v45, 1.0, v45
v_add_f32 v46, 1.0, v46
v_add_f32 v47, 1.0, v47
v_cvt_pk_bf16_f32 v40, v40, v40
v_and_b32 v40, 0xffff0000, v40
v_cvt_pk_bf16_f32 v41, v41, v41
v_and_b32 v41, 0xffff0000, v41
v_cvt_pk_bf16_f32 v42, v42, v42
v_and_b32 v42, 0xffff0000, v42
v_cvt_pk_bf16_f32 v43, v43, v43
v_and_b32 v43, 0xffff0000, v43
v_cvt_pk_bf16_f32 v44, v44, v44
v_and_b32 v44, 0xffff0000, v44
v_cvt_pk_bf16_f32 v45, v45, v45
v_and_b32 v45, 0xffff0000, v45
v_cvt_pk_bf16_f32 v46, v46, v46
v_and_b32 v46, 0xffff0000, v46
v_cvt_pk_bf16_f32 v47, v47, v47
v_and_b32 v47, 0xffff0000, v47
v_mul_f32 v48, v40, v40
v_mul_f32 v49, v41, v41
v_mul_f32 v50, v42, v42
v_mul_f32 v51, v43, v43
v_mul_f32 v52, v44, v44
v_mul_f32 v53, v45, v45
v_mul_f32 v54, v46, v46
v_mul_f32 v55, v47, v47
v_mul_f32 v56, v40, v32
v_mul_f32 v57, v41, v33
v_mul_f32 v58, v42, v34
v_mul_f32 v59, v43, v35
v_mul_f32 v60, v44, v36
v_mul_f32 v61, v45, v37
v_mul_f32 v62, v46, v38
v_mul_f32 v63, v47, v39
v_lshlrev_b32 v3, 5, v1
v_add_u32 v3, 6505472, v3
global_store_dwordx4 v3, v[48:51], s[14:15] sc1
global_store_dwordx4 v3, v[52:55], s[14:15] offset:16 sc1
v_add_f32 v100, v40, v41
v_add_f32 v100, v100, v42
v_add_f32 v100, v100, v43
v_add_f32 v100, v100, v44
v_add_f32 v100, v100, v45
v_add_f32 v100, v100, v46
v_add_f32 v100, v100, v47
v_add_f32 v101, v48, v49
v_add_f32 v101, v101, v50
v_add_f32 v101, v101, v51
v_add_f32 v101, v101, v52
v_add_f32 v101, v101, v53
v_add_f32 v101, v101, v54
v_add_f32 v101, v101, v55
v_add_f32 v102, v56, v57
v_add_f32 v102, v102, v58
v_add_f32 v102, v102, v59
v_add_f32 v102, v102, v60
v_add_f32 v102, v102, v61
v_add_f32 v102, v102, v62
v_add_f32 v102, v102, v63
v_add_f32 v103, v32, v33
v_add_f32 v103, v103, v34
v_add_f32 v103, v103, v35
v_add_f32 v103, v103, v36
v_add_f32 v103, v103, v37
v_add_f32 v103, v103, v38
v_add_f32 v103, v103, v39
v_mul_f32 v104, v32, v32
v_fmac_f32 v104, v33, v33
v_fmac_f32 v104, v34, v34
v_fmac_f32 v104, v35, v35
v_fmac_f32 v104, v36, v36
v_fmac_f32 v104, v37, v37
v_fmac_f32 v104, v38, v38
v_fmac_f32 v104, v39, v39
v_lshl_add_u32 v4, v1, 4, s27
v_mov_b32 v64, 0x3f803f80
v_mov_b32 v65, 0x3f803f80
v_mov_b32 v66, 0x3f803f80
v_mov_b32 v67, 0x3f803f80
ds_write_b128 v4, v[64:67]
v_cvt_pk_bf16_f32 v68, v40, v41
v_cvt_pk_bf16_f32 v69, v42, v43
v_cvt_pk_bf16_f32 v70, v44, v45
v_cvt_pk_bf16_f32 v71, v46, v47
ds_write_b128 v4, v[68:71] offset:1024
v_cvt_pk_bf16_f32 v72, v48, v49
v_cvt_pk_bf16_f32 v73, v50, v51
v_cvt_pk_bf16_f32 v74, v52, v53
v_cvt_pk_bf16_f32 v75, v54, v55
ds_write_b128 v4, v[72:75] offset:2048
v_lshlrev_b32 v80, 16, v72
v_and_b32 v81, 0xffff0000, v72
v_lshlrev_b32 v82, 16, v73
v_and_b32 v83, 0xffff0000, v73
v_lshlrev_b32 v84, 16, v74
v_and_b32 v85, 0xffff0000, v74
v_lshlrev_b32 v86, 16, v75
v_and_b32 v87, 0xffff0000, v75
v_sub_f32 v80, v48, v80
v_sub_f32 v81, v49, v81
v_sub_f32 v82, v50, v82
v_sub_f32 v83, v51, v83
v_sub_f32 v84, v52, v84
v_sub_f32 v85, v53, v85
v_sub_f32 v86, v54, v86
v_sub_f32 v87, v55, v87
v_cvt_pk_bf16_f32 v76, v80, v81
v_cvt_pk_bf16_f32 v77, v82, v83
v_cvt_pk_bf16_f32 v78, v84, v85
v_cvt_pk_bf16_f32 v79, v86, v87
ds_write_b128 v4, v[76:79] offset:3072
v_cvt_pk_bf16_f32 v72, v56, v57
v_cvt_pk_bf16_f32 v73, v58, v59
v_cvt_pk_bf16_f32 v74, v60, v61
v_cvt_pk_bf16_f32 v75, v62, v63
ds_write_b128 v4, v[72:75] offset:4096
v_lshlrev_b32 v80, 16, v72
v_and_b32 v81, 0xffff0000, v72
v_lshlrev_b32 v82, 16, v73
v_and_b32 v83, 0xffff0000, v73
v_lshlrev_b32 v84, 16, v74
v_and_b32 v85, 0xffff0000, v74
v_lshlrev_b32 v86, 16, v75
v_and_b32 v87, 0xffff0000, v75
v_sub_f32 v80, v56, v80
v_sub_f32 v81, v57, v81
v_sub_f32 v82, v58, v82
v_sub_f32 v83, v59, v83
v_sub_f32 v84, v60, v84
v_sub_f32 v85, v61, v85
v_sub_f32 v86, v62, v86
v_sub_f32 v87, v63, v87
v_cvt_pk_bf16_f32 v76, v80, v81
v_cvt_pk_bf16_f32 v77, v82, v83
v_cvt_pk_bf16_f32 v78, v84, v85
v_cvt_pk_bf16_f32 v79, v86, v87
ds_write_b128 v4, v[76:79] offset:5120
s_nop 1
v_add_f32_dpp v100, v100, v100 row_shr:1
v_add_f32_dpp v101, v101, v101 row_shr:1
v_add_f32_dpp v102, v102, v102 row_shr:1
v_add_f32_dpp v103, v103, v103 row_shr:1
v_add_f32_dpp v104, v104, v104 row_shr:1
v_add_f32_dpp v100, v100, v100 row_shr:2
v_add_f32_dpp v101, v101, v101 row_shr:2
v_add_f32_dpp v102, v102, v102 row_shr:2
v_add_f32_dpp v103, v103, v103 row_shr:2
v_add_f32_dpp v104, v104, v104 row_shr:2
v_add_f32_dpp v100, v100, v100 row_shr:4
v_add_f32_dpp v101, v101, v101 row_shr:4
v_add_f32_dpp v102, v102, v102 row_shr:4
v_add_f32_dpp v103, v103, v103 row_shr:4
v_add_f32_dpp v104, v104, v104 row_shr:4
v_add_f32_dpp v100, v100, v100 row_shr:8
v_add_f32_dpp v101, v101, v101 row_shr:8
v_add_f32_dpp v102, v102, v102 row_shr:8
v_add_f32_dpp v103, v103, v103 row_shr:8
v_add_f32_dpp v104, v104, v104 row_shr:8
v_add_f32_dpp v100, v100, v100 row_bcast:15 row_mask:0xa
v_add_f32_dpp v101, v101, v101 row_bcast:15 row_mask:0xa
v_add_f32_dpp v102, v102, v102 row_bcast:15 row_mask:0xa
v_add_f32_dpp v103, v103, v103 row_bcast:15 row_mask:0xa
v_add_f32_dpp v104, v104, v104 row_bcast:15 row_mask:0xa
v_add_f32_dpp v100, v100, v100 row_bcast:31 row_mask:0xc
v_add_f32_dpp v101, v101, v101 row_bcast:31 row_mask:0xc
v_add_f32_dpp v102, v102, v102 row_bcast:31 row_mask:0xc
v_add_f32_dpp v103, v103, v103 row_bcast:31 row_mask:0xc
v_add_f32_dpp v104, v104, v104 row_bcast:31 row_mask:0xc
v_mov_b32 v5, 6504448
s_mov_b64 s[42:43], exec
v_cmp_eq_u32 vcc, 63, v1
s_and_saveexec_b64 s[42:43], vcc
global_store_dwordx4 v5, v[100:103], s[14:15] sc1
global_store_dword v5, v104, s[14:15] offset:16 sc1
s_mov_b64 exec, s[42:43]
v_and_b32 v6, 15, v1
v_lshrrev_b32 v7, 4, v1
v_min_u32 v8, 5, v6
v_lshlrev_b32 v8, 10, v8
v_lshl_add_u32 v8, v7, 3, v8
v_add_u32 v8, s27, v8
v_cmp_gt_u32 vcc, 6, v6
v_mov_b32 v9, 0
s_nop 0
v_cndmask_b32 v9, v9, -1, vcc
s_sub_u32 s31, s26, 520
s_mul_i32 s30, s31, 712704
s_add_u32 s30, s30, 7428096
v_lshl_add_u32 v10, v1, 4, s30
s_lshl_b32 s31, s31, 9
v_add_u32 v8, s31, v8
s_waitcnt lgkmcnt(0)
ds_read_b64 v[112:113], v8 offset:0
ds_read_b64 v[114:115], v8 offset:32
ds_read_b64 v[116:117], v8 offset:64
ds_read_b64 v[118:119], v8 offset:96
ds_read_b64 v[120:121], v8 offset:128
ds_read_b64 v[122:123], v8 offset:160
ds_read_b64 v[124:125], v8 offset:192
ds_read_b64 v[126:127], v8 offset:224
ds_read_b64 v[128:129], v8 offset:256
ds_read_b64 v[130:131], v8 offset:288
ds_read_b64 v[132:133], v8 offset:320
ds_read_b64 v[134:135], v8 offset:352
ds_read_b64 v[136:137], v8 offset:384
ds_read_b64 v[138:139], v8 offset:416
s_waitcnt lgkmcnt(6)
ds_read_b64 v[140:141], v8 offset:448
ds_read_b64 v[142:143], v8 offset:480
v_and_b32 v112, v112, v9
v_and_b32 v113, v113, v9
v_and_b32 v114, v114, v9
v_and_b32 v115, v115, v9
global_store_dwordx4 v10, v[112:115], s[14:15] sc1
v_add_u32 v10, 89088, v10
v_and_b32 v116, v116, v9
v_and_b32 v117, v117, v9
v_and_b32 v118, v118, v9
v_and_b32 v119, v119, v9
global_store_dwordx4 v10, v[116:119], s[14:15] sc1
v_add_u32 v10, 89088, v10
v_and_b32 v120, v120, v9
v_and_b32 v121, v121, v9
v_and_b32 v122, v122, v9
v_and_b32 v123, v123, v9
global_store_dwordx4 v10, v[120:123], s[14:15] sc1
v_add_u32 v10, 89088, v10
v_and_b32 v124, v124, v9
v_and_b32 v125, v125, v9
v_and_b32 v126, v126, v9
v_and_b32 v127, v127, v9
global_store_dwordx4 v10, v[124:127], s[14:15] sc1
v_add_u32 v10, 89088, v10
s_waitcnt lgkmcnt(0)
v_and_b32 v128, v128, v9
v_and_b32 v129, v129, v9
v_and_b32 v130, v130, v9
v_and_b32 v131, v131, v9
global_store_dwordx4 v10, v[128:131], s[14:15] sc1
v_add_u32 v10, 89088, v10
v_and_b32 v132, v132, v9
v_and_b32 v133, v133, v9
v_and_b32 v134, v134, v9
v_and_b32 v135, v135, v9
global_store_dwordx4 v10, v[132:135], s[14:15] sc1
v_add_u32 v10, 89088, v10
v_and_b32 v136, v136, v9
v_and_b32 v137, v137, v9
v_and_b32 v138, v138, v9
v_and_b32 v139, v139, v9
global_store_dwordx4 v10, v[136:139], s[14:15] sc1
v_add_u32 v10, 89088, v10
v_and_b32 v140, v140, v9
v_and_b32 v141, v141, v9
v_and_b32 v142, v142, v9
v_and_b32 v143, v143, v9
global_store_dwordx4 v10, v[140:143], s[14:15] sc1
v_add_u32 v10, 89088, v10
s_branch K12_UDONE
K12_UDONE:
s_branch K2_END
K2_SIDE_IDLE:
K2_END:
K2_EXIT:
s_endpgm
.section .rodata,"a"
.p2align 6
.amdhsa_kernel k12_kernel
  .amdhsa_next_free_vgpr 208
  .amdhsa_next_free_sgpr 100
  .amdhsa_accum_offset 208
  .amdhsa_group_segment_fixed_size 0
  .amdhsa_kernarg_size 136
  .amdhsa_user_sgpr_count 2
  .amdhsa_user_sgpr_kernarg_segment_ptr 1
  .amdhsa_system_sgpr_workgroup_id_x 1
  .amdhsa_float_denorm_mode_32 3
.end_amdhsa_kernel
.text
.globl k3_kernel
.p2align 8
.type k3_kernel,@function
k3_kernel:
s_cmp_ge_u32 s2, 256
s_cbranch_scc1 K3_EXIT
s_load_dwordx2 s[14:15], s[0:1], 128
s_load_dwordx2 s[12:13], s[0:1], 72
s_load_dwordx2 s[16:17], s[0:1], 88
s_load_dwordx2 s[18:19], s[0:1], 112
v_lshrrev_b32 v1, 6, v0
s_nop 0
v_readfirstlane_b32 s24, v1
v_and_b32 v1, 63, v0
s_and_b32 s25, s2, 7
s_lshr_b32 s26, s2, 3
s_lshr_b32 s27, s26, 3
s_lshl_b32 s25, s25, 2
s_add_u32 s25, s25, s27
s_and_b32 s26, s26, 7
s_and_b32 s22, s25, 3
s_lshl_b32 s23, s22, 1
s_add_u32 s23, s23, s26
s_lshl_b32 s23, s23, 1
s_and_b32 s23, s23, 15
s_mul_i32 s22, s22, 3
s_add_u32 s22, s22, s26
s_sub_u32 s21, s22, 11
s_cmp_ge_u32 s22, 11
s_cselect_b32 s22, s21, s22
s_mov_b32 s23, 0
s_mov_b32 s22, 0
s_mul_i32 s27, s26, 11
s_min_u32 s27, s27, 76
s_cmp_lt_u32 s26, 6
s_cselect_b32 s28, 11, 10
s_mul_i32 s29, s24, 3
s_add_u32 s30, s29, 0
s_add_u32 s31, s30, s27
s_cmp_lt_u32 s30, s28
s_cselect_b32 s32, s31, 86
s_add_u32 s30, s29, 1
s_add_u32 s31, s30, s27
s_cmp_lt_u32 s30, s28
s_cselect_b32 s33, s31, 86
s_add_u32 s30, s29, 2
s_add_u32 s31, s30, s27
s_cmp_lt_u32 s30, s28
s_cselect_b32 s34, s31, 86
v_lshrrev_b32 v10, 3, v1
v_and_b32 v11, 6, v10
v_and_b32 v12, 7, v1
v_xor_b32 v11, v11, v12
v_lshlrev_b32 v11, 4, v11
v_lshl_add_u32 v11, v10, 7, v11
s_lshl_b32 s41, s24, 10
s_lshl_b32 s42, s25, 16
s_add_u32 s41, s41, s42
s_add_u32 s41, s41, 2097152
s_lshl_b32 s42, s24, 10
v_lshlrev_b32 v13, 4, v1
s_lshl_b32 s30, s32, 10
v_add_u32 v126, s30, v13
s_lshl_b32 s30, s33, 10
v_add_u32 v127, s30, v13
s_lshl_b32 s30, s34, 10
v_add_u32 v128, s30, v13
s_mov_b32 s47, s23
s_lshl_b32 s46, s23, 12
v_lshrrev_b32 v3, 4, v1
v_and_b32 v6, 15, v1
v_mov_b32 v7, s32
v_mov_b32 v8, s33
v_mov_b32 v9, s34
v_cmp_eq_u32 vcc, 1, v3
v_cmp_le_u32 s[52:53], 2, v3
s_nop 0
v_cndmask_b32 v7, v7, v8, vcc
v_cndmask_b32 v7, v7, v9, s[52:53]
v_min_u32 v7, 85, v7
v_lshl_add_u32 v7, v7, 4, v6
v_lshlrev_b32 v8, 2, v7
v_add_u32 v8, 6553600, v8
v_lshlrev_b32 v9, 1, v7
s_waitcnt lgkmcnt(0)
s_mov_b32 s8, s14
s_mov_b32 s9, s15
s_mov_b32 s10, 17825792
s_mov_b32 s11, 0x20000
s_mov_b32 m0, s42
s_add_u32 s45, s41, s46
s_add_u32 s42, s42, 4096
buffer_load_dwordx4 v11, s[8:11], s45 offen lds
s_add_u32 s46, s46, 4096
s_and_b32 s46, s46, 0xffff
s_mov_b32 m0, s42
s_add_u32 s45, s41, s46
s_add_u32 s42, s42, 4096
buffer_load_dwordx4 v11, s[8:11], s45 offen lds
s_add_u32 s46, s46, 4096
s_and_b32 s46, s46, 0xffff
s_mov_b32 m0, s42
s_add_u32 s45, s41, s46
s_add_u32 s42, s42, 4096
buffer_load_dwordx4 v11, s[8:11], s45 offen lds
s_add_u32 s46, s46, 4096
s_and_b32 s46, s46, 0xffff
s_mov_b32 m0, s42
s_add_u32 s45, s41, s46
s_add_u32 s42, s42, 4096
buffer_load_dwordx4 v11, s[8:11], s45 offen lds
s_add_u32 s46, s46, 4096
s_and_b32 s46, s46, 0xffff
s_mov_b32 m0, s42
s_add_u32 s45, s41, s46
s_add_u32 s42, s42, 4096
buffer_load_dwordx4 v11, s[8:11], s45 offen lds
s_add_u32 s46, s46, 4096
s_and_b32 s46, s46, 0xffff
s_mov_b32 m0, s42
s_add_u32 s45, s41, s46
s_add_u32 s42, s42, 4096
buffer_load_dwordx4 v11, s[8:11], s45 offen lds
s_add_u32 s46, s46, 4096
s_and_b32 s46, s46, 0xffff
s_mov_b32 m0, s42
s_add_u32 s45, s41, s46
s_add_u32 s42, s42, 4096
buffer_load_dwordx4 v11, s[8:11], s45 offen lds
s_add_u32 s46, s46, 4096
s_and_b32 s46, s46, 0xffff
s_mov_b32 m0, s42
s_add_u32 s45, s41, s46
s_add_u32 s42, s42, 4096
buffer_load_dwordx4 v11, s[8:11], s45 offen lds
s_add_u32 s46, s46, 4096
s_and_b32 s46, s46, 0xffff
s_mov_b32 m0, s42
s_add_u32 s45, s41, s46
s_add_u32 s42, s42, 4096
buffer_load_dwordx4 v11, s[8:11], s45 offen lds
s_add_u32 s46, s46, 4096
s_and_b32 s46, s46, 0xffff
s_mov_b32 m0, s42
s_add_u32 s45, s41, s46
s_add_u32 s42, s42, 4096
buffer_load_dwordx4 v11, s[8:11], s45 offen lds
s_add_u32 s46, s46, 4096
s_and_b32 s46, s46, 0xffff
s_mov_b32 m0, s42
s_add_u32 s45, s41, s46
s_add_u32 s42, s42, 4096
buffer_load_dwordx4 v11, s[8:11], s45 offen lds
s_add_u32 s46, s46, 4096
s_and_b32 s46, s46, 0xffff
s_mov_b32 m0, s42
s_add_u32 s45, s41, s46
s_add_u32 s42, s42, 4096
buffer_load_dwordx4 v11, s[8:11], s45 offen lds
s_add_u32 s46, s46, 4096
s_and_b32 s46, s46, 0xffff
s_mov_b32 m0, s42
s_add_u32 s45, s41, s46
s_add_u32 s42, s42, 4096
buffer_load_dwordx4 v11, s[8:11], s45 offen lds
s_add_u32 s46, s46, 4096
s_and_b32 s46, s46, 0xffff
s_mov_b32 m0, s42
s_add_u32 s45, s41, s46
s_add_u32 s42, s42, 4096
buffer_load_dwordx4 v11, s[8:11], s45 offen lds
s_add_u32 s46, s46, 4096
s_and_b32 s46, s46, 0xffff
s_mov_b32 m0, s42
s_add_u32 s45, s41, s46
s_add_u32 s42, s42, 4096
buffer_load_dwordx4 v11, s[8:11], s45 offen lds
s_add_u32 s46, s46, 4096
s_and_b32 s46, s46, 0xffff
s_mov_b32 m0, s42
s_add_u32 s45, s41, s46
s_add_u32 s42, s42, 4096
buffer_load_dwordx4 v11, s[8:11], s45 offen lds
s_add_u32 s46, s46, 4096
s_and_b32 s46, s46, 0xffff
s_lshl_b32 s30, s24, 2
s_lshl_b32 s42, s24, 12
s_add_u32 s42, s42, 76800
s_add_u32 s31, s30, 0
s_add_u32 s31, s31, s23
s_and_b32 s31, s31, 15
s_mul_i32 s31, s31, 89088
s_add_u32 s31, s31, 7428096
s_mov_b32 m0, s42
s_add_u32 s42, s42, 1024
buffer_load_dwordx4 v13, s[8:11], s31 offen lds
s_add_u32 s31, s30, 1
s_add_u32 s31, s31, s23
s_and_b32 s31, s31, 15
s_mul_i32 s31, s31, 89088
s_add_u32 s31, s31, 7428096
s_mov_b32 m0, s42
s_add_u32 s42, s42, 1024
buffer_load_dwordx4 v13, s[8:11], s31 offen lds
s_add_u32 s31, s30, 2
s_add_u32 s31, s31, s23
s_and_b32 s31, s31, 15
s_mul_i32 s31, s31, 89088
s_add_u32 s31, s31, 7428096
s_mov_b32 m0, s42
s_add_u32 s42, s42, 1024
buffer_load_dwordx4 v13, s[8:11], s31 offen lds
s_add_u32 s31, s30, 3
s_add_u32 s31, s31, s23
s_and_b32 s31, s31, 15
s_mul_i32 s31, s31, 89088
s_add_u32 s31, s31, 7428096
s_mov_b32 m0, s42
s_add_u32 s42, s42, 1024
buffer_load_dwordx4 v13, s[8:11], s31 offen lds
s_mul_i32 s44, s47, 89088
s_add_u32 s44, s44, 7340032
buffer_load_dwordx4 a[0:3], v126, s[8:11], s44 offen
buffer_load_dwordx4 a[4:7], v127, s[8:11], s44 offen
buffer_load_dwordx4 a[8:11], v128, s[8:11], s44 offen
s_add_u32 s47, s47, 1
s_and_b32 s47, s47, 15
s_mul_i32 s44, s47, 89088
s_add_u32 s44, s44, 7340032
buffer_load_dwordx4 a[12:15], v126, s[8:11], s44 offen
buffer_load_dwordx4 a[16:19], v127, s[8:11], s44 offen
buffer_load_dwordx4 a[20:23], v128, s[8:11], s44 offen
s_add_u32 s47, s47, 1
s_and_b32 s47, s47, 15
s_mul_i32 s44, s47, 89088
s_add_u32 s44, s44, 7340032
buffer_load_dwordx4 a[24:27], v126, s[8:11], s44 offen
buffer_load_dwordx4 a[28:31], v127, s[8:11], s44 offen
buffer_load_dwordx4 a[32:35], v128, s[8:11], s44 offen
s_add_u32 s47, s47, 1
s_and_b32 s47, s47, 15
s_mul_i32 s44, s47, 89088
s_add_u32 s44, s44, 7340032
buffer_load_dwordx4 a[36:39], v126, s[8:11], s44 offen
buffer_load_dwordx4 a[40:43], v127, s[8:11], s44 offen
buffer_load_dwordx4 a[44:47], v128, s[8:11], s44 offen
s_add_u32 s47, s47, 1
s_and_b32 s47, s47, 15
s_mul_i32 s44, s47, 89088
s_add_u32 s44, s44, 7340032
buffer_load_dwordx4 a[48:51], v126, s[8:11], s44 offen
buffer_load_dwordx4 a[52:55], v127, s[8:11], s44 offen
buffer_load_dwordx4 a[56:59], v128, s[8:11], s44 offen
s_add_u32 s47, s47, 1
s_and_b32 s47, s47, 15
s_mul_i32 s44, s47, 89088
s_add_u32 s44, s44, 7340032
buffer_load_dwordx4 a[60:63], v126, s[8:11], s44 offen
buffer_load_dwordx4 a[64:67], v127, s[8:11], s44 offen
buffer_load_dwordx4 a[68:71], v128, s[8:11], s44 offen
s_add_u32 s47, s47, 1
s_and_b32 s47, s47, 15
s_mov_b32 s30, 6504448
s_load_dwordx4 s[36:39], s[14:15], s30
s_mov_b32 s31, 6504464
s_load_dword s40, s[14:15], s31
v_bfe_u32 v14, v1, 2, 2
v_lshl_add_u32 v14, v3, 2, v14
v_and_b32 v15, 6, v14
v_lshrrev_b32 v15, 1, v15
v_and_b32 v29, 3, v1
v_lshlrev_b32 v30, 7, v14
v_lshl_add_u32 v30, v29, 3, v30
s_add_u32 s30, s24, 0
s_and_b32 s48, s30, 3
v_xor_b32 v31, s48, v15
v_lshl_add_u32 v20, v31, 5, v30
s_add_u32 s30, s24, 1
s_and_b32 s49, s30, 3
v_xor_b32 v31, s49, v15
v_lshl_add_u32 v21, v31, 5, v30
s_add_u32 s30, s24, 2
s_and_b32 s50, s30, 3
v_xor_b32 v31, s50, v15
v_lshl_add_u32 v22, v31, 5, v30
s_add_u32 s30, s24, 3
s_and_b32 s51, s30, 3
v_xor_b32 v31, s51, v15
v_lshl_add_u32 v23, v31, 5, v30
v_xor_b32 v31, s24, v15
v_lshl_add_u32 v26, v31, 5, v30
s_lshl_b32 s30, s26, 1
s_sub_u32 s30, s30, s23
s_add_u32 s31, s30, 1
s_and_b32 s30, s30, 15
s_and_b32 s31, s31, 15
s_lshl_b32 s30, s30, 12
s_lshl_b32 s31, s31, 12
v_add_u32 v125, s31, v26
v_add_u32 v26, s30, v26
v_add_u32 v24, 76800, v13
v_mov_b32 v160, 0
v_mov_b32 v161, 0
v_mov_b32 v162, 0
v_mov_b32 v163, 0
v_mov_b32 v164, 0
v_mov_b32 v165, 0
v_mov_b32 v166, 0
v_mov_b32 v167, 0
v_mov_b32 v168, 0
v_mov_b32 v169, 0
v_mov_b32 v170, 0
v_mov_b32 v171, 0
v_mov_b32 v172, 0
v_mov_b32 v173, 0
v_mov_b32 v174, 0
v_mov_b32 v175, 0
v_mov_b32 v176, 0
v_mov_b32 v177, 0
v_mov_b32 v178, 0
v_mov_b32 v179, 0
v_mov_b32 v180, 0
v_mov_b32 v181, 0
v_mov_b32 v182, 0
v_mov_b32 v183, 0
v_mov_b32 v184, 0
v_mov_b32 v185, 0
v_mov_b32 v186, 0
v_mov_b32 v187, 0
v_mov_b32 v188, 0
v_mov_b32 v189, 0
v_mov_b32 v190, 0
v_mov_b32 v191, 0
v_mov_b32 v192, 0
v_mov_b32 v193, 0
v_mov_b32 v194, 0
v_mov_b32 v195, 0
v_mov_b32 v196, 0
v_mov_b32 v197, 0
v_mov_b32 v198, 0
v_mov_b32 v199, 0
v_mov_b32 v200, 0
v_mov_b32 v201, 0
v_mov_b32 v202, 0
v_mov_b32 v203, 0
v_mov_b32 v204, 0
v_mov_b32 v205, 0
v_mov_b32 v206, 0
v_mov_b32 v207, 0
v_mov_b32 v96, 0
v_mov_b32 v97, 0
v_mov_b32 v98, 0
v_mov_b32 v99, 0
v_mov_b32 v100, 0
v_mov_b32 v101, 0
v_mov_b32 v102, 0
v_mov_b32 v103, 0
v_mov_b32 v104, 0
v_mov_b32 v105, 0
v_mov_b32 v106, 0
v_mov_b32 v107, 0
s_waitcnt vmcnt(18) lgkmcnt(0)
s_barrier
ds_read_b64_tr_b16 v[32:33], v20 offset:0
ds_read_b64_tr_b16 v[34:35], v20 offset:2048
ds_read_b64_tr_b16 v[36:37], v21 offset:0
ds_read_b64_tr_b16 v[38:39], v21 offset:2048
ds_read_b64_tr_b16 v[40:41], v22 offset:0
ds_read_b64_tr_b16 v[42:43], v22 offset:2048
ds_read_b64_tr_b16 v[44:45], v23 offset:0
ds_read_b64_tr_b16 v[46:47], v23 offset:2048
ds_read_b128 v[64:67], v24 offset:0
s_mul_i32 s58, s24, 10
s_mul_i32 s67, s26, 5
s_mul_i32 s59, s26, 43
s_lshl_b32 s59, s59, 12
s_add_u32 s59, s59, 9437184
s_mov_b32 s60, s14
s_mov_b32 s61, s15
s_mov_b32 s62, 17825792
s_mov_b32 s63, 0x20000
s_mov_b32 s64, s58
s_lshl_b32 s30, s26, 8
s_add_u32 s30, s30, 6507520
v_lshl_add_u32 v27, v3, 4, s30
s_lshl_b32 s30, s26, 7
v_lshl_add_u32 v28, v3, 3, s30
s_waitcnt vmcnt(15) lgkmcnt(0)
v_mfma_f32_16x16x32_bf16 v[160:163], a[0:3], v[32:35], v[160:163]
ds_read_b64_tr_b16 v[48:49], v20 offset:4096
ds_read_b64_tr_b16 v[50:51], v20 offset:6144
ds_read_b64_tr_b16 v[52:53], v21 offset:4096
v_mfma_f32_16x16x32_bf16 v[164:167], a[0:3], v[36:39], v[164:167]
ds_read_b64_tr_b16 v[54:55], v21 offset:6144
ds_read_b64_tr_b16 v[56:57], v22 offset:4096
ds_read_b64_tr_b16 v[58:59], v22 offset:6144
v_mfma_f32_16x16x32_bf16 v[168:171], a[0:3], v[40:43], v[168:171]
ds_read_b64_tr_b16 v[60:61], v23 offset:4096
ds_read_b64_tr_b16 v[62:63], v23 offset:6144
ds_read_b128 v[72:75], v24 offset:1024
v_mfma_f32_16x16x32_bf16 v[172:175], a[0:3], v[44:47], v[172:175]
s_mul_i32 s44, s47, 89088
s_add_u32 s44, s44, 7340032
buffer_load_dwordx4 a[72:75], v126, s[8:11], s44 offen
buffer_load_dwordx4 a[76:79], v127, s[8:11], s44 offen
buffer_load_dwordx4 a[80:83], v128, s[8:11], s44 offen
s_add_u32 s47, s47, 1
s_and_b32 s47, s47, 15
v_mfma_f32_16x16x32_bf16 v[176:179], a[4:7], v[32:35], v[176:179]
v_lshlrev_b32 v80, 16, v32
v_and_b32 v81, 0xffff0000, v32
v_lshlrev_b32 v82, 16, v33
v_mfma_f32_16x16x32_bf16 v[180:183], a[4:7], v[36:39], v[180:183]
v_and_b32 v83, 0xffff0000, v33
v_lshlrev_b32 v84, 16, v34
v_and_b32 v85, 0xffff0000, v34
v_mfma_f32_16x16x32_bf16 v[184:187], a[4:7], v[40:43], v[184:187]
v_lshlrev_b32 v86, 16, v35
v_and_b32 v87, 0xffff0000, v35
v_mul_f32 v80, v80, v80
v_mfma_f32_16x16x32_bf16 v[188:191], a[4:7], v[44:47], v[188:191]
v_mul_f32 v81, v81, v81
v_mul_f32 v82, v82, v82
v_mul_f32 v83, v83, v83
v_mfma_f32_16x16x32_bf16 v[192:195], a[8:11], v[32:35], v[192:195]
v_mul_f32 v84, v84, v84
v_mul_f32 v85, v85, v85
v_mul_f32 v86, v86, v86
v_mfma_f32_16x16x32_bf16 v[196:199], a[8:11], v[36:39], v[196:199]
v_mul_f32 v87, v87, v87
v_cvt_pk_bf16_f32 v88, v80, v81
v_cvt_pk_bf16_f32 v89, v82, v83
v_mfma_f32_16x16x32_bf16 v[200:203], a[8:11], v[40:43], v[200:203]
v_cvt_pk_bf16_f32 v90, v84, v85
v_cvt_pk_bf16_f32 v91, v86, v87
v_mfma_f32_16x16x32_bf16 v[204:207], a[8:11], v[44:47], v[204:207]
s_waitcnt vmcnt(15) lgkmcnt(0)
v_mfma_f32_16x16x32_bf16 v[96:99], v[64:67], v[88:91], v[96:99]
v_mfma_f32_16x16x32_bf16 v[160:163], a[12:15], v[48:51], v[160:163]
ds_read_b64_tr_b16 v[32:33], v20 offset:8192
ds_read_b64_tr_b16 v[34:35], v20 offset:10240
ds_read_b64_tr_b16 v[36:37], v21 offset:8192
v_mfma_f32_16x16x32_bf16 v[164:167], a[12:15], v[52:55], v[164:167]
ds_read_b64_tr_b16 v[38:39], v21 offset:10240
ds_read_b64_tr_b16 v[40:41], v22 offset:8192
ds_read_b64_tr_b16 v[42:43], v22 offset:10240
v_mfma_f32_16x16x32_bf16 v[168:171], a[12:15], v[56:59], v[168:171]
ds_read_b64_tr_b16 v[44:45], v23 offset:8192
ds_read_b64_tr_b16 v[46:47], v23 offset:10240
ds_read_b128 v[64:67], v24 offset:2048
v_mfma_f32_16x16x32_bf16 v[172:175], a[12:15], v[60:63], v[172:175]
s_mul_i32 s44, s47, 89088
s_add_u32 s44, s44, 7340032
buffer_load_dwordx4 a[84:87], v126, s[8:11], s44 offen
buffer_load_dwordx4 a[88:91], v127, s[8:11], s44 offen
buffer_load_dwordx4 a[92:95], v128, s[8:11], s44 offen
s_add_u32 s47, s47, 1
s_and_b32 s47, s47, 15
v_mfma_f32_16x16x32_bf16 v[176:179], a[16:19], v[48:51], v[176:179]
v_lshlrev_b32 v80, 16, v48
v_and_b32 v81, 0xffff0000, v48
v_lshlrev_b32 v82, 16, v49
v_mfma_f32_16x16x32_bf16 v[180:183], a[16:19], v[52:55], v[180:183]
v_and_b32 v83, 0xffff0000, v49
v_lshlrev_b32 v84, 16, v50
v_and_b32 v85, 0xffff0000, v50
v_mfma_f32_16x16x32_bf16 v[184:187], a[16:19], v[56:59], v[184:187]
v_lshlrev_b32 v86, 16, v51
v_and_b32 v87, 0xffff0000, v51
v_mul_f32 v80, v80, v80
v_mfma_f32_16x16x32_bf16 v[188:191], a[16:19], v[60:63], v[188:191]
v_mul_f32 v81, v81, v81
v_mul_f32 v82, v82, v82
v_mul_f32 v83, v83, v83
v_mfma_f32_16x16x32_bf16 v[192:195], a[20:23], v[48:51], v[192:195]
v_mul_f32 v84, v84, v84
v_mul_f32 v85, v85, v85
v_mul_f32 v86, v86, v86
v_mfma_f32_16x16x32_bf16 v[196:199], a[20:23], v[52:55], v[196:199]
v_mul_f32 v87, v87, v87
v_cvt_pk_bf16_f32 v88, v80, v81
v_cvt_pk_bf16_f32 v89, v82, v83
v_mfma_f32_16x16x32_bf16 v[200:203], a[20:23], v[56:59], v[200:203]
v_cvt_pk_bf16_f32 v90, v84, v85
v_cvt_pk_bf16_f32 v91, v86, v87
v_mfma_f32_16x16x32_bf16 v[204:207], a[20:23], v[60:63], v[204:207]
s_waitcnt vmcnt(15) lgkmcnt(0)
v_mfma_f32_16x16x32_bf16 v[96:99], v[72:75], v[88:91], v[96:99]
v_mfma_f32_16x16x32_bf16 v[160:163], a[24:27], v[32:35], v[160:163]
ds_read_b64_tr_b16 v[48:49], v20 offset:12288
ds_read_b64_tr_b16 v[50:51], v20 offset:14336
ds_read_b64_tr_b16 v[52:53], v21 offset:12288
v_mfma_f32_16x16x32_bf16 v[164:167], a[24:27], v[36:39], v[164:167]
ds_read_b64_tr_b16 v[54:55], v21 offset:14336
ds_read_b64_tr_b16 v[56:57], v22 offset:12288
ds_read_b64_tr_b16 v[58:59], v22 offset:14336
v_mfma_f32_16x16x32_bf16 v[168:171], a[24:27], v[40:43], v[168:171]
ds_read_b64_tr_b16 v[60:61], v23 offset:12288
ds_read_b64_tr_b16 v[62:63], v23 offset:14336
ds_read_b128 v[72:75], v24 offset:3072
v_mfma_f32_16x16x32_bf16 v[172:175], a[24:27], v[44:47], v[172:175]
s_mul_i32 s44, s47, 89088
s_add_u32 s44, s44, 7340032
buffer_load_dwordx4 a[96:99], v126, s[8:11], s44 offen
buffer_load_dwordx4 a[100:103], v127, s[8:11], s44 offen
buffer_load_dwordx4 a[104:107], v128, s[8:11], s44 offen
s_add_u32 s47, s47, 1
s_and_b32 s47, s47, 15
v_mfma_f32_16x16x32_bf16 v[176:179], a[28:31], v[32:35], v[176:179]
v_lshlrev_b32 v80, 16, v32
v_and_b32 v81, 0xffff0000, v32
v_lshlrev_b32 v82, 16, v33
v_mfma_f32_16x16x32_bf16 v[180:183], a[28:31], v[36:39], v[180:183]
v_and_b32 v83, 0xffff0000, v33
v_lshlrev_b32 v84, 16, v34
v_and_b32 v85, 0xffff0000, v34
v_mfma_f32_16x16x32_bf16 v[184:187], a[28:31], v[40:43], v[184:187]
v_lshlrev_b32 v86, 16, v35
v_and_b32 v87, 0xffff0000, v35
v_mul_f32 v80, v80, v80
v_mfma_f32_16x16x32_bf16 v[188:191], a[28:31], v[44:47], v[188:191]
v_mul_f32 v81, v81, v81
v_mul_f32 v82, v82, v82
v_mul_f32 v83, v83, v83
v_mfma_f32_16x16x32_bf16 v[192:195], a[32:35], v[32:35], v[192:195]
v_mul_f32 v84, v84, v84
v_mul_f32 v85, v85, v85
v_mul_f32 v86, v86, v86
v_mfma_f32_16x16x32_bf16 v[196:199], a[32:35], v[36:39], v[196:199]
v_mul_f32 v87, v87, v87
v_cvt_pk_bf16_f32 v88, v80, v81
v_cvt_pk_bf16_f32 v89, v82, v83
v_mfma_f32_16x16x32_bf16 v[200:203], a[32:35], v[40:43], v[200:203]
v_cvt_pk_bf16_f32 v90, v84, v85
v_cvt_pk_bf16_f32 v91, v86, v87
v_mfma_f32_16x16x32_bf16 v[204:207], a[32:35], v[44:47], v[204:207]
s_waitcnt vmcnt(15) lgkmcnt(0)
v_mfma_f32_16x16x32_bf16 v[96:99], v[64:67], v[88:91], v[96:99]
v_mfma_f32_16x16x32_bf16 v[160:163], a[36:39], v[48:51], v[160:163]
ds_read_b64_tr_b16 v[32:33], v20 offset:16384
ds_read_b64_tr_b16 v[34:35], v20 offset:18432
ds_read_b64_tr_b16 v[36:37], v21 offset:16384
v_mfma_f32_16x16x32_bf16 v[164:167], a[36:39], v[52:55], v[164:167]
ds_read_b64_tr_b16 v[38:39], v21 offset:18432
ds_read_b64_tr_b16 v[40:41], v22 offset:16384
ds_read_b64_tr_b16 v[42:43], v22 offset:18432
v_mfma_f32_16x16x32_bf16 v[168:171], a[36:39], v[56:59], v[168:171]
ds_read_b64_tr_b16 v[44:45], v23 offset:16384
ds_read_b64_tr_b16 v[46:47], v23 offset:18432
ds_read_b128 v[64:67], v24 offset:4096
v_mfma_f32_16x16x32_bf16 v[172:175], a[36:39], v[60:63], v[172:175]
s_mul_i32 s44, s47, 89088
s_add_u32 s44, s44, 7340032
buffer_load_dwordx4 a[108:111], v126, s[8:11], s44 offen
buffer_load_dwordx4 a[112:115], v127, s[8:11], s44 offen
buffer_load_dwordx4 a[116:119], v128, s[8:11], s44 offen
s_add_u32 s47, s47, 1
s_and_b32 s47, s47, 15
v_mfma_f32_16x16x32_bf16 v[176:179], a[40:43], v[48:51], v[176:179]
v_lshlrev_b32 v80, 16, v48
v_and_b32 v81, 0xffff0000, v48
v_lshlrev_b32 v82, 16, v49
v_mfma_f32_16x16x32_bf16 v[180:183], a[40:43], v[52:55], v[180:183]
v_and_b32 v83, 0xffff0000, v49
v_lshlrev_b32 v84, 16, v50
v_and_b32 v85, 0xffff0000, v50
v_mfma_f32_16x16x32_bf16 v[184:187], a[40:43], v[56:59], v[184:187]
v_lshlrev_b32 v86, 16, v51
v_and_b32 v87, 0xffff0000, v51
v_mul_f32 v80, v80, v80
v_mfma_f32_16x16x32_bf16 v[188:191], a[40:43], v[60:63], v[188:191]
v_mul_f32 v81, v81, v81
v_mul_f32 v82, v82, v82
v_mul_f32 v83, v83, v83
v_mfma_f32_16x16x32_bf16 v[192:195], a[44:47], v[48:51], v[192:195]
v_mul_f32 v84, v84, v84
v_mul_f32 v85, v85, v85
v_mul_f32 v86, v86, v86
v_mfma_f32_16x16x32_bf16 v[196:199], a[44:47], v[52:55], v[196:199]
v_mul_f32 v87, v87, v87
v_cvt_pk_bf16_f32 v88, v80, v81
v_cvt_pk_bf16_f32 v89, v82, v83
v_mfma_f32_16x16x32_bf16 v[200:203], a[44:47], v[56:59], v[200:203]
v_cvt_pk_bf16_f32 v90, v84, v85
v_cvt_pk_bf16_f32 v91, v86, v87
v_mfma_f32_16x16x32_bf16 v[204:207], a[44:47], v[60:63], v[204:207]
s_waitcnt vmcnt(15) lgkmcnt(0)
v_mfma_f32_16x16x32_bf16 v[96:99], v[72:75], v[88:91], v[96:99]
v_mfma_f32_16x16x32_bf16 v[160:163], a[48:51], v[32:35], v[160:163]
ds_read_b64_tr_b16 v[48:49], v20 offset:20480
ds_read_b64_tr_b16 v[50:51], v20 offset:22528
ds_read_b64_tr_b16 v[52:53], v21 offset:20480
v_mfma_f32_16x16x32_bf16 v[164:167], a[48:51], v[36:39], v[164:167]
ds_read_b64_tr_b16 v[54:55], v21 offset:22528
ds_read_b64_tr_b16 v[56:57], v22 offset:20480
ds_read_b64_tr_b16 v[58:59], v22 offset:22528
v_mfma_f32_16x16x32_bf16 v[168:171], a[48:51], v[40:43], v[168:171]
ds_read_b64_tr_b16 v[60:61], v23 offset:20480
ds_read_b64_tr_b16 v[62:63], v23 offset:22528
ds_read_b128 v[72:75], v24 offset:5120
v_mfma_f32_16x16x32_bf16 v[172:175], a[48:51], v[44:47], v[172:175]
s_mul_i32 s44, s47, 89088
s_add_u32 s44, s44, 7340032
buffer_load_dwordx4 a[120:123], v126, s[8:11], s44 offen
buffer_load_dwordx4 a[124:127], v127, s[8:11], s44 offen
buffer_load_dwordx4 a[128:131], v128, s[8:11], s44 offen
s_add_u32 s47, s47, 1
s_and_b32 s47, s47, 15
v_mfma_f32_16x16x32_bf16 v[176:179], a[52:55], v[32:35], v[176:179]
v_lshlrev_b32 v80, 16, v32
v_and_b32 v81, 0xffff0000, v32
v_lshlrev_b32 v82, 16, v33
v_mfma_f32_16x16x32_bf16 v[180:183], a[52:55], v[36:39], v[180:183]
v_and_b32 v83, 0xffff0000, v33
v_lshlrev_b32 v84, 16, v34
v_and_b32 v85, 0xffff0000, v34
v_mfma_f32_16x16x32_bf16 v[184:187], a[52:55], v[40:43], v[184:187]
v_lshlrev_b32 v86, 16, v35
v_and_b32 v87, 0xffff0000, v35
v_mul_f32 v80, v80, v80
v_mfma_f32_16x16x32_bf16 v[188:191], a[52:55], v[44:47], v[188:191]
v_mul_f32 v81, v81, v81
v_mul_f32 v82, v82, v82
v_mul_f32 v83, v83, v83
v_mfma_f32_16x16x32_bf16 v[192:195], a[56:59], v[32:35], v[192:195]
v_mul_f32 v84, v84, v84
v_mul_f32 v85, v85, v85
v_mul_f32 v86, v86, v86
v_mfma_f32_16x16x32_bf16 v[196:199], a[56:59], v[36:39], v[196:199]
v_mul_f32 v87, v87, v87
v_cvt_pk_bf16_f32 v88, v80, v81
v_cvt_pk_bf16_f32 v89, v82, v83
v_mfma_f32_16x16x32_bf16 v[200:203], a[56:59], v[40:43], v[200:203]
v_cvt_pk_bf16_f32 v90, v84, v85
v_cvt_pk_bf16_f32 v91, v86, v87
v_mfma_f32_16x16x32_bf16 v[204:207], a[56:59], v[44:47], v[204:207]
s_waitcnt vmcnt(15) lgkmcnt(0)
v_mfma_f32_16x16x32_bf16 v[96:99], v[64:67], v[88:91], v[96:99]
v_mfma_f32_16x16x32_bf16 v[160:163], a[60:63], v[48:51], v[160:163]
ds_read_b64_tr_b16 v[32:33], v20 offset:24576
ds_read_b64_tr_b16 v[34:35], v20 offset:26624
ds_read_b64_tr_b16 v[36:37], v21 offset:24576
v_mfma_f32_16x16x32_bf16 v[164:167], a[60:63], v[52:55], v[164:167]
ds_read_b64_tr_b16 v[38:39], v21 offset:26624
ds_read_b64_tr_b16 v[40:41], v22 offset:24576
ds_read_b64_tr_b16 v[42:43], v22 offset:26624
v_mfma_f32_16x16x32_bf16 v[168:171], a[60:63], v[56:59], v[168:171]
ds_read_b64_tr_b16 v[44:45], v23 offset:24576
ds_read_b64_tr_b16 v[46:47], v23 offset:26624
ds_read_b128 v[64:67], v24 offset:6144
v_mfma_f32_16x16x32_bf16 v[172:175], a[60:63], v[60:63], v[172:175]
s_mul_i32 s44, s47, 89088
s_add_u32 s44, s44, 7340032
buffer_load_dwordx4 a[132:135], v126, s[8:11], s44 offen
buffer_load_dwordx4 a[136:139], v127, s[8:11], s44 offen
buffer_load_dwordx4 a[140:143], v128, s[8:11], s44 offen
s_add_u32 s47, s47, 1
s_and_b32 s47, s47, 15
v_mfma_f32_16x16x32_bf16 v[176:179], a[64:67], v[48:51], v[176:179]
v_lshlrev_b32 v80, 16, v48
v_and_b32 v81, 0xffff0000, v48
v_lshlrev_b32 v82, 16, v49
v_mfma_f32_16x16x32_bf16 v[180:183], a[64:67], v[52:55], v[180:183]
v_and_b32 v83, 0xffff0000, v49
v_lshlrev_b32 v84, 16, v50
v_and_b32 v85, 0xffff0000, v50
v_mfma_f32_16x16x32_bf16 v[184:187], a[64:67], v[56:59], v[184:187]
v_lshlrev_b32 v86, 16, v51
v_and_b32 v87, 0xffff0000, v51
v_mul_f32 v80, v80, v80
v_mfma_f32_16x16x32_bf16 v[188:191], a[64:67], v[60:63], v[188:191]
v_mul_f32 v81, v81, v81
v_mul_f32 v82, v82, v82
v_mul_f32 v83, v83, v83
v_mfma_f32_16x16x32_bf16 v[192:195], a[68:71], v[48:51], v[192:195]
v_mul_f32 v84, v84, v84
v_mul_f32 v85, v85, v85
v_mul_f32 v86, v86, v86
v_mfma_f32_16x16x32_bf16 v[196:199], a[68:71], v[52:55], v[196:199]
v_mul_f32 v87, v87, v87
v_cvt_pk_bf16_f32 v88, v80, v81
v_cvt_pk_bf16_f32 v89, v82, v83
v_mfma_f32_16x16x32_bf16 v[200:203], a[68:71], v[56:59], v[200:203]
v_cvt_pk_bf16_f32 v90, v84, v85
v_cvt_pk_bf16_f32 v91, v86, v87
v_mfma_f32_16x16x32_bf16 v[204:207], a[68:71], v[60:63], v[204:207]
s_waitcnt vmcnt(15) lgkmcnt(0)
v_mfma_f32_16x16x32_bf16 v[96:99], v[72:75], v[88:91], v[96:99]
v_mfma_f32_16x16x32_bf16 v[160:163], a[72:75], v[32:35], v[160:163]
ds_read_b64_tr_b16 v[48:49], v20 offset:28672
ds_read_b64_tr_b16 v[50:51], v20 offset:30720
ds_read_b64_tr_b16 v[52:53], v21 offset:28672
v_mfma_f32_16x16x32_bf16 v[164:167], a[72:75], v[36:39], v[164:167]
ds_read_b64_tr_b16 v[54:55], v21 offset:30720
ds_read_b64_tr_b16 v[56:57], v22 offset:28672
ds_read_b64_tr_b16 v[58:59], v22 offset:30720
v_mfma_f32_16x16x32_bf16 v[168:171], a[72:75], v[40:43], v[168:171]
ds_read_b64_tr_b16 v[60:61], v23 offset:28672
ds_read_b64_tr_b16 v[62:63], v23 offset:30720
ds_read_b128 v[72:75], v24 offset:7168
v_mfma_f32_16x16x32_bf16 v[172:175], a[72:75], v[44:47], v[172:175]
s_mul_i32 s44, s47, 89088
s_add_u32 s44, s44, 7340032
buffer_load_dwordx4 a[144:147], v126, s[8:11], s44 offen
buffer_load_dwordx4 a[148:151], v127, s[8:11], s44 offen
buffer_load_dwordx4 a[152:155], v128, s[8:11], s44 offen
s_add_u32 s47, s47, 1
s_and_b32 s47, s47, 15
v_mfma_f32_16x16x32_bf16 v[176:179], a[76:79], v[32:35], v[176:179]
v_lshlrev_b32 v80, 16, v32
v_and_b32 v81, 0xffff0000, v32
v_lshlrev_b32 v82, 16, v33
v_mfma_f32_16x16x32_bf16 v[180:183], a[76:79], v[36:39], v[180:183]
v_and_b32 v83, 0xffff0000, v33
v_lshlrev_b32 v84, 16, v34
v_and_b32 v85, 0xffff0000, v34
v_mfma_f32_16x16x32_bf16 v[184:187], a[76:79], v[40:43], v[184:187]
v_lshlrev_b32 v86, 16, v35
v_and_b32 v87, 0xffff0000, v35
v_mul_f32 v80, v80, v80
v_mfma_f32_16x16x32_bf16 v[188:191], a[76:79], v[44:47], v[188:191]
v_mul_f32 v81, v81, v81
v_mul_f32 v82, v82, v82
v_mul_f32 v83, v83, v83
v_mfma_f32_16x16x32_bf16 v[192:195], a[80:83], v[32:35], v[192:195]
v_mul_f32 v84, v84, v84
v_mul_f32 v85, v85, v85
v_mul_f32 v86, v86, v86
v_mfma_f32_16x16x32_bf16 v[196:199], a[80:83], v[36:39], v[196:199]
v_mul_f32 v87, v87, v87
v_cvt_pk_bf16_f32 v88, v80, v81
v_cvt_pk_bf16_f32 v89, v82, v83
v_mfma_f32_16x16x32_bf16 v[200:203], a[80:83], v[40:43], v[200:203]
v_cvt_pk_bf16_f32 v90, v84, v85
v_cvt_pk_bf16_f32 v91, v86, v87
v_mfma_f32_16x16x32_bf16 v[204:207], a[80:83], v[44:47], v[204:207]
s_waitcnt vmcnt(15) lgkmcnt(0)
v_mfma_f32_16x16x32_bf16 v[96:99], v[64:67], v[88:91], v[96:99]
v_mfma_f32_16x16x32_bf16 v[160:163], a[84:87], v[48:51], v[160:163]
ds_read_b64_tr_b16 v[32:33], v20 offset:32768
ds_read_b64_tr_b16 v[34:35], v20 offset:34816
ds_read_b64_tr_b16 v[36:37], v21 offset:32768
v_mfma_f32_16x16x32_bf16 v[164:167], a[84:87], v[52:55], v[164:167]
ds_read_b64_tr_b16 v[38:39], v21 offset:34816
ds_read_b64_tr_b16 v[40:41], v22 offset:32768
ds_read_b64_tr_b16 v[42:43], v22 offset:34816
v_mfma_f32_16x16x32_bf16 v[168:171], a[84:87], v[56:59], v[168:171]
ds_read_b64_tr_b16 v[44:45], v23 offset:32768
ds_read_b64_tr_b16 v[46:47], v23 offset:34816
ds_read_b128 v[64:67], v24 offset:8192
v_mfma_f32_16x16x32_bf16 v[172:175], a[84:87], v[60:63], v[172:175]
s_mul_i32 s44, s47, 89088
s_add_u32 s44, s44, 7340032
buffer_load_dwordx4 a[156:159], v126, s[8:11], s44 offen
buffer_load_dwordx4 a[160:163], v127, s[8:11], s44 offen
buffer_load_dwordx4 a[164:167], v128, s[8:11], s44 offen
s_add_u32 s47, s47, 1
s_and_b32 s47, s47, 15
v_mfma_f32_16x16x32_bf16 v[176:179], a[88:91], v[48:51], v[176:179]
v_lshlrev_b32 v80, 16, v48
v_and_b32 v81, 0xffff0000, v48
v_lshlrev_b32 v82, 16, v49
v_mfma_f32_16x16x32_bf16 v[180:183], a[88:91], v[52:55], v[180:183]
v_and_b32 v83, 0xffff0000, v49
v_lshlrev_b32 v84, 16, v50
v_and_b32 v85, 0xffff0000, v50
v_mfma_f32_16x16x32_bf16 v[184:187], a[88:91], v[56:59], v[184:187]
v_lshlrev_b32 v86, 16, v51
v_and_b32 v87, 0xffff0000, v51
v_mul_f32 v80, v80, v80
v_mfma_f32_16x16x32_bf16 v[188:191], a[88:91], v[60:63], v[188:191]
v_mul_f32 v81, v81, v81
v_mul_f32 v82, v82, v82
v_mul_f32 v83, v83, v83
v_mfma_f32_16x16x32_bf16 v[192:195], a[92:95], v[48:51], v[192:195]
v_mul_f32 v84, v84, v84
v_mul_f32 v85, v85, v85
v_mul_f32 v86, v86, v86
v_mfma_f32_16x16x32_bf16 v[196:199], a[92:95], v[52:55], v[196:199]
v_mul_f32 v87, v87, v87
v_cvt_pk_bf16_f32 v88, v80, v81
v_cvt_pk_bf16_f32 v89, v82, v83
v_mfma_f32_16x16x32_bf16 v[200:203], a[92:95], v[56:59], v[200:203]
v_cvt_pk_bf16_f32 v90, v84, v85
v_cvt_pk_bf16_f32 v91, v86, v87
v_mfma_f32_16x16x32_bf16 v[204:207], a[92:95], v[60:63], v[204:207]
s_waitcnt vmcnt(15) lgkmcnt(0)
v_mfma_f32_16x16x32_bf16 v[96:99], v[72:75], v[88:91], v[96:99]
v_mfma_f32_16x16x32_bf16 v[160:163], a[96:99], v[32:35], v[160:163]
ds_read_b64_tr_b16 v[48:49], v20 offset:36864
ds_read_b64_tr_b16 v[50:51], v20 offset:38912
ds_read_b64_tr_b16 v[52:53], v21 offset:36864
v_mfma_f32_16x16x32_bf16 v[164:167], a[96:99], v[36:39], v[164:167]
ds_read_b64_tr_b16 v[54:55], v21 offset:38912
ds_read_b64_tr_b16 v[56:57], v22 offset:36864
ds_read_b64_tr_b16 v[58:59], v22 offset:38912
v_mfma_f32_16x16x32_bf16 v[168:171], a[96:99], v[40:43], v[168:171]
ds_read_b64_tr_b16 v[60:61], v23 offset:36864
ds_read_b64_tr_b16 v[62:63], v23 offset:38912
ds_read_b128 v[72:75], v24 offset:9216
v_mfma_f32_16x16x32_bf16 v[172:175], a[96:99], v[44:47], v[172:175]
s_mul_i32 s44, s47, 89088
s_add_u32 s44, s44, 7340032
buffer_load_dwordx4 a[168:171], v126, s[8:11], s44 offen
buffer_load_dwordx4 a[172:175], v127, s[8:11], s44 offen
buffer_load_dwordx4 a[176:179], v128, s[8:11], s44 offen
s_add_u32 s47, s47, 1
s_and_b32 s47, s47, 15
v_mfma_f32_16x16x32_bf16 v[176:179], a[100:103], v[32:35], v[176:179]
v_lshlrev_b32 v80, 16, v32
v_and_b32 v81, 0xffff0000, v32
v_lshlrev_b32 v82, 16, v33
v_mfma_f32_16x16x32_bf16 v[180:183], a[100:103], v[36:39], v[180:183]
v_and_b32 v83, 0xffff0000, v33
v_lshlrev_b32 v84, 16, v34
v_and_b32 v85, 0xffff0000, v34
v_mfma_f32_16x16x32_bf16 v[184:187], a[100:103], v[40:43], v[184:187]
v_lshlrev_b32 v86, 16, v35
v_and_b32 v87, 0xffff0000, v35
v_mul_f32 v80, v80, v80
v_mfma_f32_16x16x32_bf16 v[188:191], a[100:103], v[44:47], v[188:191]
v_mul_f32 v81, v81, v81
v_mul_f32 v82, v82, v82
v_mul_f32 v83, v83, v83
v_mfma_f32_16x16x32_bf16 v[192:195], a[104:107], v[32:35], v[192:195]
v_mul_f32 v84, v84, v84
v_mul_f32 v85, v85, v85
v_mul_f32 v86, v86, v86
v_mfma_f32_16x16x32_bf16 v[196:199], a[104:107], v[36:39], v[196:199]
v_mul_f32 v87, v87, v87
v_cvt_pk_bf16_f32 v88, v80, v81
v_cvt_pk_bf16_f32 v89, v82, v83
v_mfma_f32_16x16x32_bf16 v[200:203], a[104:107], v[40:43], v[200:203]
v_cvt_pk_bf16_f32 v90, v84, v85
v_cvt_pk_bf16_f32 v91, v86, v87
v_mfma_f32_16x16x32_bf16 v[204:207], a[104:107], v[44:47], v[204:207]
s_waitcnt vmcnt(15) lgkmcnt(0)
v_mfma_f32_16x16x32_bf16 v[96:99], v[64:67], v[88:91], v[96:99]
v_mfma_f32_16x16x32_bf16 v[160:163], a[108:111], v[48:51], v[160:163]
ds_read_b64_tr_b16 v[32:33], v20 offset:40960
ds_read_b64_tr_b16 v[34:35], v20 offset:43008
ds_read_b64_tr_b16 v[36:37], v21 offset:40960
v_mfma_f32_16x16x32_bf16 v[164:167], a[108:111], v[52:55], v[164:167]
ds_read_b64_tr_b16 v[38:39], v21 offset:43008
ds_read_b64_tr_b16 v[40:41], v22 offset:40960
ds_read_b64_tr_b16 v[42:43], v22 offset:43008
v_mfma_f32_16x16x32_bf16 v[168:171], a[108:111], v[56:59], v[168:171]
ds_read_b64_tr_b16 v[44:45], v23 offset:40960
ds_read_b64_tr_b16 v[46:47], v23 offset:43008
ds_read_b128 v[64:67], v24 offset:10240
v_mfma_f32_16x16x32_bf16 v[172:175], a[108:111], v[60:63], v[172:175]
s_mul_i32 s44, s47, 89088
s_add_u32 s44, s44, 7340032
buffer_load_dwordx4 a[180:183], v126, s[8:11], s44 offen
buffer_load_dwordx4 a[184:187], v127, s[8:11], s44 offen
buffer_load_dwordx4 a[188:191], v128, s[8:11], s44 offen
s_add_u32 s47, s47, 1
s_and_b32 s47, s47, 15
v_mfma_f32_16x16x32_bf16 v[176:179], a[112:115], v[48:51], v[176:179]
v_lshlrev_b32 v80, 16, v48
v_and_b32 v81, 0xffff0000, v48
v_lshlrev_b32 v82, 16, v49
v_mfma_f32_16x16x32_bf16 v[180:183], a[112:115], v[52:55], v[180:183]
v_and_b32 v83, 0xffff0000, v49
v_lshlrev_b32 v84, 16, v50
v_and_b32 v85, 0xffff0000, v50
v_mfma_f32_16x16x32_bf16 v[184:187], a[112:115], v[56:59], v[184:187]
v_lshlrev_b32 v86, 16, v51
v_and_b32 v87, 0xffff0000, v51
v_mul_f32 v80, v80, v80
v_mfma_f32_16x16x32_bf16 v[188:191], a[112:115], v[60:63], v[188:191]
v_mul_f32 v81, v81, v81
v_mul_f32 v82, v82, v82
v_mul_f32 v83, v83, v83
v_mfma_f32_16x16x32_bf16 v[192:195], a[116:119], v[48:51], v[192:195]
v_mul_f32 v84, v84, v84
v_mul_f32 v85, v85, v85
v_mul_f32 v86, v86, v86
v_mfma_f32_16x16x32_bf16 v[196:199], a[116:119], v[52:55], v[196:199]
v_mul_f32 v87, v87, v87
v_cvt_pk_bf16_f32 v88, v80, v81
v_cvt_pk_bf16_f32 v89, v82, v83
v_mfma_f32_16x16x32_bf16 v[200:203], a[116:119], v[56:59], v[200:203]
v_cvt_pk_bf16_f32 v90, v84, v85
v_cvt_pk_bf16_f32 v91, v86, v87
v_mfma_f32_16x16x32_bf16 v[204:207], a[116:119], v[60:63], v[204:207]
s_waitcnt vmcnt(15) lgkmcnt(0)
v_mfma_f32_16x16x32_bf16 v[96:99], v[72:75], v[88:91], v[96:99]
v_mfma_f32_16x16x32_bf16 v[160:163], a[120:123], v[32:35], v[160:163]
ds_read_b64_tr_b16 v[48:49], v20 offset:45056
ds_read_b64_tr_b16 v[50:51], v20 offset:47104
ds_read_b64_tr_b16 v[52:53], v21 offset:45056
ds_read_b64_tr_b16 v[54:55], v21 offset:47104
ds_read_b64_tr_b16 v[56:57], v22 offset:45056
ds_read_b64_tr_b16 v[58:59], v22 offset:47104
v_mfma_f32_16x16x32_bf16 v[164:167], a[120:123], v[36:39], v[164:167]
ds_read_b64_tr_b16 v[60:61], v23 offset:45056
ds_read_b64_tr_b16 v[62:63], v23 offset:47104
ds_read_b128 v[72:75], v24 offset:11264
global_load_dword v112, v8, s[14:15]
v_add_u32 v8, 5504, v8
global_load_dword v113, v8, s[14:15]
v_mfma_f32_16x16x32_bf16 v[168:171], a[120:123], v[40:43], v[168:171]
v_add_u32 v8, 5504, v8
global_load_dword v114, v8, s[14:15]
v_add_u32 v8, 5504, v8
global_load_dword v115, v8, s[14:15]
v_add_u32 v8, 5504, v8
global_load_dword v116, v8, s[14:15]
v_mfma_f32_16x16x32_bf16 v[172:175], a[120:123], v[44:47], v[172:175]
v_add_u32 v8, 5504, v8
global_load_dword v117, v8, s[14:15]
v_add_u32 v8, 5504, v8
global_load_dword v118, v8, s[14:15]
v_add_u32 v8, 5504, v8
global_load_dword v119, v8, s[14:15]
v_mfma_f32_16x16x32_bf16 v[176:179], a[124:127], v[32:35], v[176:179]
v_add_u32 v8, 5504, v8
global_load_dword v120, v8, s[14:15]
v_add_u32 v8, 5504, v8
global_load_dword v121, v8, s[14:15]
v_add_u32 v8, 5504, v8
global_load_dword v122, v8, s[14:15]
v_mfma_f32_16x16x32_bf16 v[180:183], a[124:127], v[36:39], v[180:183]
v_add_u32 v8, 5504, v8
global_load_dword v123, v8, s[14:15]
global_load_ushort v124, v9, s[12:13]
global_load_dwordx4 v[208:211], v27, s[14:15] offset:0
global_load_dwordx4 v[212:215], v27, s[14:15] offset:64
global_load_dwordx4 v[216:219], v27, s[14:15] offset:128
v_mfma_f32_16x16x32_bf16 v[184:187], a[124:127], v[40:43], v[184:187]
global_load_dwordx4 v[220:223], v27, s[14:15] offset:192
global_load_dwordx2 v[224:225], v28, s[16:17] offset:0
global_load_dwordx2 v[226:227], v28, s[16:17] offset:32
global_load_dwordx2 v[228:229], v28, s[16:17] offset:64
global_load_dwordx2 v[230:231], v28, s[16:17] offset:96
v_lshlrev_b32 v80, 16, v32
v_mfma_f32_16x16x32_bf16 v[188:191], a[124:127], v[44:47], v[188:191]
v_and_b32 v81, 0xffff0000, v32
v_lshlrev_b32 v82, 16, v33
v_and_b32 v83, 0xffff0000, v33
v_lshlrev_b32 v84, 16, v34
v_and_b32 v85, 0xffff0000, v34
v_lshlrev_b32 v86, 16, v35
v_mfma_f32_16x16x32_bf16 v[192:195], a[128:131], v[32:35], v[192:195]
v_and_b32 v87, 0xffff0000, v35
v_mul_f32 v80, v80, v80
v_mul_f32 v81, v81, v81
v_mul_f32 v82, v82, v82
v_mul_f32 v83, v83, v83
v_mul_f32 v84, v84, v84
v_mfma_f32_16x16x32_bf16 v[196:199], a[128:131], v[36:39], v[196:199]
v_mul_f32 v85, v85, v85
v_mul_f32 v86, v86, v86
v_mul_f32 v87, v87, v87
v_cvt_pk_bf16_f32 v88, v80, v81
v_cvt_pk_bf16_f32 v89, v82, v83
v_cvt_pk_bf16_f32 v90, v84, v85
v_mfma_f32_16x16x32_bf16 v[200:203], a[128:131], v[40:43], v[200:203]
v_cvt_pk_bf16_f32 v91, v86, v87
v_mfma_f32_16x16x32_bf16 v[204:207], a[128:131], v[44:47], v[204:207]
s_waitcnt vmcnt(33) lgkmcnt(0)
v_mfma_f32_16x16x32_bf16 v[96:99], v[64:67], v[88:91], v[96:99]
v_mfma_f32_16x16x32_bf16 v[160:163], a[132:135], v[48:51], v[160:163]
ds_read_b64_tr_b16 v[32:33], v20 offset:49152
ds_read_b64_tr_b16 v[34:35], v20 offset:51200
ds_read_b64_tr_b16 v[36:37], v21 offset:49152
v_mfma_f32_16x16x32_bf16 v[164:167], a[132:135], v[52:55], v[164:167]
ds_read_b64_tr_b16 v[38:39], v21 offset:51200
ds_read_b64_tr_b16 v[40:41], v22 offset:49152
ds_read_b64_tr_b16 v[42:43], v22 offset:51200
v_mfma_f32_16x16x32_bf16 v[168:171], a[132:135], v[56:59], v[168:171]
ds_read_b64_tr_b16 v[44:45], v23 offset:49152
ds_read_b64_tr_b16 v[46:47], v23 offset:51200
ds_read_b128 v[64:67], v24 offset:12288
v_mfma_f32_16x16x32_bf16 v[172:175], a[132:135], v[60:63], v[172:175]
s_add_u32 s66, s67, s24
s_lshl_b32 s66, s66, 12
s_add_u32 s66, s66, s59
s_mov_b32 s62, s10
buffer_load_dwordx4 a[0:3], v13, s[60:63], s66 offen offset:0
buffer_load_dwordx4 a[4:7], v13, s[60:63], s66 offen offset:1024
buffer_load_dwordx4 a[8:11], v13, s[60:63], s66 offen offset:2048
v_mfma_f32_16x16x32_bf16 v[176:179], a[136:139], v[48:51], v[176:179]
v_lshlrev_b32 v80, 16, v48
v_and_b32 v81, 0xffff0000, v48
v_lshlrev_b32 v82, 16, v49
v_mfma_f32_16x16x32_bf16 v[180:183], a[136:139], v[52:55], v[180:183]
v_and_b32 v83, 0xffff0000, v49
v_lshlrev_b32 v84, 16, v50
v_and_b32 v85, 0xffff0000, v50
v_mfma_f32_16x16x32_bf16 v[184:187], a[136:139], v[56:59], v[184:187]
v_lshlrev_b32 v86, 16, v51
v_and_b32 v87, 0xffff0000, v51
v_mul_f32 v80, v80, v80
v_mfma_f32_16x16x32_bf16 v[188:191], a[136:139], v[60:63], v[188:191]
v_mul_f32 v81, v81, v81
v_mul_f32 v82, v82, v82
v_mul_f32 v83, v83, v83
v_mfma_f32_16x16x32_bf16 v[192:195], a[140:143], v[48:51], v[192:195]
v_mul_f32 v84, v84, v84
v_mul_f32 v85, v85, v85
v_mul_f32 v86, v86, v86
v_mfma_f32_16x16x32_bf16 v[196:199], a[140:143], v[52:55], v[196:199]
v_mul_f32 v87, v87, v87
v_cvt_pk_bf16_f32 v88, v80, v81
v_cvt_pk_bf16_f32 v89, v82, v83
v_mfma_f32_16x16x32_bf16 v[200:203], a[140:143], v[56:59], v[200:203]
v_cvt_pk_bf16_f32 v90, v84, v85
v_cvt_pk_bf16_f32 v91, v86, v87
v_mfma_f32_16x16x32_bf16 v[204:207], a[140:143], v[60:63], v[204:207]
s_waitcnt vmcnt(33) lgkmcnt(0)
v_mfma_f32_16x16x32_bf16 v[96:99], v[72:75], v[88:91], v[96:99]
v_mfma_f32_16x16x32_bf16 v[160:163], a[144:147], v[32:35], v[160:163]
ds_read_b64_tr_b16 v[48:49], v20 offset:53248
ds_read_b64_tr_b16 v[50:51], v20 offset:55296
ds_read_b64_tr_b16 v[52:53], v21 offset:53248
v_mfma_f32_16x16x32_bf16 v[164:167], a[144:147], v[36:39], v[164:167]
ds_read_b64_tr_b16 v[54:55], v21 offset:55296
ds_read_b64_tr_b16 v[56:57], v22 offset:53248
ds_read_b64_tr_b16 v[58:59], v22 offset:55296
v_mfma_f32_16x16x32_bf16 v[168:171], a[144:147], v[40:43], v[168:171]
ds_read_b64_tr_b16 v[60:61], v23 offset:53248
ds_read_b64_tr_b16 v[62:63], v23 offset:55296
ds_read_b128 v[72:75], v24 offset:13312
v_mfma_f32_16x16x32_bf16 v[172:175], a[144:147], v[44:47], v[172:175]
buffer_load_dwordx4 a[12:15], v13, s[60:63], s66 offen offset:3072
s_cmp_ge_u32 s64, s67
s_cselect_b32 s66, 4, 0
s_add_u32 s66, s66, s64
s_min_u32 s66, s66, 42
s_lshl_b32 s66, s66, 12
s_add_u32 s66, s66, s59
s_cmp_eq_u32 s64, 39
s_cselect_b32 s62, 0, s10
buffer_load_dwordx4 a[16:19], v13, s[60:63], s66 offen offset:0
buffer_load_dwordx4 a[20:23], v13, s[60:63], s66 offen offset:1024
v_mfma_f32_16x16x32_bf16 v[176:179], a[148:151], v[32:35], v[176:179]
v_lshlrev_b32 v80, 16, v32
v_and_b32 v81, 0xffff0000, v32
v_lshlrev_b32 v82, 16, v33
v_mfma_f32_16x16x32_bf16 v[180:183], a[148:151], v[36:39], v[180:183]
v_and_b32 v83, 0xffff0000, v33
v_lshlrev_b32 v84, 16, v34
v_and_b32 v85, 0xffff0000, v34
v_mfma_f32_16x16x32_bf16 v[184:187], a[148:151], v[40:43], v[184:187]
v_lshlrev_b32 v86, 16, v35
v_and_b32 v87, 0xffff0000, v35
v_mul_f32 v80, v80, v80
v_mfma_f32_16x16x32_bf16 v[188:191], a[148:151], v[44:47], v[188:191]
v_mul_f32 v81, v81, v81
v_mul_f32 v82, v82, v82
v_mul_f32 v83, v83, v83
v_mfma_f32_16x16x32_bf16 v[192:195], a[152:155], v[32:35], v[192:195]
v_mul_f32 v84, v84, v84
v_mul_f32 v85, v85, v85
v_mul_f32 v86, v86, v86
v_mfma_f32_16x16x32_bf16 v[196:199], a[152:155], v[36:39], v[196:199]
v_mul_f32 v87, v87, v87
v_cvt_pk_bf16_f32 v88, v80, v81
v_cvt_pk_bf16_f32 v89, v82, v83
v_mfma_f32_16x16x32_bf16 v[200:203], a[152:155], v[40:43], v[200:203]
v_cvt_pk_bf16_f32 v90, v84, v85
v_cvt_pk_bf16_f32 v91, v86, v87
v_mfma_f32_16x16x32_bf16 v[204:207], a[152:155], v[44:47], v[204:207]
s_waitcnt vmcnt(33) lgkmcnt(0)
v_mfma_f32_16x16x32_bf16 v[96:99], v[64:67], v[88:91], v[96:99]
v_mfma_f32_16x16x32_bf16 v[160:163], a[156:159], v[48:51], v[160:163]
ds_read_b64_tr_b16 v[32:33], v20 offset:57344
ds_read_b64_tr_b16 v[34:35], v20 offset:59392
ds_read_b64_tr_b16 v[36:37], v21 offset:57344
v_mfma_f32_16x16x32_bf16 v[164:167], a[156:159], v[52:55], v[164:167]
ds_read_b64_tr_b16 v[38:39], v21 offset:59392
ds_read_b64_tr_b16 v[40:41], v22 offset:57344
ds_read_b64_tr_b16 v[42:43], v22 offset:59392
v_mfma_f32_16x16x32_bf16 v[168:171], a[156:159], v[56:59], v[168:171]
ds_read_b64_tr_b16 v[44:45], v23 offset:57344
ds_read_b64_tr_b16 v[46:47], v23 offset:59392
ds_read_b128 v[64:67], v24 offset:14336
v_mfma_f32_16x16x32_bf16 v[172:175], a[156:159], v[60:63], v[172:175]
buffer_load_dwordx4 a[24:27], v13, s[60:63], s66 offen offset:2048
buffer_load_dwordx4 a[28:31], v13, s[60:63], s66 offen offset:3072
s_add_u32 s64, s64, 1
s_cmp_ge_u32 s64, s67
s_cselect_b32 s66, 4, 0
s_add_u32 s66, s66, s64
s_min_u32 s66, s66, 42
s_lshl_b32 s66, s66, 12
s_add_u32 s66, s66, s59
s_cmp_eq_u32 s64, 39
s_cselect_b32 s62, 0, s10
buffer_load_dwordx4 a[32:35], v13, s[60:63], s66 offen offset:0
v_mfma_f32_16x16x32_bf16 v[176:179], a[160:163], v[48:51], v[176:179]
v_lshlrev_b32 v80, 16, v48
v_and_b32 v81, 0xffff0000, v48
v_lshlrev_b32 v82, 16, v49
v_mfma_f32_16x16x32_bf16 v[180:183], a[160:163], v[52:55], v[180:183]
v_and_b32 v83, 0xffff0000, v49
v_lshlrev_b32 v84, 16, v50
v_and_b32 v85, 0xffff0000, v50
v_mfma_f32_16x16x32_bf16 v[184:187], a[160:163], v[56:59], v[184:187]
v_lshlrev_b32 v86, 16, v51
v_and_b32 v87, 0xffff0000, v51
v_mul_f32 v80, v80, v80
v_mfma_f32_16x16x32_bf16 v[188:191], a[160:163], v[60:63], v[188:191]
v_mul_f32 v81, v81, v81
v_mul_f32 v82, v82, v82
v_mul_f32 v83, v83, v83
v_mfma_f32_16x16x32_bf16 v[192:195], a[164:167], v[48:51], v[192:195]
v_mul_f32 v84, v84, v84
v_mul_f32 v85, v85, v85
v_mul_f32 v86, v86, v86
v_mfma_f32_16x16x32_bf16 v[196:199], a[164:167], v[52:55], v[196:199]
v_mul_f32 v87, v87, v87
v_cvt_pk_bf16_f32 v88, v80, v81
v_cvt_pk_bf16_f32 v89, v82, v83
v_mfma_f32_16x16x32_bf16 v[200:203], a[164:167], v[56:59], v[200:203]
v_cvt_pk_bf16_f32 v90, v84, v85
v_cvt_pk_bf16_f32 v91, v86, v87
v_mfma_f32_16x16x32_bf16 v[204:207], a[164:167], v[60:63], v[204:207]
s_waitcnt vmcnt(33) lgkmcnt(0)
v_mfma_f32_16x16x32_bf16 v[96:99], v[72:75], v[88:91], v[96:99]
v_mfma_f32_16x16x32_bf16 v[160:163], a[168:171], v[32:35], v[160:163]
ds_read_b64_tr_b16 v[48:49], v20 offset:61440
ds_read_b64_tr_b16 v[50:51], v20 offset:63488
ds_read_b64_tr_b16 v[52:53], v21 offset:61440
v_mfma_f32_16x16x32_bf16 v[164:167], a[168:171], v[36:39], v[164:167]
ds_read_b64_tr_b16 v[54:55], v21 offset:63488
ds_read_b64_tr_b16 v[56:57], v22 offset:61440
ds_read_b64_tr_b16 v[58:59], v22 offset:63488
v_mfma_f32_16x16x32_bf16 v[168:171], a[168:171], v[40:43], v[168:171]
ds_read_b64_tr_b16 v[60:61], v23 offset:61440
ds_read_b64_tr_b16 v[62:63], v23 offset:63488
ds_read_b128 v[72:75], v24 offset:15360
v_mfma_f32_16x16x32_bf16 v[172:175], a[168:171], v[44:47], v[172:175]
buffer_load_dwordx4 a[36:39], v13, s[60:63], s66 offen offset:1024
buffer_load_dwordx4 a[40:43], v13, s[60:63], s66 offen offset:2048
buffer_load_dwordx4 a[44:47], v13, s[60:63], s66 offen offset:3072
s_add_u32 s64, s64, 1
v_mfma_f32_16x16x32_bf16 v[176:179], a[172:175], v[32:35], v[176:179]
v_lshlrev_b32 v80, 16, v32
v_and_b32 v81, 0xffff0000, v32
v_lshlrev_b32 v82, 16, v33
v_mfma_f32_16x16x32_bf16 v[180:183], a[172:175], v[36:39], v[180:183]
v_and_b32 v83, 0xffff0000, v33
v_lshlrev_b32 v84, 16, v34
v_and_b32 v85, 0xffff0000, v34
v_mfma_f32_16x16x32_bf16 v[184:187], a[172:175], v[40:43], v[184:187]
v_lshlrev_b32 v86, 16, v35
v_and_b32 v87, 0xffff0000, v35
v_mul_f32 v80, v80, v80
v_mfma_f32_16x16x32_bf16 v[188:191], a[172:175], v[44:47], v[188:191]
v_mul_f32 v81, v81, v81
v_mul_f32 v82, v82, v82
v_mul_f32 v83, v83, v83
v_mfma_f32_16x16x32_bf16 v[192:195], a[176:179], v[32:35], v[192:195]
v_mul_f32 v84, v84, v84
v_mul_f32 v85, v85, v85
v_mul_f32 v86, v86, v86
v_mfma_f32_16x16x32_bf16 v[196:199], a[176:179], v[36:39], v[196:199]
v_mul_f32 v87, v87, v87
v_cvt_pk_bf16_f32 v88, v80, v81
v_cvt_pk_bf16_f32 v89, v82, v83
v_mfma_f32_16x16x32_bf16 v[200:203], a[176:179], v[40:43], v[200:203]
v_cvt_pk_bf16_f32 v90, v84, v85
v_cvt_pk_bf16_f32 v91, v86, v87
v_mfma_f32_16x16x32_bf16 v[204:207], a[176:179], v[44:47], v[204:207]
s_waitcnt vmcnt(33) lgkmcnt(0)
v_mfma_f32_16x16x32_bf16 v[96:99], v[64:67], v[88:91], v[96:99]
v_mfma_f32_16x16x32_bf16 v[160:163], a[180:183], v[48:51], v[160:163]
s_cmp_ge_u32 s64, s67
s_cselect_b32 s66, 4, 0
s_add_u32 s66, s66, s64
s_min_u32 s66, s66, 42
s_lshl_b32 s66, s66, 12
s_add_u32 s66, s66, s59
s_cmp_eq_u32 s64, 39
s_cselect_b32 s62, 0, s10
buffer_load_dwordx4 a[48:51], v13, s[60:63], s66 offen offset:0
buffer_load_dwordx4 a[52:55], v13, s[60:63], s66 offen offset:1024
v_mfma_f32_16x16x32_bf16 v[164:167], a[180:183], v[52:55], v[164:167]
buffer_load_dwordx4 a[56:59], v13, s[60:63], s66 offen offset:2048
v_lshlrev_b32 v80, 16, v48
v_mfma_f32_16x16x32_bf16 v[168:171], a[180:183], v[56:59], v[168:171]
v_and_b32 v81, 0xffff0000, v48
v_lshlrev_b32 v82, 16, v49
v_mfma_f32_16x16x32_bf16 v[172:175], a[180:183], v[60:63], v[172:175]
v_and_b32 v83, 0xffff0000, v49
v_lshlrev_b32 v84, 16, v50
v_mfma_f32_16x16x32_bf16 v[176:179], a[184:187], v[48:51], v[176:179]
v_and_b32 v85, 0xffff0000, v50
v_lshlrev_b32 v86, 16, v51
v_mfma_f32_16x16x32_bf16 v[180:183], a[184:187], v[52:55], v[180:183]
v_and_b32 v87, 0xffff0000, v51
v_mul_f32 v80, v80, v80
v_mfma_f32_16x16x32_bf16 v[184:187], a[184:187], v[56:59], v[184:187]
v_mul_f32 v81, v81, v81
v_mul_f32 v82, v82, v82
v_mfma_f32_16x16x32_bf16 v[188:191], a[184:187], v[60:63], v[188:191]
v_mul_f32 v83, v83, v83
v_mul_f32 v84, v84, v84
v_mfma_f32_16x16x32_bf16 v[192:195], a[188:191], v[48:51], v[192:195]
v_mul_f32 v85, v85, v85
v_mul_f32 v86, v86, v86
v_mfma_f32_16x16x32_bf16 v[196:199], a[188:191], v[52:55], v[196:199]
v_mul_f32 v87, v87, v87
v_cvt_pk_bf16_f32 v88, v80, v81
v_mfma_f32_16x16x32_bf16 v[200:203], a[188:191], v[56:59], v[200:203]
v_cvt_pk_bf16_f32 v89, v82, v83
v_cvt_pk_bf16_f32 v90, v84, v85
v_mfma_f32_16x16x32_bf16 v[204:207], a[188:191], v[60:63], v[204:207]
v_cvt_pk_bf16_f32 v91, v86, v87
s_nop 1
v_mfma_f32_16x16x32_bf16 v[96:99], v[72:75], v[88:91], v[96:99]
s_waitcnt vmcnt(23)
buffer_load_dwordx4 a[60:63], v13, s[60:63], s66 offen offset:3072
s_add_u32 s64, s64, 1
v_add_f32 v112, v112, v115
v_add_f32 v118, v118, v121
v_add_f32 v112, v112, v118
v_add_f32 v113, v113, v116
v_add_f32 v119, v119, v122
v_add_f32 v113, v113, v119
v_add_f32 v114, v114, v117
v_add_f32 v120, v120, v123
v_add_f32 v114, v114, v120
v_lshlrev_b32 v124, 16, v124
s_cmp_ge_u32 s64, s67
s_cselect_b32 s66, 4, 0
s_add_u32 s66, s66, s64
s_min_u32 s66, s66, 42
s_lshl_b32 s66, s66, 12
s_add_u32 s66, s66, s59
s_cmp_eq_u32 s64, 39
s_cselect_b32 s62, 0, s10
buffer_load_dwordx4 a[64:67], v13, s[60:63], s66 offen offset:0
buffer_load_dwordx4 a[68:71], v13, s[60:63], s66 offen offset:1024
s_mul_i32 s30, s24, 768
s_add_u32 s30, s30, 67584
v_lshlrev_b32 v2, 8, v3
v_lshl_add_u32 v2, v6, 2, v2
v_add_u32 v2, s30, v2
v_cmp_gt_u32 vcc, 48, v1
s_and_saveexec_b64 s[42:43], vcc
ds_write_b32 v2, v112
ds_write_b32 v2, v114 offset:64
ds_write_b32 v2, v113 offset:128
ds_write_b32 v2, v124 offset:192
s_mov_b64 exec, s[42:43]
buffer_load_dwordx4 a[72:75], v13, s[60:63], s66 offen offset:2048
buffer_load_dwordx4 a[76:79], v13, s[60:63], s66 offen offset:3072
s_add_u32 s64, s64, 1
s_lshl_b32 s30, s24, 9
s_add_u32 s30, s30, 70656
v_lshl_add_u32 v2, v6, 5, s30
v_add_f32 v97, v98, v99
v_cmp_eq_u32 vcc, 0, v3
s_and_saveexec_b64 s[42:43], vcc
ds_write_b64 v2, v[96:97] offset:24
s_mov_b64 exec, s[42:43]
s_cmp_eq_u32 s24, 3
s_cbranch_scc0 K3_nolin
v_cmp_eq_u32 s[52:53], 0, v3
v_cmp_eq_u32 s[54:55], 1, v3
s_lshl_b32 s30, s48, 9
s_add_u32 s30, s30, 70656
v_lshl_add_u32 v60, v6, 5, s30
s_lshl_b32 s30, s49, 9
s_add_u32 s30, s30, 70656
v_lshl_add_u32 v61, v6, 5, s30
s_lshl_b32 s30, s50, 9
s_add_u32 s30, s30, 70656
v_lshl_add_u32 v62, v6, 5, s30
s_lshl_b32 s30, s51, 9
s_add_u32 s30, s30, 70656
v_lshl_add_u32 v63, v6, 5, s30
s_mov_b64 s[42:43], exec
s_mov_b64 exec, s[52:53]
ds_write_b128 v60, v[192:195]
ds_write_b128 v61, v[196:199]
ds_write_b128 v62, v[200:203]
ds_write_b128 v63, v[204:207]
s_mov_b64 exec, s[54:55]
ds_write_b64 v60, v[192:193] offset:16
ds_write_b64 v61, v[196:197] offset:16
ds_write_b64 v62, v[200:201] offset:16
ds_write_b64 v63, v[204:205] offset:16
s_mov_b64 exec, s[42:43]
K3_nolin:
s_cmp_ge_u32 s64, s67
s_cselect_b32 s66, 4, 0
s_add_u32 s66, s66, s64
s_min_u32 s66, s66, 42
s_lshl_b32 s66, s66, 12
s_add_u32 s66, s66, s59
s_cmp_eq_u32 s64, 39
s_cselect_b32 s62, 0, s10
buffer_load_dwordx4 a[80:83], v13, s[60:63], s66 offen offset:0
buffer_load_dwordx4 a[84:87], v13, s[60:63], s66 offen offset:1024
s_waitcnt lgkmcnt(0)
s_barrier
buffer_load_dwordx4 a[88:91], v13, s[60:63], s66 offen offset:2048
buffer_load_dwordx4 a[92:95], v13, s[60:63], s66 offen offset:3072
s_add_u32 s64, s64, 1
v_lshlrev_b32 v2, 5, v1
v_add_u32 v2, 70656, v2
ds_read_b128 v[32:35], v2
ds_read_b128 v[36:39], v2 offset:16
s_mul_i32 s30, s24, 768
s_add_u32 s30, s30, 67584
v_lshl_add_u32 v25, v3, 4, s30
s_mov_b32 s56, 0xbdd2d3e2
s_mov_b32 s57, 0xc0135761
s_waitcnt lgkmcnt(0)
v_add_f32 v34, v34, v35
v_add_f32 v36, v36, v37
v_mul_f32 v32, 0x3b000000, v32
v_mul_f32 v38, 0x3b000000, v38
v_fma_f32 v38, -v32, v32, v38
v_max_f32 v38, 0, v38
v_cvt_pk_bf16_f32 v40, v32, v38
v_lshlrev_b32 v32, 16, v40
v_and_b32 v38, 0xffff0000, v40
v_add_f32 v38, 0x3727c5ac, v38
v_cvt_pk_bf16_f32 v38, v38, v38
v_and_b32 v38, 0xffff0000, v38
v_sqrt_f32 v38, v38
v_fma_f32 v33, -v32, s36, v33
s_cmp_ge_u32 s64, s67
s_cselect_b32 s66, 4, 0
s_add_u32 s66, s66, s64
s_min_u32 s66, s66, 42
s_lshl_b32 s66, s66, 12
s_add_u32 s66, s66, s59
s_cmp_eq_u32 s64, 39
s_cselect_b32 s62, 0, s10
buffer_load_dwordx4 a[96:99], v13, s[60:63], s66 offen offset:0
buffer_load_dwordx4 a[100:103], v13, s[60:63], s66 offen offset:1024
v_cvt_pk_bf16_f32 v38, v38, v38
v_and_b32 v38, 0xffff0000, v38
v_rcp_f32 v38, v38
v_mul_f32 v40, v32, v32
v_add_f32 v41, v32, v32
v_fma_f32 v39, -v41, v34, v39
v_fma_f32 v39, v40, s37, v39
v_fma_f32 v36, -v32, s38, v36
v_fma_f32 v33, v33, v38, s39
v_add_f32 v36, v36, v36
v_fma_f32 v39, v39, v38, v36
v_mul_f32 v33, 0x3b000000, v33
buffer_load_dwordx4 a[104:107], v13, s[60:63], s66 offen offset:2048
buffer_load_dwordx4 a[108:111], v13, s[60:63], s66 offen offset:3072
s_add_u32 s64, s64, 1
v_fma_f32 v39, v39, v38, s40
v_mul_f32 v39, 0x3b000000, v39
v_fma_f32 v39, -v33, v33, v39
v_max_f32 v39, 0, v39
v_cvt_pk_bf16_f32 v40, v33, v39
v_lshlrev_b32 v33, 16, v40
v_and_b32 v39, 0xffff0000, v40
v_add_f32 v39, 0x3727c5ac, v39
v_cvt_pk_bf16_f32 v39, v39, v39
v_and_b32 v39, 0xffff0000, v39
v_sqrt_f32 v39, v39
s_nop 0
v_cvt_pk_bf16_f32 v39, v39, v39
v_and_b32 v39, 0xffff0000, v39
v_rcp_f32 v47, v39
s_lshl_b32 s30, s24, 10
s_add_u32 s30, s30, 72704
v_mul_f32 v44, v47, v38
v_mul_f32 v46, -v47, v33
v_mul_f32 v45, -v44, v32
v_lshl_add_u32 v2, v1, 4, s30
ds_write_b128 v2, v[44:47]
s_waitcnt lgkmcnt(0)
s_lshl_b32 s31, s48, 8
s_add_u32 s31, s31, s30
v_lshl_add_u32 v2, v6, 4, s31
ds_read_b128 v[48:51], v2
s_lshl_b32 s31, s49, 8
s_add_u32 s31, s31, s30
v_lshl_add_u32 v2, v6, 4, s31
ds_read_b128 v[52:55], v2
s_lshl_b32 s31, s50, 8
s_add_u32 s31, s31, s30
v_lshl_add_u32 v2, v6, 4, s31
ds_read_b128 v[56:59], v2
s_lshl_b32 s31, s51, 8
s_add_u32 s31, s31, s30
v_lshl_add_u32 v2, v6, 4, s31
ds_read_b128 v[60:63], v2
ds_read_b128 v[64:67], v25 offset:0
ds_read_b128 v[68:71], v25 offset:64
ds_read_b128 v[72:75], v25 offset:128
ds_read_b128 v[76:79], v25 offset:192
ds_read_b128 v[128:131], v25 offset:256
ds_read_b128 v[132:135], v25 offset:320
ds_read_b128 v[136:139], v25 offset:384
ds_read_b128 v[140:143], v25 offset:448
ds_read_b128 v[144:147], v25 offset:512
ds_read_b128 v[148:151], v25 offset:576
ds_read_b128 v[152:155], v25 offset:640
ds_read_b128 v[156:159], v25 offset:704
s_cmp_ge_u32 s64, s67
s_cselect_b32 s66, 4, 0
s_add_u32 s66, s66, s64
s_min_u32 s66, s66, 42
s_lshl_b32 s66, s66, 12
s_add_u32 s66, s66, s59
s_cmp_eq_u32 s64, 39
s_cselect_b32 s62, 0, s10
buffer_load_dwordx4 a[112:115], v13, s[60:63], s66 offen offset:0
buffer_load_dwordx4 a[116:119], v13, s[60:63], s66 offen offset:1024
s_waitcnt lgkmcnt(0)
s_cmp_eq_u32 s32, 86
s_cbranch_scc1 K3_skip0
s_add_u32 s30, s29, 0
s_lshr_b32 s31, s30, 1
s_lshl_b32 s31, s31, 12
s_and_b32 s30, s30, 1
s_lshl_b32 s30, s30, 3
s_add_u32 s30, s30, s31
s_add_u32 s30, s30, 76800
v_pk_fma_f32 v[96:97], v[64:65], v[48:49], v[76:77] op_sel:[0,1,0] op_sel_hi:[1,1,1]
v_pk_fma_f32 v[98:99], v[66:67], v[48:49], v[78:79] op_sel:[0,1,0] op_sel_hi:[1,1,1]
v_pk_fma_f32 v[100:101], v[64:65], v[52:53], v[76:77] op_sel:[0,1,0] op_sel_hi:[1,1,1]
v_pk_fma_f32 v[102:103], v[66:67], v[52:53], v[78:79] op_sel:[0,1,0] op_sel_hi:[1,1,1]
v_pk_fma_f32 v[104:105], v[64:65], v[56:57], v[76:77] op_sel:[0,1,0] op_sel_hi:[1,1,1]
v_pk_fma_f32 v[106:107], v[66:67], v[56:57], v[78:79] op_sel:[0,1,0] op_sel_hi:[1,1,1]
v_pk_fma_f32 v[108:109], v[64:65], v[60:61], v[76:77] op_sel:[0,1,0] op_sel_hi:[1,1,1]
v_pk_fma_f32 v[110:111], v[66:67], v[60:61], v[78:79] op_sel:[0,1,0] op_sel_hi:[1,1,1]
buffer_load_dwordx4 a[120:123], v13, s[60:63], s66 offen offset:2048
buffer_load_dwordx4 a[124:127], v13, s[60:63], s66 offen offset:3072
s_add_u32 s64, s64, 1
v_pk_fma_f32 v[96:97], v[68:69], v[50:51], v[96:97] op_sel_hi:[1,0,1]
v_pk_fma_f32 v[98:99], v[70:71], v[50:51], v[98:99] op_sel_hi:[1,0,1]
v_pk_fma_f32 v[100:101], v[68:69], v[54:55], v[100:101] op_sel_hi:[1,0,1]
v_pk_fma_f32 v[102:103], v[70:71], v[54:55], v[102:103] op_sel_hi:[1,0,1]
v_pk_fma_f32 v[104:105], v[68:69], v[58:59], v[104:105] op_sel_hi:[1,0,1]
v_pk_fma_f32 v[106:107], v[70:71], v[58:59], v[106:107] op_sel_hi:[1,0,1]
v_pk_fma_f32 v[108:109], v[68:69], v[62:63], v[108:109] op_sel_hi:[1,0,1]
v_pk_fma_f32 v[110:111], v[70:71], v[62:63], v[110:111] op_sel_hi:[1,0,1]
s_cmp_ge_u32 s64, s67
s_cselect_b32 s66, 4, 0
s_add_u32 s66, s66, s64
s_min_u32 s66, s66, 42
s_lshl_b32 s66, s66, 12
s_add_u32 s66, s66, s59
s_cmp_eq_u32 s64, 39
s_cselect_b32 s62, 0, s10
buffer_load_dwordx4 a[128:131], v13, s[60:63], s66 offen offset:0
buffer_load_dwordx4 a[132:135], v13, s[60:63], s66 offen offset:1024
v_pk_fma_f32 v[96:97], v[72:73], v[50:51], v[96:97] op_sel:[0,1,0] op_sel_hi:[1,1,1]
v_pk_fma_f32 v[98:99], v[74:75], v[50:51], v[98:99] op_sel:[0,1,0] op_sel_hi:[1,1,1]
v_pk_fma_f32 v[100:101], v[72:73], v[54:55], v[100:101] op_sel:[0,1,0] op_sel_hi:[1,1,1]
v_pk_fma_f32 v[102:103], v[74:75], v[54:55], v[102:103] op_sel:[0,1,0] op_sel_hi:[1,1,1]
v_pk_fma_f32 v[104:105], v[72:73], v[58:59], v[104:105] op_sel:[0,1,0] op_sel_hi:[1,1,1]
v_pk_fma_f32 v[106:107], v[74:75], v[58:59], v[106:107] op_sel:[0,1,0] op_sel_hi:[1,1,1]
v_pk_fma_f32 v[108:109], v[72:73], v[62:63], v[108:109] op_sel:[0,1,0] op_sel_hi:[1,1,1]
v_pk_fma_f32 v[110:111], v[74:75], v[62:63], v[110:111] op_sel:[0,1,0] op_sel_hi:[1,1,1]
buffer_load_dwordx4 a[136:139], v13, s[60:63], s66 offen offset:2048
buffer_load_dwordx4 a[140:143], v13, s[60:63], s66 offen offset:3072
s_add_u32 s64, s64, 1
v_pk_fma_f32 v[160:161], v[160:161], v[48:49], v[96:97] op_sel_hi:[1,0,1]
v_pk_fma_f32 v[162:163], v[162:163], v[48:49], v[98:99] op_sel_hi:[1,0,1]
v_pk_fma_f32 v[164:165], v[164:165], v[52:53], v[100:101] op_sel_hi:[1,0,1]
v_pk_fma_f32 v[166:167], v[166:167], v[52:53], v[102:103] op_sel_hi:[1,0,1]
v_pk_fma_f32 v[168:169], v[168:169], v[56:57], v[104:105] op_sel_hi:[1,0,1]
v_pk_fma_f32 v[170:171], v[170:171], v[56:57], v[106:107] op_sel_hi:[1,0,1]
v_pk_fma_f32 v[172:173], v[172:173], v[60:61], v[108:109] op_sel_hi:[1,0,1]
v_pk_fma_f32 v[174:175], v[174:175], v[60:61], v[110:111] op_sel_hi:[1,0,1]
s_cmp_ge_u32 s64, s67
s_cselect_b32 s66, 4, 0
s_add_u32 s66, s66, s64
s_min_u32 s66, s66, 42
s_lshl_b32 s66, s66, 12
s_add_u32 s66, s66, s59
s_cmp_eq_u32 s64, 39
s_cselect_b32 s62, 0, s10
buffer_load_dwordx4 a[144:147], v13, s[60:63], s66 offen offset:0
buffer_load_dwordx4 a[148:151], v13, s[60:63], s66 offen offset:1024
v_pk_mul_f32 v[96:97], v[160:161], v[160:161]
v_pk_mul_f32 v[98:99], v[162:163], v[162:163]
v_pk_mul_f32 v[100:101], v[164:165], v[164:165]
v_pk_mul_f32 v[102:103], v[166:167], v[166:167]
v_pk_mul_f32 v[104:105], v[168:169], v[168:169]
v_pk_mul_f32 v[106:107], v[170:171], v[170:171]
v_pk_mul_f32 v[108:109], v[172:173], v[172:173]
v_pk_mul_f32 v[110:111], v[174:175], v[174:175]
v_pk_fma_f32 v[96:97], v[96:97], s[56:57], s[56:57] op_sel:[0,0,1] op_sel_hi:[1,0,1]
v_pk_fma_f32 v[98:99], v[98:99], s[56:57], s[56:57] op_sel:[0,0,1] op_sel_hi:[1,0,1]
v_pk_fma_f32 v[100:101], v[100:101], s[56:57], s[56:57] op_sel:[0,0,1] op_sel_hi:[1,0,1]
v_pk_fma_f32 v[102:103], v[102:103], s[56:57], s[56:57] op_sel:[0,0,1] op_sel_hi:[1,0,1]
v_pk_fma_f32 v[104:105], v[104:105], s[56:57], s[56:57] op_sel:[0,0,1] op_sel_hi:[1,0,1]
v_pk_fma_f32 v[106:107], v[106:107], s[56:57], s[56:57] op_sel:[0,0,1] op_sel_hi:[1,0,1]
v_pk_fma_f32 v[108:109], v[108:109], s[56:57], s[56:57] op_sel:[0,0,1] op_sel_hi:[1,0,1]
v_pk_fma_f32 v[110:111], v[110:111], s[56:57], s[56:57] op_sel:[0,0,1] op_sel_hi:[1,0,1]
buffer_load_dwordx4 a[152:155], v13, s[60:63], s66 offen offset:2048
buffer_load_dwordx4 a[156:159], v13, s[60:63], s66 offen offset:3072
s_add_u32 s64, s64, 1
v_pk_mul_f32 v[96:97], v[96:97], v[160:161]
v_pk_mul_f32 v[98:99], v[98:99], v[162:163]
v_pk_mul_f32 v[100:101], v[100:101], v[164:165]
v_pk_mul_f32 v[102:103], v[102:103], v[166:167]
v_pk_mul_f32 v[104:105], v[104:105], v[168:169]
v_pk_mul_f32 v[106:107], v[106:107], v[170:171]
v_pk_mul_f32 v[108:109], v[108:109], v[172:173]
v_pk_mul_f32 v[110:111], v[110:111], v[174:175]
v_exp_f32 v96, v96
v_exp_f32 v97, v97
v_exp_f32 v98, v98
v_exp_f32 v99, v99
v_exp_f32 v100, v100
v_exp_f32 v101, v101
v_exp_f32 v102, v102
v_exp_f32 v103, v103
v_exp_f32 v104, v104
v_exp_f32 v105, v105
v_exp_f32 v106, v106
v_exp_f32 v107, v107
v_exp_f32 v108, v108
v_exp_f32 v109, v109
v_exp_f32 v110, v110
v_exp_f32 v111, v111
s_cmp_ge_u32 s64, s67
s_cselect_b32 s66, 4, 0
s_add_u32 s66, s66, s64
s_min_u32 s66, s66, 42
s_lshl_b32 s66, s66, 12
s_add_u32 s66, s66, s59
s_cmp_eq_u32 s64, 39
s_cselect_b32 s62, 0, s10
buffer_load_dwordx4 a[160:163], v13, s[60:63], s66 offen offset:0
buffer_load_dwordx4 a[164:167], v13, s[60:63], s66 offen offset:1024
buffer_load_dwordx4 a[168:171], v13, s[60:63], s66 offen offset:2048
v_pk_add_f32 v[96:97], v[96:97], 1.0 op_sel_hi:[1,0]
v_pk_add_f32 v[98:99], v[98:99], 1.0 op_sel_hi:[1,0]
v_pk_add_f32 v[100:101], v[100:101], 1.0 op_sel_hi:[1,0]
v_pk_add_f32 v[102:103], v[102:103], 1.0 op_sel_hi:[1,0]
v_pk_add_f32 v[104:105], v[104:105], 1.0 op_sel_hi:[1,0]
v_pk_add_f32 v[106:107], v[106:107], 1.0 op_sel_hi:[1,0]
v_pk_add_f32 v[108:109], v[108:109], 1.0 op_sel_hi:[1,0]
v_pk_add_f32 v[110:111], v[110:111], 1.0 op_sel_hi:[1,0]
v_rcp_f32 v96, v96
v_rcp_f32 v97, v97
v_rcp_f32 v98, v98
v_rcp_f32 v99, v99
v_rcp_f32 v100, v100
v_rcp_f32 v101, v101
v_rcp_f32 v102, v102
v_rcp_f32 v103, v103
v_rcp_f32 v104, v104
v_rcp_f32 v105, v105
v_rcp_f32 v106, v106
v_rcp_f32 v107, v107
v_rcp_f32 v108, v108
v_rcp_f32 v109, v109
v_rcp_f32 v110, v110
v_rcp_f32 v111, v111
buffer_load_dwordx4 a[172:175], v13, s[60:63], s66 offen offset:3072
s_add_u32 s64, s64, 1
v_pk_mul_f32 v[160:161], v[160:161], v[96:97]
v_pk_mul_f32 v[162:163], v[162:163], v[98:99]
v_pk_mul_f32 v[164:165], v[164:165], v[100:101]
v_pk_mul_f32 v[166:167], v[166:167], v[102:103]
v_pk_mul_f32 v[168:169], v[168:169], v[104:105]
v_pk_mul_f32 v[170:171], v[170:171], v[106:107]
v_pk_mul_f32 v[172:173], v[172:173], v[108:109]
v_pk_mul_f32 v[174:175], v[174:175], v[110:111]
v_cvt_pk_bf16_f32 v112, v160, v161
v_cvt_pk_bf16_f32 v113, v162, v163
v_cvt_pk_bf16_f32 v114, v164, v165
v_cvt_pk_bf16_f32 v115, v166, v167
v_cvt_pk_bf16_f32 v116, v168, v169
v_cvt_pk_bf16_f32 v117, v170, v171
v_cvt_pk_bf16_f32 v118, v172, v173
v_cvt_pk_bf16_f32 v119, v174, v175
s_lshl_b32 s31, s48, 10
s_add_u32 s31, s31, s30
v_add_u32 v2, s31, v13
ds_write_b64 v2, v[112:113]
s_lshl_b32 s31, s49, 10
s_add_u32 s31, s31, s30
v_add_u32 v2, s31, v13
ds_write_b64 v2, v[114:115]
s_lshl_b32 s31, s50, 10
s_add_u32 s31, s31, s30
v_add_u32 v2, s31, v13
ds_write_b64 v2, v[116:117]
s_lshl_b32 s31, s51, 10
s_add_u32 s31, s31, s30
v_add_u32 v2, s31, v13
ds_write_b64 v2, v[118:119]
K3_skip0:
s_cmp_eq_u32 s33, 86
s_cbranch_scc1 K3_skip1
s_add_u32 s30, s29, 1
s_lshr_b32 s31, s30, 1
s_lshl_b32 s31, s31, 12
s_and_b32 s30, s30, 1
s_lshl_b32 s30, s30, 3
s_add_u32 s30, s30, s31
s_add_u32 s30, s30, 76800
v_pk_fma_f32 v[96:97], v[128:129], v[48:49], v[140:141] op_sel:[0,1,0] op_sel_hi:[1,1,1]
v_pk_fma_f32 v[98:99], v[130:131], v[48:49], v[142:143] op_sel:[0,1,0] op_sel_hi:[1,1,1]
v_pk_fma_f32 v[100:101], v[128:129], v[52:53], v[140:141] op_sel:[0,1,0] op_sel_hi:[1,1,1]
v_pk_fma_f32 v[102:103], v[130:131], v[52:53], v[142:143] op_sel:[0,1,0] op_sel_hi:[1,1,1]
v_pk_fma_f32 v[104:105], v[128:129], v[56:57], v[140:141] op_sel:[0,1,0] op_sel_hi:[1,1,1]
v_pk_fma_f32 v[106:107], v[130:131], v[56:57], v[142:143] op_sel:[0,1,0] op_sel_hi:[1,1,1]
v_pk_fma_f32 v[108:109], v[128:129], v[60:61], v[140:141] op_sel:[0,1,0] op_sel_hi:[1,1,1]
v_pk_fma_f32 v[110:111], v[130:131], v[60:61], v[142:143] op_sel:[0,1,0] op_sel_hi:[1,1,1]
v_pk_fma_f32 v[96:97], v[132:133], v[50:51], v[96:97] op_sel_hi:[1,0,1]
v_pk_fma_f32 v[98:99], v[134:135], v[50:51], v[98:99] op_sel_hi:[1,0,1]
v_pk_fma_f32 v[100:101], v[132:133], v[54:55], v[100:101] op_sel_hi:[1,0,1]
v_pk_fma_f32 v[102:103], v[134:135], v[54:55], v[102:103] op_sel_hi:[1,0,1]
v_pk_fma_f32 v[104:105], v[132:133], v[58:59], v[104:105] op_sel_hi:[1,0,1]
v_pk_fma_f32 v[106:107], v[134:135], v[58:59], v[106:107] op_sel_hi:[1,0,1]
v_pk_fma_f32 v[108:109], v[132:133], v[62:63], v[108:109] op_sel_hi:[1,0,1]
v_pk_fma_f32 v[110:111], v[134:135], v[62:63], v[110:111] op_sel_hi:[1,0,1]
v_pk_fma_f32 v[96:97], v[136:137], v[50:51], v[96:97] op_sel:[0,1,0] op_sel_hi:[1,1,1]
v_pk_fma_f32 v[98:99], v[138:139], v[50:51], v[98:99] op_sel:[0,1,0] op_sel_hi:[1,1,1]
v_pk_fma_f32 v[100:101], v[136:137], v[54:55], v[100:101] op_sel:[0,1,0] op_sel_hi:[1,1,1]
v_pk_fma_f32 v[102:103], v[138:139], v[54:55], v[102:103] op_sel:[0,1,0] op_sel_hi:[1,1,1]
v_pk_fma_f32 v[104:105], v[136:137], v[58:59], v[104:105] op_sel:[0,1,0] op_sel_hi:[1,1,1]
v_pk_fma_f32 v[106:107], v[138:139], v[58:59], v[106:107] op_sel:[0,1,0] op_sel_hi:[1,1,1]
v_pk_fma_f32 v[108:109], v[136:137], v[62:63], v[108:109] op_sel:[0,1,0] op_sel_hi:[1,1,1]
v_pk_fma_f32 v[110:111], v[138:139], v[62:63], v[110:111] op_sel:[0,1,0] op_sel_hi:[1,1,1]
v_pk_fma_f32 v[176:177], v[176:177], v[48:49], v[96:97] op_sel_hi:[1,0,1]
v_pk_fma_f32 v[178:179], v[178:179], v[48:49], v[98:99] op_sel_hi:[1,0,1]
v_pk_fma_f32 v[180:181], v[180:181], v[52:53], v[100:101] op_sel_hi:[1,0,1]
v_pk_fma_f32 v[182:183], v[182:183], v[52:53], v[102:103] op_sel_hi:[1,0,1]
v_pk_fma_f32 v[184:185], v[184:185], v[56:57], v[104:105] op_sel_hi:[1,0,1]
v_pk_fma_f32 v[186:187], v[186:187], v[56:57], v[106:107] op_sel_hi:[1,0,1]
v_pk_fma_f32 v[188:189], v[188:189], v[60:61], v[108:109] op_sel_hi:[1,0,1]
v_pk_fma_f32 v[190:191], v[190:191], v[60:61], v[110:111] op_sel_hi:[1,0,1]
v_pk_mul_f32 v[96:97], v[176:177], v[176:177]
v_pk_mul_f32 v[98:99], v[178:179], v[178:179]
v_pk_mul_f32 v[100:101], v[180:181], v[180:181]
v_pk_mul_f32 v[102:103], v[182:183], v[182:183]
v_pk_mul_f32 v[104:105], v[184:185], v[184:185]
v_pk_mul_f32 v[106:107], v[186:187], v[186:187]
v_pk_mul_f32 v[108:109], v[188:189], v[188:189]
v_pk_mul_f32 v[110:111], v[190:191], v[190:191]
v_pk_fma_f32 v[96:97], v[96:97], s[56:57], s[56:57] op_sel:[0,0,1] op_sel_hi:[1,0,1]
v_pk_fma_f32 v[98:99], v[98:99], s[56:57], s[56:57] op_sel:[0,0,1] op_sel_hi:[1,0,1]
v_pk_fma_f32 v[100:101], v[100:101], s[56:57], s[56:57] op_sel:[0,0,1] op_sel_hi:[1,0,1]
v_pk_fma_f32 v[102:103], v[102:103], s[56:57], s[56:57] op_sel:[0,0,1] op_sel_hi:[1,0,1]
v_pk_fma_f32 v[104:105], v[104:105], s[56:57], s[56:57] op_sel:[0,0,1] op_sel_hi:[1,0,1]
v_pk_fma_f32 v[106:107], v[106:107], s[56:57], s[56:57] op_sel:[0,0,1] op_sel_hi:[1,0,1]
v_pk_fma_f32 v[108:109], v[108:109], s[56:57], s[56:57] op_sel:[0,0,1] op_sel_hi:[1,0,1]
v_pk_fma_f32 v[110:111], v[110:111], s[56:57], s[56:57] op_sel:[0,0,1] op_sel_hi:[1,0,1]
v_pk_mul_f32 v[96:97], v[96:97], v[176:177]
v_pk_mul_f32 v[98:99], v[98:99], v[178:179]
v_pk_mul_f32 v[100:101], v[100:101], v[180:181]
v_pk_mul_f32 v[102:103], v[102:103], v[182:183]
v_pk_mul_f32 v[104:105], v[104:105], v[184:185]
v_pk_mul_f32 v[106:107], v[106:107], v[186:187]
v_pk_mul_f32 v[108:109], v[108:109], v[188:189]
v_pk_mul_f32 v[110:111], v[110:111], v[190:191]
v_exp_f32 v96, v96
v_exp_f32 v97, v97
v_exp_f32 v98, v98
v_exp_f32 v99, v99
v_exp_f32 v100, v100
v_exp_f32 v101, v101
v_exp_f32 v102, v102
v_exp_f32 v103, v103
v_exp_f32 v104, v104
v_exp_f32 v105, v105
v_exp_f32 v106, v106
v_exp_f32 v107, v107
v_exp_f32 v108, v108
v_exp_f32 v109, v109
v_exp_f32 v110, v110
v_exp_f32 v111, v111
v_pk_add_f32 v[96:97], v[96:97], 1.0 op_sel_hi:[1,0]
v_pk_add_f32 v[98:99], v[98:99], 1.0 op_sel_hi:[1,0]
v_pk_add_f32 v[100:101], v[100:101], 1.0 op_sel_hi:[1,0]
v_pk_add_f32 v[102:103], v[102:103], 1.0 op_sel_hi:[1,0]
v_pk_add_f32 v[104:105], v[104:105], 1.0 op_sel_hi:[1,0]
v_pk_add_f32 v[106:107], v[106:107], 1.0 op_sel_hi:[1,0]
v_pk_add_f32 v[108:109], v[108:109], 1.0 op_sel_hi:[1,0]
v_pk_add_f32 v[110:111], v[110:111], 1.0 op_sel_hi:[1,0]
v_rcp_f32 v96, v96
v_rcp_f32 v97, v97
v_rcp_f32 v98, v98
v_rcp_f32 v99, v99
v_rcp_f32 v100, v100
v_rcp_f32 v101, v101
v_rcp_f32 v102, v102
v_rcp_f32 v103, v103
v_rcp_f32 v104, v104
v_rcp_f32 v105, v105
v_rcp_f32 v106, v106
v_rcp_f32 v107, v107
v_rcp_f32 v108, v108
v_rcp_f32 v109, v109
v_rcp_f32 v110, v110
v_rcp_f32 v111, v111
v_pk_mul_f32 v[176:177], v[176:177], v[96:97]
v_pk_mul_f32 v[178:179], v[178:179], v[98:99]
v_pk_mul_f32 v[180:181], v[180:181], v[100:101]
v_pk_mul_f32 v[182:183], v[182:183], v[102:103]
v_pk_mul_f32 v[184:185], v[184:185], v[104:105]
v_pk_mul_f32 v[186:187], v[186:187], v[106:107]
v_pk_mul_f32 v[188:189], v[188:189], v[108:109]
v_pk_mul_f32 v[190:191], v[190:191], v[110:111]
v_cvt_pk_bf16_f32 v112, v176, v177
v_cvt_pk_bf16_f32 v113, v178, v179
v_cvt_pk_bf16_f32 v114, v180, v181
v_cvt_pk_bf16_f32 v115, v182, v183
v_cvt_pk_bf16_f32 v116, v184, v185
v_cvt_pk_bf16_f32 v117, v186, v187
v_cvt_pk_bf16_f32 v118, v188, v189
v_cvt_pk_bf16_f32 v119, v190, v191
s_cmp_eq_u32 s29, 9
s_cbranch_scc0 K3_paired1
s_lshr_b32 s31, s26, 1
s_add_u32 s31, s31, 40
s_mul_i32 s43, s25, 43
s_add_u32 s31, s31, s43
s_lshl_b32 s31, s31, 12
s_and_b32 s43, s26, 1
s_lshl_b32 s43, s43, 3
s_add_u32 s31, s31, s43
s_add_u32 s31, s31, 11534336
s_lshl_b32 s43, s48, 10
s_add_u32 s43, s43, s31
buffer_store_dwordx2 v[112:113], v13, s[8:11], s43 offen sc1
s_lshl_b32 s43, s49, 10
s_add_u32 s43, s43, s31
buffer_store_dwordx2 v[114:115], v13, s[8:11], s43 offen sc1
s_lshl_b32 s43, s50, 10
s_add_u32 s43, s43, s31
buffer_store_dwordx2 v[116:117], v13, s[8:11], s43 offen sc1
s_lshl_b32 s43, s51, 10
s_add_u32 s43, s43, s31
buffer_store_dwordx2 v[118:119], v13, s[8:11], s43 offen sc1
s_branch K3_skip1
K3_paired1:
s_lshl_b32 s31, s48, 10
s_add_u32 s31, s31, s30
v_add_u32 v2, s31, v13
ds_write_b64 v2, v[112:113]
s_lshl_b32 s31, s49, 10
s_add_u32 s31, s31, s30
v_add_u32 v2, s31, v13
ds_write_b64 v2, v[114:115]
s_lshl_b32 s31, s50, 10
s_add_u32 s31, s31, s30
v_add_u32 v2, s31, v13
ds_write_b64 v2, v[116:117]
s_lshl_b32 s31, s51, 10
s_add_u32 s31, s31, s30
v_add_u32 v2, s31, v13
ds_write_b64 v2, v[118:119]
K3_skip1:
s_cmp_eq_u32 s34, 86
s_cbranch_scc1 K3_skip2
s_add_u32 s30, s29, 2
s_lshr_b32 s31, s30, 1
s_lshl_b32 s31, s31, 12
s_and_b32 s30, s30, 1
s_lshl_b32 s30, s30, 3
s_add_u32 s30, s30, s31
s_add_u32 s30, s30, 76800
v_pk_fma_f32 v[96:97], v[144:145], v[48:49], v[156:157] op_sel:[0,1,0] op_sel_hi:[1,1,1]
v_pk_fma_f32 v[98:99], v[146:147], v[48:49], v[158:159] op_sel:[0,1,0] op_sel_hi:[1,1,1]
v_pk_fma_f32 v[100:101], v[144:145], v[52:53], v[156:157] op_sel:[0,1,0] op_sel_hi:[1,1,1]
v_pk_fma_f32 v[102:103], v[146:147], v[52:53], v[158:159] op_sel:[0,1,0] op_sel_hi:[1,1,1]
v_pk_fma_f32 v[104:105], v[144:145], v[56:57], v[156:157] op_sel:[0,1,0] op_sel_hi:[1,1,1]
v_pk_fma_f32 v[106:107], v[146:147], v[56:57], v[158:159] op_sel:[0,1,0] op_sel_hi:[1,1,1]
v_pk_fma_f32 v[108:109], v[144:145], v[60:61], v[156:157] op_sel:[0,1,0] op_sel_hi:[1,1,1]
v_pk_fma_f32 v[110:111], v[146:147], v[60:61], v[158:159] op_sel:[0,1,0] op_sel_hi:[1,1,1]
v_pk_fma_f32 v[96:97], v[148:149], v[50:51], v[96:97] op_sel_hi:[1,0,1]
v_pk_fma_f32 v[98:99], v[150:151], v[50:51], v[98:99] op_sel_hi:[1,0,1]
v_pk_fma_f32 v[100:101], v[148:149], v[54:55], v[100:101] op_sel_hi:[1,0,1]
v_pk_fma_f32 v[102:103], v[150:151], v[54:55], v[102:103] op_sel_hi:[1,0,1]
v_pk_fma_f32 v[104:105], v[148:149], v[58:59], v[104:105] op_sel_hi:[1,0,1]
v_pk_fma_f32 v[106:107], v[150:151], v[58:59], v[106:107] op_sel_hi:[1,0,1]
v_pk_fma_f32 v[108:109], v[148:149], v[62:63], v[108:109] op_sel_hi:[1,0,1]
v_pk_fma_f32 v[110:111], v[150:151], v[62:63], v[110:111] op_sel_hi:[1,0,1]
v_pk_fma_f32 v[96:97], v[152:153], v[50:51], v[96:97] op_sel:[0,1,0] op_sel_hi:[1,1,1]
v_pk_fma_f32 v[98:99], v[154:155], v[50:51], v[98:99] op_sel:[0,1,0] op_sel_hi:[1,1,1]
v_pk_fma_f32 v[100:101], v[152:153], v[54:55], v[100:101] op_sel:[0,1,0] op_sel_hi:[1,1,1]
v_pk_fma_f32 v[102:103], v[154:155], v[54:55], v[102:103] op_sel:[0,1,0] op_sel_hi:[1,1,1]
v_pk_fma_f32 v[104:105], v[152:153], v[58:59], v[104:105] op_sel:[0,1,0] op_sel_hi:[1,1,1]
v_pk_fma_f32 v[106:107], v[154:155], v[58:59], v[106:107] op_sel:[0,1,0] op_sel_hi:[1,1,1]
v_pk_fma_f32 v[108:109], v[152:153], v[62:63], v[108:109] op_sel:[0,1,0] op_sel_hi:[1,1,1]
v_pk_fma_f32 v[110:111], v[154:155], v[62:63], v[110:111] op_sel:[0,1,0] op_sel_hi:[1,1,1]
v_pk_fma_f32 v[192:193], v[192:193], v[48:49], v[96:97] op_sel_hi:[1,0,1]
v_pk_fma_f32 v[194:195], v[194:195], v[48:49], v[98:99] op_sel_hi:[1,0,1]
v_pk_fma_f32 v[196:197], v[196:197], v[52:53], v[100:101] op_sel_hi:[1,0,1]
v_pk_fma_f32 v[198:199], v[198:199], v[52:53], v[102:103] op_sel_hi:[1,0,1]
v_pk_fma_f32 v[200:201], v[200:201], v[56:57], v[104:105] op_sel_hi:[1,0,1]
v_pk_fma_f32 v[202:203], v[202:203], v[56:57], v[106:107] op_sel_hi:[1,0,1]
v_pk_fma_f32 v[204:205], v[204:205], v[60:61], v[108:109] op_sel_hi:[1,0,1]
v_pk_fma_f32 v[206:207], v[206:207], v[60:61], v[110:111] op_sel_hi:[1,0,1]
v_pk_mul_f32 v[96:97], v[192:193], v[192:193]
v_pk_mul_f32 v[98:99], v[194:195], v[194:195]
v_pk_mul_f32 v[100:101], v[196:197], v[196:197]
v_pk_mul_f32 v[102:103], v[198:199], v[198:199]
v_pk_mul_f32 v[104:105], v[200:201], v[200:201]
v_pk_mul_f32 v[106:107], v[202:203], v[202:203]
v_pk_mul_f32 v[108:109], v[204:205], v[204:205]
v_pk_mul_f32 v[110:111], v[206:207], v[206:207]
v_pk_fma_f32 v[96:97], v[96:97], s[56:57], s[56:57] op_sel:[0,0,1] op_sel_hi:[1,0,1]
v_pk_fma_f32 v[98:99], v[98:99], s[56:57], s[56:57] op_sel:[0,0,1] op_sel_hi:[1,0,1]
v_pk_fma_f32 v[100:101], v[100:101], s[56:57], s[56:57] op_sel:[0,0,1] op_sel_hi:[1,0,1]
v_pk_fma_f32 v[102:103], v[102:103], s[56:57], s[56:57] op_sel:[0,0,1] op_sel_hi:[1,0,1]
v_pk_fma_f32 v[104:105], v[104:105], s[56:57], s[56:57] op_sel:[0,0,1] op_sel_hi:[1,0,1]
v_pk_fma_f32 v[106:107], v[106:107], s[56:57], s[56:57] op_sel:[0,0,1] op_sel_hi:[1,0,1]
v_pk_fma_f32 v[108:109], v[108:109], s[56:57], s[56:57] op_sel:[0,0,1] op_sel_hi:[1,0,1]
v_pk_fma_f32 v[110:111], v[110:111], s[56:57], s[56:57] op_sel:[0,0,1] op_sel_hi:[1,0,1]
v_pk_mul_f32 v[96:97], v[96:97], v[192:193]
v_pk_mul_f32 v[98:99], v[98:99], v[194:195]
v_pk_mul_f32 v[100:101], v[100:101], v[196:197]
v_pk_mul_f32 v[102:103], v[102:103], v[198:199]
v_pk_mul_f32 v[104:105], v[104:105], v[200:201]
v_pk_mul_f32 v[106:107], v[106:107], v[202:203]
v_pk_mul_f32 v[108:109], v[108:109], v[204:205]
v_pk_mul_f32 v[110:111], v[110:111], v[206:207]
v_exp_f32 v96, v96
v_exp_f32 v97, v97
v_exp_f32 v98, v98
v_exp_f32 v99, v99
v_exp_f32 v100, v100
v_exp_f32 v101, v101
v_exp_f32 v102, v102
v_exp_f32 v103, v103
v_exp_f32 v104, v104
v_exp_f32 v105, v105
v_exp_f32 v106, v106
v_exp_f32 v107, v107
v_exp_f32 v108, v108
v_exp_f32 v109, v109
v_exp_f32 v110, v110
v_exp_f32 v111, v111
v_pk_add_f32 v[96:97], v[96:97], 1.0 op_sel_hi:[1,0]
v_pk_add_f32 v[98:99], v[98:99], 1.0 op_sel_hi:[1,0]
v_pk_add_f32 v[100:101], v[100:101], 1.0 op_sel_hi:[1,0]
v_pk_add_f32 v[102:103], v[102:103], 1.0 op_sel_hi:[1,0]
v_pk_add_f32 v[104:105], v[104:105], 1.0 op_sel_hi:[1,0]
v_pk_add_f32 v[106:107], v[106:107], 1.0 op_sel_hi:[1,0]
v_pk_add_f32 v[108:109], v[108:109], 1.0 op_sel_hi:[1,0]
v_pk_add_f32 v[110:111], v[110:111], 1.0 op_sel_hi:[1,0]
v_rcp_f32 v96, v96
v_rcp_f32 v97, v97
v_rcp_f32 v98, v98
v_rcp_f32 v99, v99
v_rcp_f32 v100, v100
v_rcp_f32 v101, v101
v_rcp_f32 v102, v102
v_rcp_f32 v103, v103
v_rcp_f32 v104, v104
v_rcp_f32 v105, v105
v_rcp_f32 v106, v106
v_rcp_f32 v107, v107
v_rcp_f32 v108, v108
v_rcp_f32 v109, v109
v_rcp_f32 v110, v110
v_rcp_f32 v111, v111
v_pk_mul_f32 v[192:193], v[192:193], v[96:97]
v_pk_mul_f32 v[194:195], v[194:195], v[98:99]
v_pk_mul_f32 v[196:197], v[196:197], v[100:101]
v_pk_mul_f32 v[198:199], v[198:199], v[102:103]
v_pk_mul_f32 v[200:201], v[200:201], v[104:105]
v_pk_mul_f32 v[202:203], v[202:203], v[106:107]
v_pk_mul_f32 v[204:205], v[204:205], v[108:109]
v_pk_mul_f32 v[206:207], v[206:207], v[110:111]
v_cvt_pk_bf16_f32 v112, v192, v193
v_cvt_pk_bf16_f32 v113, v194, v195
v_cvt_pk_bf16_f32 v114, v196, v197
v_cvt_pk_bf16_f32 v115, v198, v199
v_cvt_pk_bf16_f32 v116, v200, v201
v_cvt_pk_bf16_f32 v117, v202, v203
v_cvt_pk_bf16_f32 v118, v204, v205
v_cvt_pk_bf16_f32 v119, v206, v207
s_lshl_b32 s31, s48, 10
s_add_u32 s31, s31, s30
v_add_u32 v2, s31, v13
ds_write_b64 v2, v[112:113]
s_lshl_b32 s31, s49, 10
s_add_u32 s31, s31, s30
v_add_u32 v2, s31, v13
ds_write_b64 v2, v[114:115]
s_lshl_b32 s31, s50, 10
s_add_u32 s31, s31, s30
v_add_u32 v2, s31, v13
ds_write_b64 v2, v[116:117]
s_lshl_b32 s31, s51, 10
s_add_u32 s31, s31, s30
v_add_u32 v2, s31, v13
ds_write_b64 v2, v[118:119]
K3_skip2:
s_waitcnt lgkmcnt(0)
s_barrier
s_mul_i32 s30, s24, 5120
v_add_u32 v2, s30, v13
v_add_u32 v2, 76800, v2
ds_read_b128 v[32:35], v2 offset:0
ds_read_b128 v[36:39], v2 offset:1024
ds_read_b128 v[40:43], v2 offset:2048
ds_read_b128 v[44:47], v2 offset:3072
ds_read_b128 v[48:51], v2 offset:4096
s_mul_i32 s31, s25, 43
s_mul_i32 s43, s26, 5
s_add_u32 s31, s31, s43
s_lshl_b32 s31, s31, 12
s_add_u32 s31, s31, s30
s_add_u32 s31, s31, 11534336
s_waitcnt lgkmcnt(4)
buffer_store_dwordx4 v[32:35], v13, s[8:11], s31 offen offset:0 sc1
s_waitcnt lgkmcnt(3)
buffer_store_dwordx4 v[36:39], v13, s[8:11], s31 offen offset:1024 sc1
s_waitcnt lgkmcnt(2)
buffer_store_dwordx4 v[40:43], v13, s[8:11], s31 offen offset:2048 sc1
s_waitcnt lgkmcnt(1)
buffer_store_dwordx4 v[44:47], v13, s[8:11], s31 offen offset:3072 sc1
s_waitcnt lgkmcnt(0)
s_add_u32 s31, s31, 4096
buffer_store_dwordx4 v[48:51], v13, s[8:11], s31 offen offset:0 sc1
v_accvgpr_write_b32 a176, 0
v_accvgpr_write_b32 a177, 0
v_accvgpr_write_b32 a178, 0
v_accvgpr_write_b32 a179, 0
v_accvgpr_write_b32 a180, 0
v_accvgpr_write_b32 a181, 0
v_accvgpr_write_b32 a182, 0
v_accvgpr_write_b32 a183, 0
v_accvgpr_write_b32 a184, 0
v_accvgpr_write_b32 a185, 0
v_accvgpr_write_b32 a186, 0
v_accvgpr_write_b32 a187, 0
v_accvgpr_write_b32 a188, 0
v_accvgpr_write_b32 a189, 0
v_accvgpr_write_b32 a190, 0
v_accvgpr_write_b32 a191, 0
v_accvgpr_write_b32 a192, 0
v_accvgpr_write_b32 a193, 0
v_accvgpr_write_b32 a194, 0
v_accvgpr_write_b32 a195, 0
v_accvgpr_write_b32 a196, 0
v_accvgpr_write_b32 a197, 0
v_accvgpr_write_b32 a198, 0
v_accvgpr_write_b32 a199, 0
v_accvgpr_write_b32 a200, 0
v_accvgpr_write_b32 a201, 0
v_accvgpr_write_b32 a202, 0
v_accvgpr_write_b32 a203, 0
v_accvgpr_write_b32 a204, 0
v_accvgpr_write_b32 a205, 0
v_accvgpr_write_b32 a206, 0
v_accvgpr_write_b32 a207, 0
v_accvgpr_write_b32 a208, 0
v_accvgpr_write_b32 a209, 0
v_accvgpr_write_b32 a210, 0
v_accvgpr_write_b32 a211, 0
v_accvgpr_write_b32 a212, 0
v_accvgpr_write_b32 a213, 0
v_accvgpr_write_b32 a214, 0
v_accvgpr_write_b32 a215, 0
v_accvgpr_write_b32 a216, 0
v_accvgpr_write_b32 a217, 0
v_accvgpr_write_b32 a218, 0
v_accvgpr_write_b32 a219, 0
v_accvgpr_write_b32 a220, 0
v_accvgpr_write_b32 a221, 0
v_accvgpr_write_b32 a222, 0
v_accvgpr_write_b32 a223, 0
v_accvgpr_write_b32 a224, 0
v_accvgpr_write_b32 a225, 0
v_accvgpr_write_b32 a226, 0
v_accvgpr_write_b32 a227, 0
v_accvgpr_write_b32 a228, 0
v_accvgpr_write_b32 a229, 0
v_accvgpr_write_b32 a230, 0
v_accvgpr_write_b32 a231, 0
v_accvgpr_write_b32 a232, 0
v_accvgpr_write_b32 a233, 0
v_accvgpr_write_b32 a234, 0
v_accvgpr_write_b32 a235, 0
v_accvgpr_write_b32 a236, 0
v_accvgpr_write_b32 a237, 0
v_accvgpr_write_b32 a238, 0
v_accvgpr_write_b32 a239, 0
s_lshl_b32 s30, s24, 12
s_add_u32 s30, s30, 76800
v_add_u32 v2, s30, v13
ds_read_b128 v[192:195], v2 offset:0
ds_read_b128 v[196:199], v2 offset:1024
ds_read_b128 v[200:203], v2 offset:2048
ds_read_b128 v[204:207], v2 offset:3072
s_waitcnt vmcnt(5) lgkmcnt(0)
v_mfma_f32_16x16x32_bf16 a[176:179], a[0:3], v[192:195], a[176:179]
v_mfma_f32_16x16x32_bf16 a[180:183], a[0:3], v[196:199], a[180:183]
v_mfma_f32_16x16x32_bf16 a[184:187], a[0:3], v[200:203], a[184:187]
v_mfma_f32_16x16x32_bf16 a[188:191], a[0:3], v[204:207], a[188:191]
v_mfma_f32_16x16x32_bf16 a[192:195], a[4:7], v[192:195], a[192:195]
v_mfma_f32_16x16x32_bf16 a[196:199], a[4:7], v[196:199], a[196:199]
v_mfma_f32_16x16x32_bf16 a[200:203], a[4:7], v[200:203], a[200:203]
v_mfma_f32_16x16x32_bf16 a[204:207], a[4:7], v[204:207], a[204:207]
v_mfma_f32_16x16x32_bf16 a[208:211], a[8:11], v[192:195], a[208:211]
v_mfma_f32_16x16x32_bf16 a[212:215], a[8:11], v[196:199], a[212:215]
v_mfma_f32_16x16x32_bf16 a[216:219], a[8:11], v[200:203], a[216:219]
v_mfma_f32_16x16x32_bf16 a[220:223], a[8:11], v[204:207], a[220:223]
v_mfma_f32_16x16x32_bf16 a[224:227], a[12:15], v[192:195], a[224:227]
v_mfma_f32_16x16x32_bf16 a[228:231], a[12:15], v[196:199], a[228:231]
v_mfma_f32_16x16x32_bf16 a[232:235], a[12:15], v[200:203], a[232:235]
v_mfma_f32_16x16x32_bf16 a[236:239], a[12:15], v[204:207], a[236:239]
s_waitcnt vmcnt(0)
s_barrier
s_cmp_lg_u32 s24, 0
s_cbranch_scc1 K3_wait
s_lshl_b32 s30, s25, 7
s_add_u32 s30, s30, 6520832
v_mov_b32 v2, s30
v_mov_b32 v4, 1
s_mov_b64 s[42:43], exec
s_mov_b64 exec, 1
global_atomic_add v4, v2, v4, s[14:15] sc0 sc1
s_waitcnt vmcnt(0)
v_readfirstlane_b32 s30, v4
s_cmp_eq_u32 s30, 7
s_cbranch_scc1 K3_pollx
s_mov_b32 s31, 0x100000
K3_poll:
buffer_load_dword v5, v2, s[8:11], 0 offen sc1
s_waitcnt vmcnt(0)
v_readfirstlane_b32 s30, v5
s_sub_u32 s31, s31, 1
s_cmp_eq_u32 s31, 0
s_cbranch_scc1 K3_pollx
s_cmp_ge_u32 s30, 8
s_cbranch_scc0 K3_poll
K3_pollx:
s_mov_b64 exec, s[42:43]
K3_wait:
s_barrier
s_mul_i32 s57, s25, 43
s_lshl_b32 s57, s57, 12
s_add_u32 s57, s57, 11534336
s_mov_b32 s64, s58
s_cmp_ge_u32 s64, s67
s_cselect_b32 s56, 4, 0
s_add_u32 s56, s56, s64
s_min_u32 s56, s56, 42
s_lshl_b32 s56, s56, 12
s_add_u32 s56, s56, s57
buffer_load_dwordx4 v[32:35], v13, s[8:11], s56 offen offset:0 sc1
buffer_load_dwordx4 v[36:39], v13, s[8:11], s56 offen offset:1024 sc1
buffer_load_dwordx4 v[40:43], v13, s[8:11], s56 offen offset:2048 sc1
buffer_load_dwordx4 v[44:47], v13, s[8:11], s56 offen offset:3072 sc1
s_add_u32 s64, s64, 1
s_cmp_ge_u32 s64, s67
s_cselect_b32 s56, 4, 0
s_add_u32 s56, s56, s64
s_min_u32 s56, s56, 42
s_lshl_b32 s56, s56, 12
s_add_u32 s56, s56, s57
buffer_load_dwordx4 v[48:51], v13, s[8:11], s56 offen offset:0 sc1
buffer_load_dwordx4 v[52:55], v13, s[8:11], s56 offen offset:1024 sc1
buffer_load_dwordx4 v[56:59], v13, s[8:11], s56 offen offset:2048 sc1
buffer_load_dwordx4 v[60:63], v13, s[8:11], s56 offen offset:3072 sc1
s_add_u32 s64, s64, 1
s_cmp_ge_u32 s64, s67
s_cselect_b32 s56, 4, 0
s_add_u32 s56, s56, s64
s_min_u32 s56, s56, 42
s_lshl_b32 s56, s56, 12
s_add_u32 s56, s56, s57
buffer_load_dwordx4 v[64:67], v13, s[8:11], s56 offen offset:0 sc1
buffer_load_dwordx4 v[68:71], v13, s[8:11], s56 offen offset:1024 sc1
buffer_load_dwordx4 v[72:75], v13, s[8:11], s56 offen offset:2048 sc1
buffer_load_dwordx4 v[76:79], v13, s[8:11], s56 offen offset:3072 sc1
s_add_u32 s64, s64, 1
s_cmp_ge_u32 s64, s67
s_cselect_b32 s56, 4, 0
s_add_u32 s56, s56, s64
s_min_u32 s56, s56, 42
s_lshl_b32 s56, s56, 12
s_add_u32 s56, s56, s57
buffer_load_dwordx4 v[80:83], v13, s[8:11], s56 offen offset:0 sc1
buffer_load_dwordx4 v[84:87], v13, s[8:11], s56 offen offset:1024 sc1
buffer_load_dwordx4 v[88:91], v13, s[8:11], s56 offen offset:2048 sc1
buffer_load_dwordx4 v[92:95], v13, s[8:11], s56 offen offset:3072 sc1
s_add_u32 s64, s64, 1
ds_read_b64_tr_b16 v[16:17], v26 offset:0
ds_read_b64_tr_b16 v[18:19], v26 offset:2048
ds_read_b64_tr_b16 v[20:21], v125 offset:0
ds_read_b64_tr_b16 v[22:23], v125 offset:2048
s_waitcnt vmcnt(12)
v_mfma_f32_16x16x32_bf16 a[176:179], a[16:19], v[32:35], a[176:179]
s_cmp_ge_u32 s64, s67
s_cselect_b32 s56, 4, 0
s_add_u32 s56, s56, s64
s_min_u32 s56, s56, 42
s_lshl_b32 s56, s56, 12
s_add_u32 s56, s56, s57
buffer_load_dwordx4 v[96:99], v13, s[8:11], s56 offen offset:0 sc1
v_mfma_f32_16x16x32_bf16 a[180:183], a[16:19], v[36:39], a[180:183]
v_mfma_f32_16x16x32_bf16 a[184:187], a[16:19], v[40:43], a[184:187]
v_mfma_f32_16x16x32_bf16 a[188:191], a[16:19], v[44:47], a[188:191]
v_mfma_f32_16x16x32_bf16 a[192:195], a[20:23], v[32:35], a[192:195]
buffer_load_dwordx4 v[100:103], v13, s[8:11], s56 offen offset:1024 sc1
v_mfma_f32_16x16x32_bf16 a[196:199], a[20:23], v[36:39], a[196:199]
v_mfma_f32_16x16x32_bf16 a[200:203], a[20:23], v[40:43], a[200:203]
v_mfma_f32_16x16x32_bf16 a[204:207], a[20:23], v[44:47], a[204:207]
v_mfma_f32_16x16x32_bf16 a[208:211], a[24:27], v[32:35], a[208:211]
buffer_load_dwordx4 v[104:107], v13, s[8:11], s56 offen offset:2048 sc1
v_mfma_f32_16x16x32_bf16 a[212:215], a[24:27], v[36:39], a[212:215]
v_mfma_f32_16x16x32_bf16 a[216:219], a[24:27], v[40:43], a[216:219]
v_mfma_f32_16x16x32_bf16 a[220:223], a[24:27], v[44:47], a[220:223]
v_mfma_f32_16x16x32_bf16 a[224:227], a[28:31], v[32:35], a[224:227]
buffer_load_dwordx4 v[108:111], v13, s[8:11], s56 offen offset:3072 sc1
s_add_u32 s64, s64, 1
v_mfma_f32_16x16x32_bf16 a[228:231], a[28:31], v[36:39], a[228:231]
v_mfma_f32_16x16x32_bf16 a[232:235], a[28:31], v[40:43], a[232:235]
v_mfma_f32_16x16x32_bf16 a[236:239], a[28:31], v[44:47], a[236:239]
s_waitcnt vmcnt(12)
v_mfma_f32_16x16x32_bf16 a[176:179], a[32:35], v[48:51], a[176:179]
s_cmp_ge_u32 s64, s67
s_cselect_b32 s56, 4, 0
s_add_u32 s56, s56, s64
s_min_u32 s56, s56, 42
s_lshl_b32 s56, s56, 12
s_add_u32 s56, s56, s57
buffer_load_dwordx4 v[112:115], v13, s[8:11], s56 offen offset:0 sc1
v_mfma_f32_16x16x32_bf16 a[180:183], a[32:35], v[52:55], a[180:183]
v_mfma_f32_16x16x32_bf16 a[184:187], a[32:35], v[56:59], a[184:187]
v_mfma_f32_16x16x32_bf16 a[188:191], a[32:35], v[60:63], a[188:191]
v_mfma_f32_16x16x32_bf16 a[192:195], a[36:39], v[48:51], a[192:195]
buffer_load_dwordx4 v[116:119], v13, s[8:11], s56 offen offset:1024 sc1
v_mfma_f32_16x16x32_bf16 a[196:199], a[36:39], v[52:55], a[196:199]
v_mfma_f32_16x16x32_bf16 a[200:203], a[36:39], v[56:59], a[200:203]
v_mfma_f32_16x16x32_bf16 a[204:207], a[36:39], v[60:63], a[204:207]
v_mfma_f32_16x16x32_bf16 a[208:211], a[40:43], v[48:51], a[208:211]
buffer_load_dwordx4 v[120:123], v13, s[8:11], s56 offen offset:2048 sc1
v_mfma_f32_16x16x32_bf16 a[212:215], a[40:43], v[52:55], a[212:215]
v_mfma_f32_16x16x32_bf16 a[216:219], a[40:43], v[56:59], a[216:219]
v_mfma_f32_16x16x32_bf16 a[220:223], a[40:43], v[60:63], a[220:223]
v_mfma_f32_16x16x32_bf16 a[224:227], a[44:47], v[48:51], a[224:227]
buffer_load_dwordx4 v[124:127], v13, s[8:11], s56 offen offset:3072 sc1
s_add_u32 s64, s64, 1
v_mfma_f32_16x16x32_bf16 a[228:231], a[44:47], v[52:55], a[228:231]
v_mfma_f32_16x16x32_bf16 a[232:235], a[44:47], v[56:59], a[232:235]
v_mfma_f32_16x16x32_bf16 a[236:239], a[44:47], v[60:63], a[236:239]
s_waitcnt vmcnt(12)
v_mfma_f32_16x16x32_bf16 a[176:179], a[48:51], v[64:67], a[176:179]
s_cmp_ge_u32 s64, s67
s_cselect_b32 s56, 4, 0
s_add_u32 s56, s56, s64
s_min_u32 s56, s56, 42
s_lshl_b32 s56, s56, 12
s_add_u32 s56, s56, s57
buffer_load_dwordx4 v[128:131], v13, s[8:11], s56 offen offset:0 sc1
v_mfma_f32_16x16x32_bf16 a[180:183], a[48:51], v[68:71], a[180:183]
v_mfma_f32_16x16x32_bf16 a[184:187], a[48:51], v[72:75], a[184:187]
v_mfma_f32_16x16x32_bf16 a[188:191], a[48:51], v[76:79], a[188:191]
v_mfma_f32_16x16x32_bf16 a[192:195], a[52:55], v[64:67], a[192:195]
buffer_load_dwordx4 v[132:135], v13, s[8:11], s56 offen offset:1024 sc1
v_mfma_f32_16x16x32_bf16 a[196:199], a[52:55], v[68:71], a[196:199]
v_mfma_f32_16x16x32_bf16 a[200:203], a[52:55], v[72:75], a[200:203]
v_mfma_f32_16x16x32_bf16 a[204:207], a[52:55], v[76:79], a[204:207]
v_mfma_f32_16x16x32_bf16 a[208:211], a[56:59], v[64:67], a[208:211]
buffer_load_dwordx4 v[136:139], v13, s[8:11], s56 offen offset:2048 sc1
v_mfma_f32_16x16x32_bf16 a[212:215], a[56:59], v[68:71], a[212:215]
v_mfma_f32_16x16x32_bf16 a[216:219], a[56:59], v[72:75], a[216:219]
v_mfma_f32_16x16x32_bf16 a[220:223], a[56:59], v[76:79], a[220:223]
v_mfma_f32_16x16x32_bf16 a[224:227], a[60:63], v[64:67], a[224:227]
buffer_load_dwordx4 v[140:143], v13, s[8:11], s56 offen offset:3072 sc1
s_add_u32 s64, s64, 1
v_mfma_f32_16x16x32_bf16 a[228:231], a[60:63], v[68:71], a[228:231]
v_mfma_f32_16x16x32_bf16 a[232:235], a[60:63], v[72:75], a[232:235]
v_mfma_f32_16x16x32_bf16 a[236:239], a[60:63], v[76:79], a[236:239]
s_waitcnt vmcnt(12)
v_mfma_f32_16x16x32_bf16 a[176:179], a[64:67], v[80:83], a[176:179]
s_cmp_ge_u32 s64, s67
s_cselect_b32 s56, 4, 0
s_add_u32 s56, s56, s64
s_min_u32 s56, s56, 42
s_lshl_b32 s56, s56, 12
s_add_u32 s56, s56, s57
buffer_load_dwordx4 v[144:147], v13, s[8:11], s56 offen offset:0 sc1
v_mfma_f32_16x16x32_bf16 a[180:183], a[64:67], v[84:87], a[180:183]
v_mfma_f32_16x16x32_bf16 a[184:187], a[64:67], v[88:91], a[184:187]
v_mfma_f32_16x16x32_bf16 a[188:191], a[64:67], v[92:95], a[188:191]
v_mfma_f32_16x16x32_bf16 a[192:195], a[68:71], v[80:83], a[192:195]
buffer_load_dwordx4 v[148:151], v13, s[8:11], s56 offen offset:1024 sc1
v_mfma_f32_16x16x32_bf16 a[196:199], a[68:71], v[84:87], a[196:199]
v_mfma_f32_16x16x32_bf16 a[200:203], a[68:71], v[88:91], a[200:203]
v_mfma_f32_16x16x32_bf16 a[204:207], a[68:71], v[92:95], a[204:207]
v_mfma_f32_16x16x32_bf16 a[208:211], a[72:75], v[80:83], a[208:211]
buffer_load_dwordx4 v[152:155], v13, s[8:11], s56 offen offset:2048 sc1
v_mfma_f32_16x16x32_bf16 a[212:215], a[72:75], v[84:87], a[212:215]
v_mfma_f32_16x16x32_bf16 a[216:219], a[72:75], v[88:91], a[216:219]
v_mfma_f32_16x16x32_bf16 a[220:223], a[72:75], v[92:95], a[220:223]
v_mfma_f32_16x16x32_bf16 a[224:227], a[76:79], v[80:83], a[224:227]
buffer_load_dwordx4 v[156:159], v13, s[8:11], s56 offen offset:3072 sc1
s_add_u32 s64, s64, 1
v_mfma_f32_16x16x32_bf16 a[228:231], a[76:79], v[84:87], a[228:231]
v_mfma_f32_16x16x32_bf16 a[232:235], a[76:79], v[88:91], a[232:235]
v_mfma_f32_16x16x32_bf16 a[236:239], a[76:79], v[92:95], a[236:239]
s_waitcnt vmcnt(12)
v_mfma_f32_16x16x32_bf16 a[176:179], a[80:83], v[96:99], a[176:179]
s_cmp_ge_u32 s64, s67
s_cselect_b32 s56, 4, 0
s_add_u32 s56, s56, s64
s_min_u32 s56, s56, 42
s_lshl_b32 s56, s56, 12
s_add_u32 s56, s56, s57
buffer_load_dwordx4 v[160:163], v13, s[8:11], s56 offen offset:0 sc1
v_mfma_f32_16x16x32_bf16 a[180:183], a[80:83], v[100:103], a[180:183]
v_mfma_f32_16x16x32_bf16 a[184:187], a[80:83], v[104:107], a[184:187]
v_mfma_f32_16x16x32_bf16 a[188:191], a[80:83], v[108:111], a[188:191]
v_mfma_f32_16x16x32_bf16 a[192:195], a[84:87], v[96:99], a[192:195]
buffer_load_dwordx4 v[164:167], v13, s[8:11], s56 offen offset:1024 sc1
v_mfma_f32_16x16x32_bf16 a[196:199], a[84:87], v[100:103], a[196:199]
v_mfma_f32_16x16x32_bf16 a[200:203], a[84:87], v[104:107], a[200:203]
v_mfma_f32_16x16x32_bf16 a[204:207], a[84:87], v[108:111], a[204:207]
v_mfma_f32_16x16x32_bf16 a[208:211], a[88:91], v[96:99], a[208:211]
buffer_load_dwordx4 v[168:171], v13, s[8:11], s56 offen offset:2048 sc1
v_mfma_f32_16x16x32_bf16 a[212:215], a[88:91], v[100:103], a[212:215]
v_mfma_f32_16x16x32_bf16 a[216:219], a[88:91], v[104:107], a[216:219]
v_mfma_f32_16x16x32_bf16 a[220:223], a[88:91], v[108:111], a[220:223]
v_mfma_f32_16x16x32_bf16 a[224:227], a[92:95], v[96:99], a[224:227]
buffer_load_dwordx4 v[172:175], v13, s[8:11], s56 offen offset:3072 sc1
s_add_u32 s64, s64, 1
v_mfma_f32_16x16x32_bf16 a[228:231], a[92:95], v[100:103], a[228:231]
v_mfma_f32_16x16x32_bf16 a[232:235], a[92:95], v[104:107], a[232:235]
v_mfma_f32_16x16x32_bf16 a[236:239], a[92:95], v[108:111], a[236:239]
s_waitcnt vmcnt(12)
v_mfma_f32_16x16x32_bf16 a[176:179], a[96:99], v[112:115], a[176:179]
s_cmp_ge_u32 s64, s67
s_cselect_b32 s56, 4, 0
s_add_u32 s56, s56, s64
s_min_u32 s56, s56, 42
s_lshl_b32 s56, s56, 12
s_add_u32 s56, s56, s57
buffer_load_dwordx4 v[176:179], v13, s[8:11], s56 offen offset:0 sc1
v_mfma_f32_16x16x32_bf16 a[180:183], a[96:99], v[116:119], a[180:183]
v_mfma_f32_16x16x32_bf16 a[184:187], a[96:99], v[120:123], a[184:187]
v_mfma_f32_16x16x32_bf16 a[188:191], a[96:99], v[124:127], a[188:191]
v_mfma_f32_16x16x32_bf16 a[192:195], a[100:103], v[112:115], a[192:195]
buffer_load_dwordx4 v[180:183], v13, s[8:11], s56 offen offset:1024 sc1
v_mfma_f32_16x16x32_bf16 a[196:199], a[100:103], v[116:119], a[196:199]
v_mfma_f32_16x16x32_bf16 a[200:203], a[100:103], v[120:123], a[200:203]
v_mfma_f32_16x16x32_bf16 a[204:207], a[100:103], v[124:127], a[204:207]
v_mfma_f32_16x16x32_bf16 a[208:211], a[104:107], v[112:115], a[208:211]
buffer_load_dwordx4 v[184:187], v13, s[8:11], s56 offen offset:2048 sc1
v_mfma_f32_16x16x32_bf16 a[212:215], a[104:107], v[116:119], a[212:215]
v_mfma_f32_16x16x32_bf16 a[216:219], a[104:107], v[120:123], a[216:219]
v_mfma_f32_16x16x32_bf16 a[220:223], a[104:107], v[124:127], a[220:223]
v_mfma_f32_16x16x32_bf16 a[224:227], a[108:111], v[112:115], a[224:227]
buffer_load_dwordx4 v[188:191], v13, s[8:11], s56 offen offset:3072 sc1
s_add_u32 s64, s64, 1
v_mfma_f32_16x16x32_bf16 a[228:231], a[108:111], v[116:119], a[228:231]
v_mfma_f32_16x16x32_bf16 a[232:235], a[108:111], v[120:123], a[232:235]
v_mfma_f32_16x16x32_bf16 a[236:239], a[108:111], v[124:127], a[236:239]
s_waitcnt vmcnt(12)
v_mfma_f32_16x16x32_bf16 a[176:179], a[112:115], v[128:131], a[176:179]
v_mfma_f32_16x16x32_bf16 a[180:183], a[112:115], v[132:135], a[180:183]
v_mfma_f32_16x16x32_bf16 a[184:187], a[112:115], v[136:139], a[184:187]
v_mfma_f32_16x16x32_bf16 a[188:191], a[112:115], v[140:143], a[188:191]
v_mfma_f32_16x16x32_bf16 a[192:195], a[116:119], v[128:131], a[192:195]
v_mfma_f32_16x16x32_bf16 a[196:199], a[116:119], v[132:135], a[196:199]
v_mfma_f32_16x16x32_bf16 a[200:203], a[116:119], v[136:139], a[200:203]
v_mfma_f32_16x16x32_bf16 a[204:207], a[116:119], v[140:143], a[204:207]
v_mfma_f32_16x16x32_bf16 a[208:211], a[120:123], v[128:131], a[208:211]
v_mfma_f32_16x16x32_bf16 a[212:215], a[120:123], v[132:135], a[212:215]
v_mfma_f32_16x16x32_bf16 a[216:219], a[120:123], v[136:139], a[216:219]
v_mfma_f32_16x16x32_bf16 a[220:223], a[120:123], v[140:143], a[220:223]
v_mfma_f32_16x16x32_bf16 a[224:227], a[124:127], v[128:131], a[224:227]
v_mfma_f32_16x16x32_bf16 a[228:231], a[124:127], v[132:135], a[228:231]
v_mfma_f32_16x16x32_bf16 a[232:235], a[124:127], v[136:139], a[232:235]
v_mfma_f32_16x16x32_bf16 a[236:239], a[124:127], v[140:143], a[236:239]
s_waitcnt vmcnt(8)
v_mfma_f32_16x16x32_bf16 a[176:179], a[128:131], v[144:147], a[176:179]
v_mfma_f32_16x16x32_bf16 a[180:183], a[128:131], v[148:151], a[180:183]
v_mfma_f32_16x16x32_bf16 a[184:187], a[128:131], v[152:155], a[184:187]
v_mfma_f32_16x16x32_bf16 a[188:191], a[128:131], v[156:159], a[188:191]
v_mfma_f32_16x16x32_bf16 a[192:195], a[132:135], v[144:147], a[192:195]
v_mfma_f32_16x16x32_bf16 a[196:199], a[132:135], v[148:151], a[196:199]
v_mfma_f32_16x16x32_bf16 a[200:203], a[132:135], v[152:155], a[200:203]
v_mfma_f32_16x16x32_bf16 a[204:207], a[132:135], v[156:159], a[204:207]
v_mfma_f32_16x16x32_bf16 a[208:211], a[136:139], v[144:147], a[208:211]
v_mfma_f32_16x16x32_bf16 a[212:215], a[136:139], v[148:151], a[212:215]
v_mfma_f32_16x16x32_bf16 a[216:219], a[136:139], v[152:155], a[216:219]
v_mfma_f32_16x16x32_bf16 a[220:223], a[136:139], v[156:159], a[220:223]
v_mfma_f32_16x16x32_bf16 a[224:227], a[140:143], v[144:147], a[224:227]
v_mfma_f32_16x16x32_bf16 a[228:231], a[140:143], v[148:151], a[228:231]
v_mfma_f32_16x16x32_bf16 a[232:235], a[140:143], v[152:155], a[232:235]
v_mfma_f32_16x16x32_bf16 a[236:239], a[140:143], v[156:159], a[236:239]
s_waitcnt vmcnt(4)
v_mfma_f32_16x16x32_bf16 a[176:179], a[144:147], v[160:163], a[176:179]
v_mfma_f32_16x16x32_bf16 a[180:183], a[144:147], v[164:167], a[180:183]
v_mfma_f32_16x16x32_bf16 a[184:187], a[144:147], v[168:171], a[184:187]
v_mfma_f32_16x16x32_bf16 a[188:191], a[144:147], v[172:175], a[188:191]
v_mfma_f32_16x16x32_bf16 a[192:195], a[148:151], v[160:163], a[192:195]
v_mfma_f32_16x16x32_bf16 a[196:199], a[148:151], v[164:167], a[196:199]
v_mfma_f32_16x16x32_bf16 a[200:203], a[148:151], v[168:171], a[200:203]
v_mfma_f32_16x16x32_bf16 a[204:207], a[148:151], v[172:175], a[204:207]
v_mfma_f32_16x16x32_bf16 a[208:211], a[152:155], v[160:163], a[208:211]
v_mfma_f32_16x16x32_bf16 a[212:215], a[152:155], v[164:167], a[212:215]
v_mfma_f32_16x16x32_bf16 a[216:219], a[152:155], v[168:171], a[216:219]
v_mfma_f32_16x16x32_bf16 a[220:223], a[152:155], v[172:175], a[220:223]
v_mfma_f32_16x16x32_bf16 a[224:227], a[156:159], v[160:163], a[224:227]
v_mfma_f32_16x16x32_bf16 a[228:231], a[156:159], v[164:167], a[228:231]
v_mfma_f32_16x16x32_bf16 a[232:235], a[156:159], v[168:171], a[232:235]
v_mfma_f32_16x16x32_bf16 a[236:239], a[156:159], v[172:175], a[236:239]
s_waitcnt vmcnt(0)
v_mfma_f32_16x16x32_bf16 a[176:179], a[160:163], v[176:179], a[176:179]
v_mfma_f32_16x16x32_bf16 a[180:183], a[160:163], v[180:183], a[180:183]
v_mfma_f32_16x16x32_bf16 a[184:187], a[160:163], v[184:187], a[184:187]
v_mfma_f32_16x16x32_bf16 a[188:191], a[160:163], v[188:191], a[188:191]
v_mfma_f32_16x16x32_bf16 a[192:195], a[164:167], v[176:179], a[192:195]
v_mfma_f32_16x16x32_bf16 a[196:199], a[164:167], v[180:183], a[196:199]
v_mfma_f32_16x16x32_bf16 a[200:203], a[164:167], v[184:187], a[200:203]
v_mfma_f32_16x16x32_bf16 a[204:207], a[164:167], v[188:191], a[204:207]
v_mfma_f32_16x16x32_bf16 a[208:211], a[168:171], v[176:179], a[208:211]
v_mfma_f32_16x16x32_bf16 a[212:215], a[168:171], v[180:183], a[212:215]
v_mfma_f32_16x16x32_bf16 a[216:219], a[168:171], v[184:187], a[216:219]
v_mfma_f32_16x16x32_bf16 a[220:223], a[168:171], v[188:191], a[220:223]
v_mfma_f32_16x16x32_bf16 a[224:227], a[172:175], v[176:179], a[224:227]
v_mfma_f32_16x16x32_bf16 a[228:231], a[172:175], v[180:183], a[228:231]
v_mfma_f32_16x16x32_bf16 a[232:235], a[172:175], v[184:187], a[232:235]
v_mfma_f32_16x16x32_bf16 a[236:239], a[172:175], v[188:191], a[236:239]
v_mul_u32_u24 v5, 272, v6
v_lshl_add_u32 v5, v3, 4, v5
s_mul_i32 s30, s24, 17408
s_add_u32 s30, s30, 76800
v_add_u32 v7, s30, v5
s_nop 4
ds_write_b128 v7, a[176:179] offset:0
ds_write_b128 v7, a[180:183] offset:4352
ds_write_b128 v7, a[184:187] offset:8704
ds_write_b128 v7, a[188:191] offset:13056
ds_write_b128 v7, a[192:195] offset:64
ds_write_b128 v7, a[196:199] offset:4416
ds_write_b128 v7, a[200:203] offset:8768
ds_write_b128 v7, a[204:207] offset:13120
ds_write_b128 v7, a[208:211] offset:128
ds_write_b128 v7, a[212:215] offset:4480
ds_write_b128 v7, a[216:219] offset:8832
ds_write_b128 v7, a[220:223] offset:13184
ds_write_b128 v7, a[224:227] offset:192
ds_write_b128 v7, a[228:231] offset:4544
ds_write_b128 v7, a[232:235] offset:8896
ds_write_b128 v7, a[236:239] offset:13248
s_mul_i32 s30, s24, 4352
s_add_u32 s30, s30, 76800
v_add_u32 v7, s30, v5
s_waitcnt lgkmcnt(0)
s_barrier
ds_read_b128 v[32:35], v7 offset:0
ds_read_b128 v[36:39], v7 offset:17408
ds_read_b128 v[40:43], v7 offset:34816
ds_read_b128 v[44:47], v7 offset:52224
ds_read_b128 v[48:51], v7 offset:64
ds_read_b128 v[52:55], v7 offset:17472
ds_read_b128 v[56:59], v7 offset:34880
ds_read_b128 v[60:63], v7 offset:52288
ds_read_b128 v[64:67], v7 offset:128
ds_read_b128 v[68:71], v7 offset:17536
ds_read_b128 v[72:75], v7 offset:34944
ds_read_b128 v[76:79], v7 offset:52352
ds_read_b128 v[80:83], v7 offset:192
ds_read_b128 v[84:87], v7 offset:17600
ds_read_b128 v[88:91], v7 offset:35008
ds_read_b128 v[92:95], v7 offset:52416
s_mov_b32 s40, s18
s_mov_b32 s41, s19
s_mov_b32 s42, 2097152
s_mov_b32 s43, 0x20000
s_lshl_b32 s30, s25, 16
s_lshl_b32 s31, s24, 14
s_add_u32 s30, s30, s31
s_lshl_b32 s31, s26, 7
s_add_u32 s30, s30, s31
v_lshlrev_b32 v9, 10, v6
v_lshl_add_u32 v9, v3, 3, v9
v_add_u32 v9, s30, v9
s_waitcnt lgkmcnt(12)
v_pk_add_f32 v[32:33], v[32:33], v[36:37]
v_pk_add_f32 v[40:41], v[40:41], v[44:45]
v_pk_add_f32 v[34:35], v[34:35], v[38:39]
v_pk_add_f32 v[42:43], v[42:43], v[46:47]
v_pk_add_f32 v[32:33], v[32:33], v[40:41]
v_pk_add_f32 v[34:35], v[34:35], v[42:43]
v_lshlrev_b32 v120, 16, v224
v_and_b32 v121, 0xffff0000, v224
v_lshlrev_b32 v124, 16, v16
v_and_b32 v125, 0xffff0000, v16
v_lshlrev_b32 v122, 16, v225
v_and_b32 v123, 0xffff0000, v225
v_lshlrev_b32 v126, 16, v17
v_and_b32 v127, 0xffff0000, v17
v_pk_add_f32 v[32:33], v[32:33], v[120:121]
v_pk_add_f32 v[34:35], v[34:35], v[122:123]
v_pk_fma_f32 v[32:33], v[32:33], v[208:209], v[124:125]
v_pk_fma_f32 v[34:35], v[34:35], v[210:211], v[126:127]
v_cvt_pk_bf16_f32 v24, v32, v33
v_cvt_pk_bf16_f32 v25, v34, v35
buffer_store_dwordx2 v[24:25], v9, s[40:43], 0 offen offset:0
s_waitcnt lgkmcnt(8)
v_pk_add_f32 v[48:49], v[48:49], v[52:53]
v_pk_add_f32 v[56:57], v[56:57], v[60:61]
v_pk_add_f32 v[50:51], v[50:51], v[54:55]
v_pk_add_f32 v[58:59], v[58:59], v[62:63]
v_pk_add_f32 v[48:49], v[48:49], v[56:57]
v_pk_add_f32 v[50:51], v[50:51], v[58:59]
v_lshlrev_b32 v120, 16, v226
v_and_b32 v121, 0xffff0000, v226
v_lshlrev_b32 v124, 16, v18
v_and_b32 v125, 0xffff0000, v18
v_lshlrev_b32 v122, 16, v227
v_and_b32 v123, 0xffff0000, v227
v_lshlrev_b32 v126, 16, v19
v_and_b32 v127, 0xffff0000, v19
v_pk_add_f32 v[48:49], v[48:49], v[120:121]
v_pk_add_f32 v[50:51], v[50:51], v[122:123]
v_pk_fma_f32 v[48:49], v[48:49], v[212:213], v[124:125]
v_pk_fma_f32 v[50:51], v[50:51], v[214:215], v[126:127]
v_cvt_pk_bf16_f32 v26, v48, v49
v_cvt_pk_bf16_f32 v27, v50, v51
buffer_store_dwordx2 v[26:27], v9, s[40:43], 0 offen offset:32
s_waitcnt lgkmcnt(4)
v_pk_add_f32 v[64:65], v[64:65], v[68:69]
v_pk_add_f32 v[72:73], v[72:73], v[76:77]
v_pk_add_f32 v[66:67], v[66:67], v[70:71]
v_pk_add_f32 v[74:75], v[74:75], v[78:79]
v_pk_add_f32 v[64:65], v[64:65], v[72:73]
v_pk_add_f32 v[66:67], v[66:67], v[74:75]
v_lshlrev_b32 v120, 16, v228
v_and_b32 v121, 0xffff0000, v228
v_lshlrev_b32 v124, 16, v20
v_and_b32 v125, 0xffff0000, v20
v_lshlrev_b32 v122, 16, v229
v_and_b32 v123, 0xffff0000, v229
v_lshlrev_b32 v126, 16, v21
v_and_b32 v127, 0xffff0000, v21
v_pk_add_f32 v[64:65], v[64:65], v[120:121]
v_pk_add_f32 v[66:67], v[66:67], v[122:123]
v_pk_fma_f32 v[64:65], v[64:65], v[216:217], v[124:125]
v_pk_fma_f32 v[66:67], v[66:67], v[218:219], v[126:127]
v_cvt_pk_bf16_f32 v28, v64, v65
v_cvt_pk_bf16_f32 v29, v66, v67
buffer_store_dwordx2 v[28:29], v9, s[40:43], 0 offen offset:64
s_waitcnt lgkmcnt(0)
v_pk_add_f32 v[80:81], v[80:81], v[84:85]
v_pk_add_f32 v[88:89], v[88:89], v[92:93]
v_pk_add_f32 v[82:83], v[82:83], v[86:87]
v_pk_add_f32 v[90:91], v[90:91], v[94:95]
v_pk_add_f32 v[80:81], v[80:81], v[88:89]
v_pk_add_f32 v[82:83], v[82:83], v[90:91]
v_lshlrev_b32 v120, 16, v230
v_and_b32 v121, 0xffff0000, v230
v_lshlrev_b32 v124, 16, v22
v_and_b32 v125, 0xffff0000, v22
v_lshlrev_b32 v122, 16, v231
v_and_b32 v123, 0xffff0000, v231
v_lshlrev_b32 v126, 16, v23
v_and_b32 v127, 0xffff0000, v23
v_pk_add_f32 v[80:81], v[80:81], v[120:121]
v_pk_add_f32 v[82:83], v[82:83], v[122:123]
v_pk_fma_f32 v[80:81], v[80:81], v[220:221], v[124:125]
v_pk_fma_f32 v[82:83], v[82:83], v[222:223], v[126:127]
v_cvt_pk_bf16_f32 v30, v80, v81
v_cvt_pk_bf16_f32 v31, v82, v83
buffer_store_dwordx2 v[30:31], v9, s[40:43], 0 offen offset:96
K3_END:
K3_EXIT:
s_endpgm
.section .rodata,"a"
.p2align 6
.amdhsa_kernel k3_kernel
  .amdhsa_next_free_vgpr 496
  .amdhsa_next_free_sgpr 100
  .amdhsa_accum_offset 256
  .amdhsa_group_segment_fixed_size 0
  .amdhsa_kernarg_size 136
  .amdhsa_user_sgpr_count 2
  .amdhsa_user_sgpr_kernarg_segment_ptr 1
  .amdhsa_system_sgpr_workgroup_id_x 1
  .amdhsa_float_denorm_mode_32 3
.end_amdhsa_kernel
```
